```python
import torch

def _softmax(x, axis=-1):
    return torch.softmax(x, dim=axis)
def _gelu(x):
    return torch.nn.functional.gelu(x, approximate="tanh")
def _silu(x):
    return torch.nn.functional.silu(x)
def _sigmoid(x):
    return torch.sigmoid(x)
def _layernorm(x, axis=-1, eps=1e-5):
    m = x.mean(dim=axis, keepdim=True)
    v = x.var(dim=axis, keepdim=True, unbiased=False)
    return (x - m) / torch.sqrt(v + eps)
def _scatter_add(tgt, idx, src, axis=0):
    return tgt.clone().index_add_(axis, idx, src)
def _segment_sum(src, seg, n):
    out = torch.zeros((n,) + src.shape[1:], dtype=src.dtype)
    return out.index_add_(0, seg, src)
def _pad(x, pw):
    flat = tuple(v for pair in reversed(pw) for v in pair)
    return torch.nn.functional.pad(x, flat)

kernel_name = 'sequential_preLN__ssm_conv_h3__glu_gated_swiglu__prompt'

def setup_inputs():

    _w = (lambda a: (lambda t: t.to(torch.bfloat16) if t.is_floating_point() else t)(torch.as_tensor(a)))
    def _A_setup():
        B, S, D = 1, 2048, 1024
        ks = 4
        return {
            "q": _w((lambda *s: torch.randn(*s, dtype=torch.bfloat16) * 0.05)(B, S, D)),
            "k": _w((lambda *s: torch.randn(*s, dtype=torch.bfloat16) * 0.2)(B, S, D)),
            "v": _w((lambda *s: torch.randn(*s, dtype=torch.bfloat16) * 0.2)(B, S, D)),
            "shift_k": _w((lambda *s: torch.randn(*s, dtype=torch.bfloat16) * 0.2)(D, ks) * 0.5),
            "ssm_k": _w((lambda *s: torch.randn(*s, dtype=torch.bfloat16) * 0.4)(D, S) * (1.0 / S ** 0.5)),
            "ssm_D": _w((lambda *s: torch.randn(*s, dtype=torch.bfloat16) * 0.2)(D)),
        }
    _A_in = _A_setup()

    def _B_setup():
        B, S, D, F = 1, 2048, 1024, 3584
        return {
            "x": _w((lambda *s: torch.randn(*s, dtype=torch.bfloat16) * 0.05)(B, S, D)),
            "w1": _w((lambda *s: torch.randn(*s, dtype=torch.bfloat16) * 0.2)(D, F) * (2.0 / D) ** 0.5),
            "w3": _w((lambda *s: torch.randn(*s, dtype=torch.bfloat16) * 0.2)(D, F) * (2.0 / D) ** 0.5),
            "w2": _w((lambda *s: torch.randn(*s, dtype=torch.bfloat16) * 0.2)(F, D) * (2.0 / F) ** 0.5),
        }
    _B_in = _B_setup()

    return {
        "A_q": _A_in["q"],
        "A_k": _A_in["k"],
        "A_v": _A_in["v"],
        "A_shift_k": _A_in["shift_k"],
        "A_ssm_k": _A_in["ssm_k"],
        "A_ssm_D": _A_in["ssm_D"],
        "B_x": _B_in["x"],
        "B_w1": _B_in["w1"],
        "B_w3": _B_in["w3"],
        "B_w2": _B_in["w2"],
    }

def reference(A_q, A_k, A_v, A_shift_k, A_ssm_k, A_ssm_D, B_x, B_w1, B_w3, B_w2):
    def _A_ref(q, k, v, shift_k, ssm_k, ssm_D):
        B, S, D = q.shape
        ks = shift_k.shape[-1]
        k_pad = _pad(k, ((0, 0), (ks - 1, 0), (0, 0)))
        k_shift = torch.zeros_like(k)
        for t in range(ks):
            k_shift = k_shift + k_pad[:, t:t + S, :] * shift_k[:, ks - 1 - t][None, None, :]
        kv = k_shift * v
        L = 2 * S
        kv_pad = _pad(kv, ((0, 0), (0, S), (0, 0)))
        kf_pad = _pad(ssm_k, ((0, 0), (0, S)))
        kv_f = (lambda x, axes=(-2,-1): torch.fft.rfft2(x.float(), dim=axes))(kv_pad[:, None, :, :], axes=(1, 2))
        kf_f = (lambda x, axes=(-2,-1): torch.fft.rfft2(x.float(), dim=axes))(kf_pad[:, None, :], axes=(1, 2))
        kf_f = (lambda x, *d: x.permute(*d))(kf_f, 1, 2, 0)
        y_f = kv_f * kf_f[None, :, :, :]
        y = (lambda x, s, axes=(-2,-1): torch.fft.irfft2(x, s=s, dim=axes).to(torch.bfloat16))(y_f, (1, L), axes=(1, 2))[:, 0, :S, :]
        y = y + kv * ssm_D[None, None, :]
        return q * y

    def _B_ref(x, w1, w3, w2):
        gate = torch.einsum("bsd,df->bsf", x, w1)
        up = torch.einsum("bsd,df->bsf", x, w3)
        h = _silu(gate) * up
        out = torch.einsum("bsf,fd->bsd", h, w2)
        return out

    x = A_q
    h = x + _A_ref(_layernorm(x, axis=-1), A_k, A_v, A_shift_k, A_ssm_k, A_ssm_D)
    h2 = h + _B_ref(_layernorm(h, axis=-1), B_w1, B_w3, B_w2)
    return h2
```

```asm
; @launch grid=(256,1,1) block=(256,1,1) lds=163840
.amdgcn_target "amdgcn-amd-amdhsa--gfx950"
.text
.globl sequential_preLN__ssm_conv_h3__glu_gated_swiglu__prompt_kernel
.p2align 8
.type sequential_preLN__ssm_conv_h3__glu_gated_swiglu__prompt_kernel,@function
sequential_preLN__ssm_conv_h3__glu_gated_swiglu__prompt_kernel:
    s_cmp_ge_u32 s2, 256
    s_cbranch_scc1 L_end
    s_load_dwordx8 s[4:11], s[0:1], 0
    s_load_dwordx8 s[20:27], s[0:1], 64
    s_load_dwordx2 s[28:29], s[0:1], 96
    s_load_dwordx8 s[12:19], s[0:1], 32
    s_memrealtime s[56:57]
    v_lshrrev_b32 v1, 6, v0
    v_and_b32 v2, 63, v0
    v_readfirstlane_b32 s30, v1
    s_mov_b32 s90, 0xffff0000
    s_mov_b32 s3, 0
    s_bfe_u32 s82, s2, 0x30003
    s_and_b32 s83, s2, 7
    s_lshr_b32 s84, s2, 6
    s_lshl_b32 s84, s84, 3
    s_or_b32 s83, s83, s84
    v_and_b32 v9, 3, v0
    v_bfe_u32 v10, v0, 4, 1
    v_lshl_add_u32 v1, v9, 1, v10
    v_bfe_u32 v8, v0, 5, 2
    v_bfe_u32 v11, v0, 2, 2
    v_lshl_add_u32 v8, v8, 2, v11
    s_lshr_b32 s77, s30, 1
    s_lshl_b32 s85, s83, 16
    s_lshl_b32 s86, s77, 21
    s_add_u32 s85, s85, s86
    s_lshl_b32 s86, s82, 8
    s_add_u32 s85, s85, s86
    v_lshlrev_b32 v3, 13, v1
    v_lshl_add_u32 v3, v8, 4, v3
    v_add_u32 v3, s85, v3
    v_add_u32 v4, 0xffffe800, v3
    v_add_u32 v5, 0xfffff800, v3
    v_add_u32 v6, 0x1000, v3
    s_lshl_b32 s86, s82, 10
    v_lshlrev_b32 v7, 6, v8
    v_add_u32 v7, s86, v7
    s_lshl_b32 s87, s82, 1
    s_add_u32 s87, s87, s77
    s_lshl_b32 s87, s87, 5
    s_add_u32 s87, s87, s83
    s_lshl_b32 s88, s87, 13
    s_add_u32 s88, s88, 48
    v_lshlrev_b32 v160, 9, v8
    v_lshl_add_u32 v160, v10, 8, v160
    v_lshlrev_b32 v161, 4, v9
    v_sub_u32 v160, v160, v161
    v_add_u32 v160, s88, v160
    s_lshl_b32 s87, s87, 1
    s_and_b32 s86, s30, 1
    s_add_u32 s87, s87, s86
    s_lshl_b32 s87, s87, 5
    v_mov_b32 v162, 0
    s_mul_i32 s88, s30, 13056
    s_add_u32 s88, s88, 98304
    s_and_b32 s101, s2, 7
    s_lshl_b32 s101, s101, 7
    s_lshr_b32 s99, s2, 3
    s_lshl_b32 s99, s99, 2
    s_add_u32 s101, s101, s99
    s_add_u32 s101, s101, s30
    s_lshl_b32 s99, s101, 12
    s_and_b32 s80, s2, 1
    s_lshl_b32 s80, s80, 2
    s_bfe_u32 s81, s2, 0x20003
    s_add_u32 s80, s80, s81
    s_bfe_u32 s81, s2, 0x20001
    s_lshl_b32 s81, s81, 3
    s_lshr_b32 s91, s2, 5
    s_add_u32 s81, s81, s91
    s_lshl_b32 s91, s80, 5
    s_add_u32 s91, s91, s81
    s_lshl_b32 s96, s91, 2
    s_add_u32 s96, s96, s30
    s_lshl_b32 s96, s96, 12
    v_lshlrev_b32 v220, 4, v2
    s_waitcnt lgkmcnt(0)
    s_mov_b32 s44, s26
    s_mov_b32 s45, s27
    s_mov_b32 s46, 0x100
    s_mov_b32 s47, 0x20000
    s_cmp_eq_u32 s77, 0
    s_cbranch_scc1 L_p0
    s_add_u32 s68, s12, s99
    s_addc_u32 s69, s13, 0
    s_mov_b32 s70, 0x1000
    s_mov_b32 s71, 0x20000
    buffer_load_dwordx4 v[200:203], v220, s[68:71], 0 offen offset:0
    buffer_load_dword v216, v220, s[68:71], 0 offen offset:16
    buffer_load_dwordx4 v[204:207], v220, s[68:71], 0 offen offset:1024
    buffer_load_dword v217, v220, s[68:71], 0 offen offset:1040
    buffer_load_dwordx4 v[208:211], v220, s[68:71], 0 offen offset:2048
    buffer_load_dword v218, v220, s[68:71], 0 offen offset:2064
    buffer_load_dwordx4 v[212:215], v220, s[68:71], 0 offen offset:3072
    buffer_load_dword v219, v220, s[68:71], 0 offen offset:3088
    s_and_b32 s76, s2, 1
    s_lshr_b32 s56, s2, 3
    s_bfe_u32 s74, s2, 0x10001
    s_lshl_b32 s74, s74, 3
    s_and_b32 s57, s56, 7
    s_add_u32 s74, s74, s57
    s_bfe_u32 s75, s2, 0x10002
    s_lshl_b32 s75, s75, 2
    s_lshr_b32 s57, s56, 3
    s_add_u32 s75, s75, s57
    v_lshrrev_b32 v252, 2, v2
    v_lshlrev_b32 v253, 11, v252
    v_lshrrev_b32 v254, 3, v2
    v_xor_b32 v254, v254, v2
    v_and_b32 v254, 2, v254
    v_and_or_b32 v254, v2, 1, v254
    v_lshl_add_u32 v248, v254, 4, v253
    v_add_u32 v249, 31744, v248
    v_add_u32 v250, 63488, v248
    v_add_u32 v251, 95232, v248
    s_mul_i32 s56, s76, 3670016
    s_lshl_b32 s57, s75, 8
    s_add_u32 s56, s56, s57
    s_lshl_b32 s57, s30, 6
    s_add_u32 s56, s56, s57
    s_add_u32 s68, s22, s56
    s_addc_u32 s69, s23, 0
    s_mov_b32 s71, 0x20000
    s_sub_u32 s70, 7340032, s56
    s_mov_b32 s72, 0
    v_lshlrev_b32 v252, 6, v252
    v_bfe_u32 v253, v2, 4, 1
    v_lshl_add_u32 v252, v253, 5, v252
    v_and_b32 v253, 3, v2
    v_lshl_add_u32 v252, v253, 3, v252
    s_lshl_b32 s73, s30, 13
    s_add_u32 s73, s73, 32768
    v_add_u32 v253, s73, v252
    v_xor_b32 v254, 32, v253
    s_and_b32 s56, s81, 1
    s_lshl_b32 s56, s56, 1
    s_movk_i32 s57, 4682
    s_movk_i32 s58, 7168
    v_mov_b32 v76, 0x80000000
    v_subrev_u32 v77, 8, v2
    v_cmp_gt_u32 vcc, 56, v2
    v_mul_u32_u24 v80, s57, v2
    v_lshrrev_b32 v80, 16, v80
    v_mul_u32_u24 v81, 14, v80
    v_sub_u32 v81, v2, v81
    v_add_u32 v81, s56, v81
    v_subrev_u32 v82, 14, v81
    v_min_u32 v81, v81, v82
    v_mul_u32_u24 v80, s58, v80
    v_lshl_add_u32 v80, v81, 4, v80
    v_cndmask_b32 v78, v76, v80, vcc
    v_cmp_gt_u32 vcc, 56, v77
    v_mul_u32_u24 v80, s57, v77
    v_lshrrev_b32 v80, 16, v80
    v_mul_u32_u24 v81, 14, v80
    v_sub_u32 v81, v77, v81
    v_add_u32 v81, s56, v81
    v_subrev_u32 v82, 14, v81
    v_min_u32 v81, v81, v82
    v_mul_u32_u24 v80, s58, v80
    v_lshl_add_u32 v80, v81, 4, v80
    v_cndmask_b32 v79, v76, v80, vcc
    v_mov_b32 v240, v78
    v_add_u32 v241, 27648, v78
    v_add_u32 v242, 55296, v79
    v_add_u32 v243, 82944, v79
    v_add_u32 v244, 114688, v78
    v_add_u32 v245, 142336, v78
    v_add_u32 v246, 169984, v79
    v_add_u32 v247, 197632, v79
    s_and_b32 s56, s30, 1
    s_lshr_b32 s57, s30, 1
    s_mul_i32 s97, s56, 229376
    s_mov_b32 s100, 458752
    s_lshl_b32 s98, s57, 14
    s_lshl_b32 s56, s56, 13
    s_add_u32 s98, s98, s56
    s_mul_i32 s56, s81, 224
    s_cmp_eq_u32 s57, 0
    s_cselect_b32 s52, s18, s20
    s_cselect_b32 s53, s19, s21
    s_add_u32 s52, s52, s56
    s_addc_u32 s53, s53, 0
    s_mov_b32 s55, 0x20000
    s_sub_u32 s54, 7340032, s56
    v_mov_b32 v196, 0
    v_mov_b32 v197, 0
    v_lshlrev_b32 v198, 3, v2
    v_add_u32 v198, s88, v198
    ds_write_b64 v198, v[196:197] offset:4096
    v_min_u32 v199, 7, v2
    v_lshlrev_b32 v199, 2, v199
    v_add_u32 v199, s88, v199
    ds_write_b32 v199, v196 offset:4608
    v_add_u32 v198, s88, v220
    s_waitcnt vmcnt(6)
    v_readfirstlane_b32 s58, v200
    ds_write_b128 v198, v[200:203] offset:4640
    v_alignbit_b32 v224, v201, v200, 16
    v_alignbit_b32 v225, v202, v201, 16
    v_alignbit_b32 v226, v203, v202, 16
    v_alignbit_b32 v227, v216, v203, 16
    ds_write_b128 v198, v[224:227] offset:8800
    s_waitcnt vmcnt(4)
    ds_write_b128 v198, v[204:207] offset:5664
    v_alignbit_b32 v228, v205, v204, 16
    v_alignbit_b32 v229, v206, v205, 16
    v_alignbit_b32 v230, v207, v206, 16
    v_alignbit_b32 v231, v217, v207, 16
    ds_write_b128 v198, v[228:231] offset:9824
    s_waitcnt vmcnt(2)
    ds_write_b128 v198, v[208:211] offset:6688
    v_alignbit_b32 v232, v209, v208, 16
    v_alignbit_b32 v233, v210, v209, 16
    v_alignbit_b32 v234, v211, v210, 16
    v_alignbit_b32 v235, v218, v211, 16
    ds_write_b128 v198, v[232:235] offset:10848
    s_waitcnt vmcnt(0)
    ds_write_b128 v198, v[212:215] offset:7712
    v_alignbit_b32 v236, v213, v212, 16
    v_alignbit_b32 v237, v214, v213, 16
    v_alignbit_b32 v238, v215, v214, 16
    v_alignbit_b32 v239, v219, v215, 16
    ds_write_b128 v198, v[236:239] offset:11872
    s_lshl_b32 s58, s58, 16
    v_cmp_le_u32 vcc, 7, v2
    v_mov_b32 v197, s58
    s_nop 0
    v_cndmask_b32 v197, v196, v197, vcc
    ds_write_b32 v199, v197 offset:8768
L_p0:
    s_mov_b32 s32, s6
    s_mov_b32 s33, s7
    s_mov_b32 s34, 0x400000
    s_mov_b32 s35, 0x20000
    s_mov_b32 s36, s8
    s_mov_b32 s37, s9
    s_mov_b32 s38, 0x400000
    s_mov_b32 s39, 0x20000
    s_mov_b32 s40, s10
    s_mov_b32 s41, s11
    s_mov_b32 s42, 0x2000
    s_mov_b32 s43, 0x20000
    buffer_load_dwordx4 v[52:55], v7, s[40:43], 0 offen offset:0
    buffer_load_dwordx4 v[56:59], v7, s[40:43], 0 offen offset:16
    buffer_load_dwordx4 v[60:63], v7, s[40:43], 0 offen offset:32
    buffer_load_dwordx4 v[64:67], v7, s[40:43], 0 offen offset:48
    buffer_load_dwordx4 v[8:11], v4, s[32:35], 0 offen offset:0
    buffer_load_dwordx4 v[12:15], v4, s[32:35], 0 offen offset:2048
    buffer_load_dwordx4 v[16:19], v5, s[32:35], 0 offen offset:0
    buffer_load_dwordx4 v[20:23], v3, s[32:35], 0 offen offset:0
    buffer_load_dwordx4 v[24:27], v3, s[32:35], 0 offen offset:2048
    buffer_load_dwordx4 v[28:31], v6, s[32:35], 0 offen offset:0
    buffer_load_dwordx4 v[32:35], v6, s[32:35], 0 offen offset:2048
    buffer_load_dwordx4 v[36:39], v3, s[36:39], 0 offen offset:0
    buffer_load_dwordx4 v[40:43], v3, s[36:39], 0 offen offset:2048
    buffer_load_dwordx4 v[44:47], v6, s[36:39], 0 offen offset:0
    buffer_load_dwordx4 v[48:51], v6, s[36:39], 0 offen offset:2048
L_p0b:
    s_mov_b32 s48, s28
    s_mov_b32 s49, s29
    s_mov_b32 s50, 0x400000
    s_mov_b32 s51, 0x20000
    s_or_b32 s56, s56, 1
    s_xor_b32 s57, s30, 0
    s_or_b32 s57, s57, s2
    s_cmp_lg_u32 s57, 0
    s_cbranch_scc1 L_nonce_skip
    v_mov_b32 v163, s56
    s_mov_b64 exec, 1
    buffer_store_dword v163, v162, s[44:47], 0 offen sc1
    s_mov_b64 exec, -1
    s_waitcnt vmcnt(0)
L_nonce_skip:
    s_add_u32 s92, s28, 0x2800000
    s_addc_u32 s93, s29, 0
    s_mov_b32 s94, 0x40000
    s_mov_b32 s95, 0x20000
    s_waitcnt vmcnt(11)
    v_lshlrev_b32 v68, 16, v52
    v_and_b32 v76, s90, v52
    v_lshlrev_b32 v84, 16, v53
    v_and_b32 v92, s90, v53
    v_lshlrev_b32 v69, 16, v54
    v_and_b32 v77, s90, v54
    v_lshlrev_b32 v85, 16, v55
    v_and_b32 v93, s90, v55
    v_lshlrev_b32 v70, 16, v56
    v_and_b32 v78, s90, v56
    v_lshlrev_b32 v86, 16, v57
    v_and_b32 v94, s90, v57
    v_lshlrev_b32 v71, 16, v58
    v_and_b32 v79, s90, v58
    v_lshlrev_b32 v87, 16, v59
    v_and_b32 v95, s90, v59
    v_lshlrev_b32 v72, 16, v60
    v_and_b32 v80, s90, v60
    v_lshlrev_b32 v88, 16, v61
    v_and_b32 v96, s90, v61
    v_lshlrev_b32 v73, 16, v62
    v_and_b32 v81, s90, v62
    v_lshlrev_b32 v89, 16, v63
    v_and_b32 v97, s90, v63
    v_lshlrev_b32 v74, 16, v64
    v_and_b32 v82, s90, v64
    v_lshlrev_b32 v90, 16, v65
    v_and_b32 v98, s90, v65
    v_lshlrev_b32 v75, 16, v66
    v_and_b32 v83, s90, v66
    v_lshlrev_b32 v91, 16, v67
    v_and_b32 v99, s90, v67
    s_waitcnt vmcnt(10)
    v_lshlrev_b32 v100, 16, v8
    v_and_b32 v101, s90, v8
    v_lshlrev_b32 v102, 16, v9
    v_and_b32 v103, s90, v9
    v_lshlrev_b32 v104, 16, v10
    v_and_b32 v105, s90, v10
    v_lshlrev_b32 v106, 16, v11
    v_and_b32 v107, s90, v11
    s_waitcnt vmcnt(9)
    v_lshlrev_b32 v108, 16, v12
    v_and_b32 v109, s90, v12
    v_lshlrev_b32 v110, 16, v13
    v_and_b32 v111, s90, v13
    v_lshlrev_b32 v112, 16, v14
    v_and_b32 v113, s90, v14
    v_lshlrev_b32 v114, 16, v15
    v_and_b32 v115, s90, v15
    s_waitcnt vmcnt(8)
    v_lshlrev_b32 v116, 16, v16
    v_and_b32 v117, s90, v16
    v_lshlrev_b32 v118, 16, v17
    v_and_b32 v119, s90, v17
    v_lshlrev_b32 v120, 16, v18
    v_and_b32 v121, s90, v18
    v_lshlrev_b32 v122, 16, v19
    v_and_b32 v123, s90, v19
    s_waitcnt vmcnt(7)
    v_lshlrev_b32 v124, 16, v20
    v_and_b32 v125, s90, v20
    v_lshlrev_b32 v126, 16, v21
    v_and_b32 v127, s90, v21
    v_lshlrev_b32 v128, 16, v22
    v_and_b32 v129, s90, v22
    v_lshlrev_b32 v130, 16, v23
    v_and_b32 v131, s90, v23
    v_pk_mul_f32 v[164:165], v[124:125], v[68:69]
    v_pk_mul_f32 v[166:167], v[126:127], v[70:71]
    v_pk_mul_f32 v[168:169], v[128:129], v[72:73]
    v_pk_mul_f32 v[170:171], v[130:131], v[74:75]
    v_pk_fma_f32 v[164:165], v[116:117], v[76:77], v[164:165]
    v_pk_fma_f32 v[166:167], v[118:119], v[78:79], v[166:167]
    v_pk_fma_f32 v[168:169], v[120:121], v[80:81], v[168:169]
    v_pk_fma_f32 v[170:171], v[122:123], v[82:83], v[170:171]
    v_pk_fma_f32 v[164:165], v[108:109], v[84:85], v[164:165]
    v_pk_fma_f32 v[166:167], v[110:111], v[86:87], v[166:167]
    v_pk_fma_f32 v[168:169], v[112:113], v[88:89], v[168:169]
    v_pk_fma_f32 v[170:171], v[114:115], v[90:91], v[170:171]
    v_pk_fma_f32 v[164:165], v[100:101], v[92:93], v[164:165]
    v_pk_fma_f32 v[166:167], v[102:103], v[94:95], v[166:167]
    v_pk_fma_f32 v[168:169], v[104:105], v[96:97], v[168:169]
    v_pk_fma_f32 v[170:171], v[106:107], v[98:99], v[170:171]
    s_waitcnt vmcnt(6)
    v_lshlrev_b32 v132, 16, v24
    v_and_b32 v133, s90, v24
    v_lshlrev_b32 v134, 16, v25
    v_and_b32 v135, s90, v25
    v_lshlrev_b32 v136, 16, v26
    v_and_b32 v137, s90, v26
    v_lshlrev_b32 v138, 16, v27
    v_and_b32 v139, s90, v27
    v_pk_mul_f32 v[172:173], v[132:133], v[68:69]
    v_pk_mul_f32 v[174:175], v[134:135], v[70:71]
    v_pk_mul_f32 v[176:177], v[136:137], v[72:73]
    v_pk_mul_f32 v[178:179], v[138:139], v[74:75]
    v_pk_fma_f32 v[172:173], v[124:125], v[76:77], v[172:173]
    v_pk_fma_f32 v[174:175], v[126:127], v[78:79], v[174:175]
    v_pk_fma_f32 v[176:177], v[128:129], v[80:81], v[176:177]
    v_pk_fma_f32 v[178:179], v[130:131], v[82:83], v[178:179]
    v_pk_fma_f32 v[172:173], v[116:117], v[84:85], v[172:173]
    v_pk_fma_f32 v[174:175], v[118:119], v[86:87], v[174:175]
    v_pk_fma_f32 v[176:177], v[120:121], v[88:89], v[176:177]
    v_pk_fma_f32 v[178:179], v[122:123], v[90:91], v[178:179]
    v_pk_fma_f32 v[172:173], v[108:109], v[92:93], v[172:173]
    v_pk_fma_f32 v[174:175], v[110:111], v[94:95], v[174:175]
    v_pk_fma_f32 v[176:177], v[112:113], v[96:97], v[176:177]
    v_pk_fma_f32 v[178:179], v[114:115], v[98:99], v[178:179]
    s_waitcnt vmcnt(5)
    v_lshlrev_b32 v140, 16, v28
    v_and_b32 v141, s90, v28
    v_lshlrev_b32 v142, 16, v29
    v_and_b32 v143, s90, v29
    v_lshlrev_b32 v144, 16, v30
    v_and_b32 v145, s90, v30
    v_lshlrev_b32 v146, 16, v31
    v_and_b32 v147, s90, v31
    v_pk_mul_f32 v[180:181], v[140:141], v[68:69]
    v_pk_mul_f32 v[182:183], v[142:143], v[70:71]
    v_pk_mul_f32 v[184:185], v[144:145], v[72:73]
    v_pk_mul_f32 v[186:187], v[146:147], v[74:75]
    v_pk_fma_f32 v[180:181], v[132:133], v[76:77], v[180:181]
    v_pk_fma_f32 v[182:183], v[134:135], v[78:79], v[182:183]
    v_pk_fma_f32 v[184:185], v[136:137], v[80:81], v[184:185]
    v_pk_fma_f32 v[186:187], v[138:139], v[82:83], v[186:187]
    v_pk_fma_f32 v[180:181], v[124:125], v[84:85], v[180:181]
    v_pk_fma_f32 v[182:183], v[126:127], v[86:87], v[182:183]
    v_pk_fma_f32 v[184:185], v[128:129], v[88:89], v[184:185]
    v_pk_fma_f32 v[186:187], v[130:131], v[90:91], v[186:187]
    v_pk_fma_f32 v[180:181], v[116:117], v[92:93], v[180:181]
    v_pk_fma_f32 v[182:183], v[118:119], v[94:95], v[182:183]
    v_pk_fma_f32 v[184:185], v[120:121], v[96:97], v[184:185]
    v_pk_fma_f32 v[186:187], v[122:123], v[98:99], v[186:187]
    s_waitcnt vmcnt(4)
    v_lshlrev_b32 v148, 16, v32
    v_and_b32 v149, s90, v32
    v_lshlrev_b32 v150, 16, v33
    v_and_b32 v151, s90, v33
    v_lshlrev_b32 v152, 16, v34
    v_and_b32 v153, s90, v34
    v_lshlrev_b32 v154, 16, v35
    v_and_b32 v155, s90, v35
    v_pk_mul_f32 v[188:189], v[148:149], v[68:69]
    v_pk_mul_f32 v[190:191], v[150:151], v[70:71]
    v_pk_mul_f32 v[192:193], v[152:153], v[72:73]
    v_pk_mul_f32 v[194:195], v[154:155], v[74:75]
    v_pk_fma_f32 v[188:189], v[140:141], v[76:77], v[188:189]
    v_pk_fma_f32 v[190:191], v[142:143], v[78:79], v[190:191]
    v_pk_fma_f32 v[192:193], v[144:145], v[80:81], v[192:193]
    v_pk_fma_f32 v[194:195], v[146:147], v[82:83], v[194:195]
    v_pk_fma_f32 v[188:189], v[132:133], v[84:85], v[188:189]
    v_pk_fma_f32 v[190:191], v[134:135], v[86:87], v[190:191]
    v_pk_fma_f32 v[192:193], v[136:137], v[88:89], v[192:193]
    v_pk_fma_f32 v[194:195], v[138:139], v[90:91], v[194:195]
    v_pk_fma_f32 v[188:189], v[124:125], v[92:93], v[188:189]
    v_pk_fma_f32 v[190:191], v[126:127], v[94:95], v[190:191]
    v_pk_fma_f32 v[192:193], v[128:129], v[96:97], v[192:193]
    v_pk_fma_f32 v[194:195], v[130:131], v[98:99], v[194:195]
    s_waitcnt vmcnt(3)
    v_lshlrev_b32 v8, 16, v36
    v_and_b32 v9, s90, v36
    v_lshlrev_b32 v10, 16, v37
    v_and_b32 v11, s90, v37
    v_lshlrev_b32 v12, 16, v38
    v_and_b32 v13, s90, v38
    v_lshlrev_b32 v14, 16, v39
    v_and_b32 v15, s90, v39
    v_pk_mul_f32 v[164:165], v[164:165], v[8:9]
    v_pk_mul_f32 v[166:167], v[166:167], v[10:11]
    v_pk_mul_f32 v[168:169], v[168:169], v[12:13]
    v_pk_mul_f32 v[170:171], v[170:171], v[14:15]
    s_waitcnt vmcnt(2)
    v_lshlrev_b32 v8, 16, v40
    v_and_b32 v9, s90, v40
    v_lshlrev_b32 v10, 16, v41
    v_and_b32 v11, s90, v41
    v_lshlrev_b32 v12, 16, v42
    v_and_b32 v13, s90, v42
    v_lshlrev_b32 v14, 16, v43
    v_and_b32 v15, s90, v43
    v_pk_mul_f32 v[172:173], v[172:173], v[8:9]
    v_pk_mul_f32 v[174:175], v[174:175], v[10:11]
    v_pk_mul_f32 v[176:177], v[176:177], v[12:13]
    v_pk_mul_f32 v[178:179], v[178:179], v[14:15]
    s_waitcnt vmcnt(1)
    v_lshlrev_b32 v8, 16, v44
    v_and_b32 v9, s90, v44
    v_lshlrev_b32 v10, 16, v45
    v_and_b32 v11, s90, v45
    v_lshlrev_b32 v12, 16, v46
    v_and_b32 v13, s90, v46
    v_lshlrev_b32 v14, 16, v47
    v_and_b32 v15, s90, v47
    v_pk_mul_f32 v[180:181], v[180:181], v[8:9]
    v_pk_mul_f32 v[182:183], v[182:183], v[10:11]
    v_pk_mul_f32 v[184:185], v[184:185], v[12:13]
    v_pk_mul_f32 v[186:187], v[186:187], v[14:15]
    s_waitcnt vmcnt(0)
    buffer_load_dword v163, v162, s[44:47], 0 offen sc1
    v_lshlrev_b32 v8, 16, v48
    v_and_b32 v9, s90, v48
    v_lshlrev_b32 v10, 16, v49
    v_and_b32 v11, s90, v49
    v_lshlrev_b32 v12, 16, v50
    v_and_b32 v13, s90, v50
    v_lshlrev_b32 v14, 16, v51
    v_and_b32 v15, s90, v51
    v_pk_mul_f32 v[188:189], v[188:189], v[8:9]
    v_pk_mul_f32 v[190:191], v[190:191], v[10:11]
    v_pk_mul_f32 v[192:193], v[192:193], v[12:13]
    v_pk_mul_f32 v[194:195], v[194:195], v[14:15]
    v_cvt_pk_bf16_f32 v52, v192, v184
    v_cvt_pk_bf16_f32 v53, v176, v168
    v_cvt_pk_bf16_f32 v54, v188, v180
    v_cvt_pk_bf16_f32 v55, v172, v164
    v_cvt_pk_bf16_f32 v56, v193, v185
    v_cvt_pk_bf16_f32 v57, v177, v169
    v_cvt_pk_bf16_f32 v58, v189, v181
    v_cvt_pk_bf16_f32 v59, v173, v165
    v_cvt_pk_bf16_f32 v60, v194, v186
    v_cvt_pk_bf16_f32 v61, v178, v170
    v_cvt_pk_bf16_f32 v62, v190, v182
    v_cvt_pk_bf16_f32 v63, v174, v166
    v_cvt_pk_bf16_f32 v64, v195, v187
    v_cvt_pk_bf16_f32 v65, v179, v171
    v_cvt_pk_bf16_f32 v66, v191, v183
    v_cvt_pk_bf16_f32 v67, v175, v167
    v_permlane16_swap_b32 v54, v52
    v_permlane16_swap_b32 v55, v53
    buffer_store_dwordx4 v[52:55], v160, s[48:51], 0 offen offset:0 sc1
    v_permlane16_swap_b32 v58, v56
    v_permlane16_swap_b32 v59, v57
    buffer_store_dwordx4 v[56:59], v160, s[48:51], 0 offen offset:64 sc1
    v_permlane16_swap_b32 v62, v60
    v_permlane16_swap_b32 v63, v61
    buffer_store_dwordx4 v[60:63], v160, s[48:51], 0 offen offset:128 sc1
    s_nop 0
    v_permlane16_swap_b32 v66, v64
    v_permlane16_swap_b32 v67, v65
    buffer_store_dwordx4 v[64:67], v160, s[48:51], 0 offen offset:192 sc1
    s_waitcnt vmcnt(4)
L_nonce:
    v_readfirstlane_b32 s31, v163
    s_nop 0
    s_cmp_lg_u32 s31, 0
    s_cbranch_scc1 L_nonce_ok
    s_add_u32 s3, s3, 1
    s_cmp_gt_u32 s3, 200000
    s_cbranch_scc1 L_nonce_ok
    buffer_load_dword v163, v162, s[44:47], 0 offen sc1
    s_waitcnt vmcnt(0)
    s_branch L_nonce
L_nonce_ok:
    v_mov_b32 v163, s31
    s_cmp_eq_u32 s77, 0
    s_cbranch_scc0 L_p0hi
    s_getpc_b64 s[78:79]
L_pc1:
    s_lshl_b32 s77, s30, 13
    s_add_u32 s77, s77, L_p0hi-L_pc1
    v_lshl_add_u32 v164, v2, 7, s77
    v_min_u32 v164, L_g1epi-L_pc1, v164
    global_load_dword v165, v164, s[78:79]
    s_waitcnt vmcnt(1)
    s_mov_b64 exec, 1
    buffer_store_dword v163, v162, s[92:95], s87 offen sc1
    s_mov_b64 exec, -1
    s_add_u32 s68, s12, s99
    s_addc_u32 s69, s13, 0
    s_mov_b32 s70, 0x1000
    s_mov_b32 s71, 0x20000
    buffer_load_dwordx4 v[200:203], v220, s[68:71], 0 offen offset:0
    buffer_load_dword v216, v220, s[68:71], 0 offen offset:16
    buffer_load_dwordx4 v[204:207], v220, s[68:71], 0 offen offset:1024
    buffer_load_dword v217, v220, s[68:71], 0 offen offset:1040
    buffer_load_dwordx4 v[208:211], v220, s[68:71], 0 offen offset:2048
    buffer_load_dword v218, v220, s[68:71], 0 offen offset:2064
    buffer_load_dwordx4 v[212:215], v220, s[68:71], 0 offen offset:3072
    buffer_load_dword v219, v220, s[68:71], 0 offen offset:3088
    s_and_b32 s76, s2, 1
    s_lshr_b32 s56, s2, 3
    s_bfe_u32 s74, s2, 0x10001
    s_lshl_b32 s74, s74, 3
    s_and_b32 s57, s56, 7
    s_add_u32 s74, s74, s57
    s_bfe_u32 s75, s2, 0x10002
    s_lshl_b32 s75, s75, 2
    s_lshr_b32 s57, s56, 3
    s_add_u32 s75, s75, s57
    v_lshrrev_b32 v252, 2, v2
    v_lshlrev_b32 v253, 11, v252
    v_lshrrev_b32 v254, 3, v2
    v_xor_b32 v254, v254, v2
    v_and_b32 v254, 2, v254
    v_and_or_b32 v254, v2, 1, v254
    v_lshl_add_u32 v248, v254, 4, v253
    v_add_u32 v249, 31744, v248
    v_add_u32 v250, 63488, v248
    v_add_u32 v251, 95232, v248
    s_mul_i32 s56, s76, 3670016
    s_lshl_b32 s57, s75, 8
    s_add_u32 s56, s56, s57
    s_lshl_b32 s57, s30, 6
    s_add_u32 s56, s56, s57
    s_add_u32 s68, s22, s56
    s_addc_u32 s69, s23, 0
    s_mov_b32 s71, 0x20000
    s_sub_u32 s70, 7340032, s56
    s_mov_b32 s72, 0
    v_lshlrev_b32 v252, 6, v252
    v_bfe_u32 v253, v2, 4, 1
    v_lshl_add_u32 v252, v253, 5, v252
    v_and_b32 v253, 3, v2
    v_lshl_add_u32 v252, v253, 3, v252
    s_lshl_b32 s73, s30, 13
    s_add_u32 s73, s73, 32768
    v_add_u32 v253, s73, v252
    v_xor_b32 v254, 32, v253
    s_and_b32 s56, s81, 1
    s_lshl_b32 s56, s56, 1
    s_movk_i32 s57, 4682
    s_movk_i32 s58, 7168
    v_mov_b32 v76, 0x80000000
    v_subrev_u32 v77, 8, v2
    v_cmp_gt_u32 vcc, 56, v2
    v_mul_u32_u24 v80, s57, v2
    v_lshrrev_b32 v80, 16, v80
    v_mul_u32_u24 v81, 14, v80
    v_sub_u32 v81, v2, v81
    v_add_u32 v81, s56, v81
    v_subrev_u32 v82, 14, v81
    v_min_u32 v81, v81, v82
    v_mul_u32_u24 v80, s58, v80
    v_lshl_add_u32 v80, v81, 4, v80
    v_cndmask_b32 v78, v76, v80, vcc
    v_cmp_gt_u32 vcc, 56, v77
    v_mul_u32_u24 v80, s57, v77
    v_lshrrev_b32 v80, 16, v80
    v_mul_u32_u24 v81, 14, v80
    v_sub_u32 v81, v77, v81
    v_add_u32 v81, s56, v81
    v_subrev_u32 v82, 14, v81
    v_min_u32 v81, v81, v82
    v_mul_u32_u24 v80, s58, v80
    v_lshl_add_u32 v80, v81, 4, v80
    v_cndmask_b32 v79, v76, v80, vcc
    v_mov_b32 v240, v78
    v_add_u32 v241, 27648, v78
    v_add_u32 v242, 55296, v79
    v_add_u32 v243, 82944, v79
    v_add_u32 v244, 114688, v78
    v_add_u32 v245, 142336, v78
    v_add_u32 v246, 169984, v79
    v_add_u32 v247, 197632, v79
    s_and_b32 s56, s30, 1
    s_lshr_b32 s57, s30, 1
    s_mul_i32 s97, s56, 229376
    s_mov_b32 s100, 458752
    s_lshl_b32 s98, s57, 14
    s_lshl_b32 s56, s56, 13
    s_add_u32 s98, s98, s56
    s_mul_i32 s56, s81, 224
    s_cmp_eq_u32 s57, 0
    s_cselect_b32 s52, s18, s20
    s_cselect_b32 s53, s19, s21
    s_add_u32 s52, s52, s56
    s_addc_u32 s53, s53, 0
    s_mov_b32 s55, 0x20000
    s_sub_u32 s54, 7340032, s56
    v_mov_b32 v196, 0
    v_mov_b32 v197, 0
    v_lshlrev_b32 v198, 3, v2
    v_add_u32 v198, s88, v198
    ds_write_b64 v198, v[196:197] offset:4096
    v_min_u32 v199, 7, v2
    v_lshlrev_b32 v199, 2, v199
    v_add_u32 v199, s88, v199
    ds_write_b32 v199, v196 offset:4608
    v_add_u32 v198, s88, v220
    s_waitcnt vmcnt(6)
    v_readfirstlane_b32 s58, v200
    ds_write_b128 v198, v[200:203] offset:4640
    v_alignbit_b32 v224, v201, v200, 16
    v_alignbit_b32 v225, v202, v201, 16
    v_alignbit_b32 v226, v203, v202, 16
    v_alignbit_b32 v227, v216, v203, 16
    ds_write_b128 v198, v[224:227] offset:8800
    s_waitcnt vmcnt(4)
    ds_write_b128 v198, v[204:207] offset:5664
    v_alignbit_b32 v228, v205, v204, 16
    v_alignbit_b32 v229, v206, v205, 16
    v_alignbit_b32 v230, v207, v206, 16
    v_alignbit_b32 v231, v217, v207, 16
    ds_write_b128 v198, v[228:231] offset:9824
    s_waitcnt vmcnt(2)
    ds_write_b128 v198, v[208:211] offset:6688
    v_alignbit_b32 v232, v209, v208, 16
    v_alignbit_b32 v233, v210, v209, 16
    v_alignbit_b32 v234, v211, v210, 16
    v_alignbit_b32 v235, v218, v211, 16
    ds_write_b128 v198, v[232:235] offset:10848
    s_waitcnt vmcnt(0)
    ds_write_b128 v198, v[212:215] offset:7712
    v_alignbit_b32 v236, v213, v212, 16
    v_alignbit_b32 v237, v214, v213, 16
    v_alignbit_b32 v238, v215, v214, 16
    v_alignbit_b32 v239, v219, v215, 16
    ds_write_b128 v198, v[236:239] offset:11872
    s_lshl_b32 s58, s58, 16
    v_cmp_le_u32 vcc, 7, v2
    v_mov_b32 v197, s58
    s_nop 0
    v_cndmask_b32 v197, v196, v197, vcc
    ds_write_b32 v199, v197 offset:8768
    s_branch L_p0j
L_p0hi:
    s_waitcnt vmcnt(0)
    s_mov_b64 exec, 1
    buffer_store_dword v163, v162, s[92:95], s87 offen sc1
    s_mov_b64 exec, -1
L_p0j:
    s_and_b32 s82, s2, 7
    s_lshr_b32 s83, s2, 3
    s_lshl_b32 s84, s83, 2
    s_add_u32 s84, s84, s30
    s_mov_b32 s85, s101
    s_lshl_b32 s86, s82, 5
    s_add_u32 s86, s86, s83
    s_lshr_b32 s57, s85, 1
    s_lshl_b32 s57, s57, 2
    s_load_dword s89, s[14:15], s57
    v_lshlrev_b32 v4, 4, v2
    v_lshrrev_b32 v3, 2, v2
    v_sub_u32 v3, 15, v3
    v_lshlrev_b32 v3, 13, v3
    v_and_b32 v5, 3, v2
    v_lshl_add_u32 v3, v5, 4, v3
    s_lshl_b32 s56, s84, 6
    v_add_u32 v3, s56, v3
    v_lshlrev_b32 v34, 5, v2
    v_and_b32 v5, 15, v2
    v_lshrrev_b32 v6, 4, v2
    v_add_u32 v31, 1, v5
    v_and_b32 v32, 1, v31
    v_sub_u32 v31, v31, v32
    v_lshl_add_u32 v31, v6, 3, v31
    v_lshlrev_b32 v31, 1, v31
    v_mul_u32_u24 v32, 4160, v32
    v_add3_u32 v31, v31, v32, s88
    v_add_u32 v36, 4608, v31
    v_add_u32 v37, 5632, v31
    v_add_u32 v38, 6656, v31
    v_add_u32 v39, 7680, v31
    v_lshlrev_b32 v32, 5, v5
    v_lshlrev_b32 v33, 4, v6
    v_sub_u32 v33, v33, v32
    v_add_u32 v33, s88, v33
    v_add_u32 v40, 480, v33
    v_add_u32 v7, s88, v4
    v_mov_b32 v92, 0
    v_mov_b32 v93, 0
    v_mov_b32 v94, 0
    v_mov_b32 v95, 0
    s_nop 1
    v_mfma_f32_32x32x16_bf16 v[44:59], v[92:95], v[92:95], 0
    v_mfma_f32_32x32x16_bf16 v[60:75], v[92:95], v[92:95], 0
    s_waitcnt lgkmcnt(0)
    s_bitcmp1_b32 s85, 0
    s_cselect_b32 s56, 0, 16
    s_lshl_b32 s89, s89, s56
    s_and_b32 s89, s89, 0xffff0000
    s_lshl_b32 s99, s82, 12
    ds_read2_b32 a[0:1], v36 offset0:0 offset1:1
    ds_read2_b32 a[2:3], v36 offset0:2 offset1:3
    ds_read2_b32 a[4:5], v36 offset0:128 offset1:129
    ds_read2_b32 a[6:7], v36 offset0:130 offset1:131
    ds_read2_b32 a[8:9], v37 offset0:0 offset1:1
    ds_read2_b32 a[10:11], v37 offset0:2 offset1:3
    ds_read2_b32 a[12:13], v37 offset0:128 offset1:129
    ds_read2_b32 a[14:15], v37 offset0:130 offset1:131
    ds_read2_b32 v[96:97], v38 offset0:0 offset1:1
    ds_read2_b32 v[98:99], v38 offset0:2 offset1:3
    ds_read2_b32 v[100:101], v38 offset0:128 offset1:129
    ds_read2_b32 v[102:103], v38 offset0:130 offset1:131
    ds_read2_b32 v[104:105], v39 offset0:0 offset1:1
    ds_read2_b32 v[106:107], v39 offset0:2 offset1:3
    ds_read2_b32 v[108:109], v39 offset0:128 offset1:129
    ds_read2_b32 v[110:111], v39 offset0:130 offset1:131
L_poll2:
    buffer_load_dword v35, v34, s[92:95], s99 offen sc1
    s_waitcnt vmcnt(0)
    v_cmp_ne_u32 vcc, s31, v35
    s_add_u32 s3, s3, 1
    s_cmp_gt_u32 s3, 200000
    s_cbranch_scc1 L_poll2x
    s_cbranch_vccz L_poll2x
    s_branch L_poll2
L_poll2x:
    s_lshl_b32 s101, s82, 19
    s_add_u32 s57, s101, 0x20000
    buffer_load_dwordx4 v[8:11], v3, s[48:51], s57 offen sc1
    s_add_u32 s57, s101, 0x0
    buffer_load_dwordx4 v[12:15], v3, s[48:51], s57 offen sc1
    s_mul_i32 s56, s2, 7168
    s_mul_i32 s57, s30, 1792
    s_add_u32 s56, s56, s57
    v_lshlrev_b32 v41, 7, v2
    s_add_u32 s40, s18, s56
    s_addc_u32 s41, s19, 0
    s_mov_b32 s42, 0x700
    s_mov_b32 s43, 0x20000
    s_add_u32 s32, s20, s56
    s_addc_u32 s33, s21, 0
    s_mov_b32 s34, 0x700
    s_mov_b32 s35, 0x20000
    s_mov_b32 s36, s4
    s_mov_b32 s37, s5
    s_mov_b32 s38, 0x400000
    s_mov_b32 s39, 0x20000
    s_add_u32 s99, s99, 2048
    s_waitcnt vmcnt(1)
    ds_write_b128 v7, v[8:11] offset:2048
    s_waitcnt vmcnt(0)
    ds_write_b128 v7, v[12:15] offset:3072
    s_waitcnt lgkmcnt(0)
    ds_read_b128 v[128:131], v40 offset:3584
    ds_read_b128 v[132:135], v40 offset:3072
    ds_read_b128 v[136:139], v40 offset:2560
    ds_read_b128 v[140:143], v40 offset:2048
    s_waitcnt lgkmcnt(3)
    v_mfma_f32_16x16x32_bf16 v[44:47], a[0:3], v[128:131], v[44:47]
    ds_read_b128 v[144:147], v40 offset:3648
    s_waitcnt lgkmcnt(3)
    v_mfma_f32_16x16x32_bf16 v[48:51], a[0:3], v[132:135], v[48:51]
    ds_read2_b32 a[16:17], v36 offset0:16 offset1:17
    s_waitcnt lgkmcnt(3)
    v_mfma_f32_16x16x32_bf16 v[52:55], a[0:3], v[136:139], v[52:55]
    ds_read2_b32 a[18:19], v36 offset0:18 offset1:19
    s_waitcnt lgkmcnt(3)
    v_mfma_f32_16x16x32_bf16 v[56:59], a[0:3], v[140:143], v[56:59]
    ds_read_b128 v[148:151], v40 offset:3136
    v_mfma_f32_16x16x32_bf16 v[48:51], a[4:7], v[128:131], v[48:51]
    ds_read2_b32 a[20:21], v36 offset0:144 offset1:145
    v_mfma_f32_16x16x32_bf16 v[52:55], a[4:7], v[132:135], v[52:55]
    ds_read2_b32 a[22:23], v36 offset0:146 offset1:147
    v_mfma_f32_16x16x32_bf16 v[56:59], a[4:7], v[136:139], v[56:59]
    ds_read_b128 v[152:155], v40 offset:2624
    v_mfma_f32_16x16x32_bf16 v[60:63], a[4:7], v[140:143], v[60:63]
    ds_read2_b32 a[24:25], v37 offset0:16 offset1:17
    v_mfma_f32_16x16x32_bf16 v[52:55], a[8:11], v[128:131], v[52:55]
    ds_read2_b32 a[26:27], v37 offset0:18 offset1:19
    v_mfma_f32_16x16x32_bf16 v[56:59], a[8:11], v[132:135], v[56:59]
    ds_read_b128 v[156:159], v40 offset:2112
    v_mfma_f32_16x16x32_bf16 v[60:63], a[8:11], v[136:139], v[60:63]
    ds_read2_b32 a[28:29], v37 offset0:144 offset1:145
    v_mfma_f32_16x16x32_bf16 v[64:67], a[8:11], v[140:143], v[64:67]
    ds_read2_b32 a[30:31], v37 offset0:146 offset1:147
    v_mfma_f32_16x16x32_bf16 v[56:59], a[12:15], v[128:131], v[56:59]
    ds_read2_b32 v[112:113], v38 offset0:16 offset1:17
    v_mfma_f32_16x16x32_bf16 v[60:63], a[12:15], v[132:135], v[60:63]
    ds_read2_b32 v[114:115], v38 offset0:18 offset1:19
    v_mfma_f32_16x16x32_bf16 v[64:67], a[12:15], v[136:139], v[64:67]
    ds_read2_b32 v[116:117], v38 offset0:144 offset1:145
    v_mfma_f32_16x16x32_bf16 v[68:71], a[12:15], v[140:143], v[68:71]
    ds_read2_b32 v[118:119], v38 offset0:146 offset1:147
    v_mfma_f32_16x16x32_bf16 v[60:63], v[96:99], v[128:131], v[60:63]
    ds_read2_b32 v[120:121], v39 offset0:16 offset1:17
    v_mfma_f32_16x16x32_bf16 v[64:67], v[96:99], v[132:135], v[64:67]
    ds_read2_b32 v[122:123], v39 offset0:18 offset1:19
    v_mfma_f32_16x16x32_bf16 v[68:71], v[96:99], v[136:139], v[68:71]
    ds_read2_b32 v[124:125], v39 offset0:144 offset1:145
    v_mfma_f32_16x16x32_bf16 v[72:75], v[96:99], v[140:143], v[72:75]
    ds_read2_b32 v[126:127], v39 offset0:146 offset1:147
    v_mfma_f32_16x16x32_bf16 v[64:67], v[100:103], v[128:131], v[64:67]
    v_mfma_f32_16x16x32_bf16 v[68:71], v[100:103], v[132:135], v[68:71]
    v_mfma_f32_16x16x32_bf16 v[72:75], v[100:103], v[136:139], v[72:75]
    v_mfma_f32_16x16x32_bf16 v[68:71], v[104:107], v[128:131], v[68:71]
    v_mfma_f32_16x16x32_bf16 v[72:75], v[104:107], v[132:135], v[72:75]
    v_mfma_f32_16x16x32_bf16 v[72:75], v[108:111], v[128:131], v[72:75]
    s_waitcnt lgkmcnt(15)
    v_mfma_f32_16x16x32_bf16 v[44:47], a[16:19], v[144:147], v[44:47]
    ds_read_b128 v[128:131], v40 offset:3712
    v_mfma_f32_16x16x32_bf16 v[48:51], a[16:19], v[148:151], v[48:51]
    ds_read2_b32 a[32:33], v36 offset0:32 offset1:33
    s_waitcnt lgkmcnt(15)
    v_mfma_f32_16x16x32_bf16 v[52:55], a[16:19], v[152:155], v[52:55]
    ds_read2_b32 a[34:35], v36 offset0:34 offset1:35
    s_waitcnt lgkmcnt(13)
    v_mfma_f32_16x16x32_bf16 v[56:59], a[16:19], v[156:159], v[56:59]
    ds_read_b128 v[132:135], v40 offset:3200
    v_mfma_f32_16x16x32_bf16 v[48:51], a[20:23], v[144:147], v[48:51]
    ds_read2_b32 a[36:37], v36 offset0:160 offset1:161
    v_mfma_f32_16x16x32_bf16 v[52:55], a[20:23], v[148:151], v[52:55]
    ds_read2_b32 a[38:39], v36 offset0:162 offset1:163
    v_mfma_f32_16x16x32_bf16 v[56:59], a[20:23], v[152:155], v[56:59]
    ds_read_b128 v[136:139], v40 offset:2688
    v_mfma_f32_16x16x32_bf16 v[60:63], a[20:23], v[156:159], v[60:63]
    ds_read2_b32 a[40:41], v37 offset0:32 offset1:33
    v_mfma_f32_16x16x32_bf16 v[52:55], a[24:27], v[144:147], v[52:55]
    ds_read2_b32 a[42:43], v37 offset0:34 offset1:35
    v_mfma_f32_16x16x32_bf16 v[56:59], a[24:27], v[148:151], v[56:59]
    ds_read_b128 v[140:143], v40 offset:2176
    v_mfma_f32_16x16x32_bf16 v[60:63], a[24:27], v[152:155], v[60:63]
    ds_read2_b32 a[44:45], v37 offset0:160 offset1:161
    v_mfma_f32_16x16x32_bf16 v[64:67], a[24:27], v[156:159], v[64:67]
    ds_read2_b32 a[46:47], v37 offset0:162 offset1:163
    s_waitcnt lgkmcnt(15)
    v_mfma_f32_16x16x32_bf16 v[56:59], a[28:31], v[144:147], v[56:59]
    ds_read2_b32 v[96:97], v38 offset0:32 offset1:33
    buffer_load_dword v35, v34, s[92:95], s99 offen sc1
    v_mfma_f32_16x16x32_bf16 v[60:63], a[28:31], v[148:151], v[60:63]
    ds_read2_b32 v[98:99], v38 offset0:34 offset1:35
    v_mfma_f32_16x16x32_bf16 v[64:67], a[28:31], v[152:155], v[64:67]
    ds_read2_b32 v[100:101], v38 offset0:160 offset1:161
    v_mfma_f32_16x16x32_bf16 v[68:71], a[28:31], v[156:159], v[68:71]
    ds_read2_b32 v[102:103], v38 offset0:162 offset1:163
    v_mfma_f32_16x16x32_bf16 v[60:63], v[112:115], v[144:147], v[60:63]
    ds_read2_b32 v[104:105], v39 offset0:32 offset1:33
    v_mfma_f32_16x16x32_bf16 v[64:67], v[112:115], v[148:151], v[64:67]
    ds_read2_b32 v[106:107], v39 offset0:34 offset1:35
    v_mfma_f32_16x16x32_bf16 v[68:71], v[112:115], v[152:155], v[68:71]
    ds_read2_b32 v[108:109], v39 offset0:160 offset1:161
    v_mfma_f32_16x16x32_bf16 v[72:75], v[112:115], v[156:159], v[72:75]
    ds_read2_b32 v[110:111], v39 offset0:162 offset1:163
    v_mfma_f32_16x16x32_bf16 v[64:67], v[116:119], v[144:147], v[64:67]
    v_mfma_f32_16x16x32_bf16 v[68:71], v[116:119], v[148:151], v[68:71]
    v_mfma_f32_16x16x32_bf16 v[72:75], v[116:119], v[152:155], v[72:75]
    s_waitcnt lgkmcnt(15)
    v_mfma_f32_16x16x32_bf16 v[68:71], v[120:123], v[144:147], v[68:71]
    v_mfma_f32_16x16x32_bf16 v[72:75], v[120:123], v[148:151], v[72:75]
    v_mfma_f32_16x16x32_bf16 v[72:75], v[124:127], v[144:147], v[72:75]
    v_mfma_f32_16x16x32_bf16 v[44:47], a[32:35], v[128:131], v[44:47]
    ds_read_b128 v[144:147], v40 offset:3776
    v_mfma_f32_16x16x32_bf16 v[48:51], a[32:35], v[132:135], v[48:51]
    ds_read2_b32 a[48:49], v36 offset0:48 offset1:49
    s_waitcnt lgkmcnt(15)
    v_mfma_f32_16x16x32_bf16 v[52:55], a[32:35], v[136:139], v[52:55]
    ds_read2_b32 a[50:51], v36 offset0:50 offset1:51
    s_waitcnt lgkmcnt(13)
    v_mfma_f32_16x16x32_bf16 v[56:59], a[32:35], v[140:143], v[56:59]
    ds_read_b128 v[148:151], v40 offset:3264
    v_mfma_f32_16x16x32_bf16 v[48:51], a[36:39], v[128:131], v[48:51]
    ds_read2_b32 a[52:53], v36 offset0:176 offset1:177
    v_mfma_f32_16x16x32_bf16 v[52:55], a[36:39], v[132:135], v[52:55]
    ds_read2_b32 a[54:55], v36 offset0:178 offset1:179
    v_mfma_f32_16x16x32_bf16 v[56:59], a[36:39], v[136:139], v[56:59]
    ds_read_b128 v[152:155], v40 offset:2752
    v_mfma_f32_16x16x32_bf16 v[60:63], a[36:39], v[140:143], v[60:63]
    ds_read2_b32 a[56:57], v37 offset0:48 offset1:49
    v_mfma_f32_16x16x32_bf16 v[52:55], a[40:43], v[128:131], v[52:55]
    ds_read2_b32 a[58:59], v37 offset0:50 offset1:51
    v_mfma_f32_16x16x32_bf16 v[56:59], a[40:43], v[132:135], v[56:59]
    ds_read_b128 v[156:159], v40 offset:2240
    v_mfma_f32_16x16x32_bf16 v[60:63], a[40:43], v[136:139], v[60:63]
    ds_read2_b32 a[60:61], v37 offset0:176 offset1:177
    v_mfma_f32_16x16x32_bf16 v[64:67], a[40:43], v[140:143], v[64:67]
    ds_read2_b32 a[62:63], v37 offset0:178 offset1:179
    s_waitcnt lgkmcnt(15)
    v_mfma_f32_16x16x32_bf16 v[56:59], a[44:47], v[128:131], v[56:59]
    ds_read2_b32 v[112:113], v38 offset0:48 offset1:49
    v_mfma_f32_16x16x32_bf16 v[60:63], a[44:47], v[132:135], v[60:63]
    ds_read2_b32 v[114:115], v38 offset0:50 offset1:51
    v_mfma_f32_16x16x32_bf16 v[64:67], a[44:47], v[136:139], v[64:67]
    ds_read2_b32 v[116:117], v38 offset0:176 offset1:177
    v_mfma_f32_16x16x32_bf16 v[68:71], a[44:47], v[140:143], v[68:71]
    ds_read2_b32 v[118:119], v38 offset0:178 offset1:179
    v_mfma_f32_16x16x32_bf16 v[60:63], v[96:99], v[128:131], v[60:63]
    ds_read2_b32 v[120:121], v39 offset0:48 offset1:49
    v_mfma_f32_16x16x32_bf16 v[64:67], v[96:99], v[132:135], v[64:67]
    ds_read2_b32 v[122:123], v39 offset0:50 offset1:51
    v_mfma_f32_16x16x32_bf16 v[68:71], v[96:99], v[136:139], v[68:71]
    ds_read2_b32 v[124:125], v39 offset0:176 offset1:177
    v_mfma_f32_16x16x32_bf16 v[72:75], v[96:99], v[140:143], v[72:75]
    ds_read2_b32 v[126:127], v39 offset0:178 offset1:179
    v_mfma_f32_16x16x32_bf16 v[64:67], v[100:103], v[128:131], v[64:67]
    v_mfma_f32_16x16x32_bf16 v[68:71], v[100:103], v[132:135], v[68:71]
    v_mfma_f32_16x16x32_bf16 v[72:75], v[100:103], v[136:139], v[72:75]
    s_waitcnt lgkmcnt(15)
    v_mfma_f32_16x16x32_bf16 v[68:71], v[104:107], v[128:131], v[68:71]
    v_mfma_f32_16x16x32_bf16 v[72:75], v[104:107], v[132:135], v[72:75]
    v_mfma_f32_16x16x32_bf16 v[72:75], v[108:111], v[128:131], v[72:75]
    v_mfma_f32_16x16x32_bf16 v[44:47], a[48:51], v[144:147], v[44:47]
    ds_read_b128 v[128:131], v40 offset:3840
    v_mfma_f32_16x16x32_bf16 v[48:51], a[48:51], v[148:151], v[48:51]
    ds_read2_b32 a[64:65], v36 offset0:64 offset1:65
    s_waitcnt lgkmcnt(15)
    v_mfma_f32_16x16x32_bf16 v[52:55], a[48:51], v[152:155], v[52:55]
    ds_read2_b32 a[66:67], v36 offset0:66 offset1:67
    s_waitcnt lgkmcnt(13)
    v_mfma_f32_16x16x32_bf16 v[56:59], a[48:51], v[156:159], v[56:59]
    ds_read_b128 v[132:135], v40 offset:3328
    v_mfma_f32_16x16x32_bf16 v[48:51], a[52:55], v[144:147], v[48:51]
    ds_read2_b32 a[68:69], v36 offset0:192 offset1:193
    v_mfma_f32_16x16x32_bf16 v[52:55], a[52:55], v[148:151], v[52:55]
    ds_read2_b32 a[70:71], v36 offset0:194 offset1:195
    v_mfma_f32_16x16x32_bf16 v[56:59], a[52:55], v[152:155], v[56:59]
    ds_read_b128 v[136:139], v40 offset:2816
    v_mfma_f32_16x16x32_bf16 v[60:63], a[52:55], v[156:159], v[60:63]
    ds_read2_b32 a[72:73], v37 offset0:64 offset1:65
    v_mfma_f32_16x16x32_bf16 v[52:55], a[56:59], v[144:147], v[52:55]
    ds_read2_b32 a[74:75], v37 offset0:66 offset1:67
    v_mfma_f32_16x16x32_bf16 v[56:59], a[56:59], v[148:151], v[56:59]
    ds_read_b128 v[140:143], v40 offset:2304
    v_mfma_f32_16x16x32_bf16 v[60:63], a[56:59], v[152:155], v[60:63]
    ds_read2_b32 a[76:77], v37 offset0:192 offset1:193
    v_mfma_f32_16x16x32_bf16 v[64:67], a[56:59], v[156:159], v[64:67]
    ds_read2_b32 a[78:79], v37 offset0:194 offset1:195
    s_waitcnt lgkmcnt(15)
    v_mfma_f32_16x16x32_bf16 v[56:59], a[60:63], v[144:147], v[56:59]
    ds_read2_b32 v[96:97], v38 offset0:64 offset1:65
    v_mfma_f32_16x16x32_bf16 v[60:63], a[60:63], v[148:151], v[60:63]
    ds_read2_b32 v[98:99], v38 offset0:66 offset1:67
    v_mfma_f32_16x16x32_bf16 v[64:67], a[60:63], v[152:155], v[64:67]
    ds_read2_b32 v[100:101], v38 offset0:192 offset1:193
    v_mfma_f32_16x16x32_bf16 v[68:71], a[60:63], v[156:159], v[68:71]
    ds_read2_b32 v[102:103], v38 offset0:194 offset1:195
    v_mfma_f32_16x16x32_bf16 v[60:63], v[112:115], v[144:147], v[60:63]
    ds_read2_b32 v[104:105], v39 offset0:64 offset1:65
    v_mfma_f32_16x16x32_bf16 v[64:67], v[112:115], v[148:151], v[64:67]
    ds_read2_b32 v[106:107], v39 offset0:66 offset1:67
    v_mfma_f32_16x16x32_bf16 v[68:71], v[112:115], v[152:155], v[68:71]
    ds_read2_b32 v[108:109], v39 offset0:192 offset1:193
    v_mfma_f32_16x16x32_bf16 v[72:75], v[112:115], v[156:159], v[72:75]
    ds_read2_b32 v[110:111], v39 offset0:194 offset1:195
    v_mfma_f32_16x16x32_bf16 v[64:67], v[116:119], v[144:147], v[64:67]
    v_mfma_f32_16x16x32_bf16 v[68:71], v[116:119], v[148:151], v[68:71]
    v_mfma_f32_16x16x32_bf16 v[72:75], v[116:119], v[152:155], v[72:75]
    s_waitcnt lgkmcnt(15)
    v_mfma_f32_16x16x32_bf16 v[68:71], v[120:123], v[144:147], v[68:71]
    v_mfma_f32_16x16x32_bf16 v[72:75], v[120:123], v[148:151], v[72:75]
    v_mfma_f32_16x16x32_bf16 v[72:75], v[124:127], v[144:147], v[72:75]
    s_waitcnt vmcnt(0)
    v_cmp_ne_u32 vcc, s31, v35
    s_cbranch_vccz L_f0b
L_poll3:
    buffer_load_dword v35, v34, s[92:95], s99 offen sc1
    s_waitcnt vmcnt(0)
    v_cmp_ne_u32 vcc, s31, v35
    s_add_u32 s3, s3, 1
    s_cmp_gt_u32 s3, 200000
    s_cbranch_scc1 L_poll3x
    s_cbranch_vccz L_poll3x
    s_branch L_poll3
L_poll3x:
L_f0b:
    s_add_u32 s57, s101, 0x60000
    buffer_load_dwordx4 v[8:11], v3, s[48:51], s57 offen sc1
    s_add_u32 s57, s101, 0x40000
    buffer_load_dwordx4 v[12:15], v3, s[48:51], s57 offen sc1
    v_mfma_f32_16x16x32_bf16 v[44:47], a[64:67], v[128:131], v[44:47]
    ds_read_b128 v[144:147], v40 offset:3904
    v_mfma_f32_16x16x32_bf16 v[48:51], a[64:67], v[132:135], v[48:51]
    ds_read2_b32 a[80:81], v36 offset0:80 offset1:81
    s_waitcnt lgkmcnt(15)
    v_mfma_f32_16x16x32_bf16 v[52:55], a[64:67], v[136:139], v[52:55]
    ds_read2_b32 a[82:83], v36 offset0:82 offset1:83
    buffer_load_dwordx4 v[224:227], v4, s[36:39], s96 offen offset:0
    s_waitcnt lgkmcnt(13)
    v_mfma_f32_16x16x32_bf16 v[56:59], a[64:67], v[140:143], v[56:59]
    ds_read_b128 v[148:151], v40 offset:3392
    v_mfma_f32_16x16x32_bf16 v[48:51], a[68:71], v[128:131], v[48:51]
    ds_read2_b32 a[84:85], v36 offset0:208 offset1:209
    v_mfma_f32_16x16x32_bf16 v[52:55], a[68:71], v[132:135], v[52:55]
    ds_read2_b32 a[86:87], v36 offset0:210 offset1:211
    buffer_load_dwordx4 v[228:231], v4, s[36:39], s96 offen offset:1024
    v_mfma_f32_16x16x32_bf16 v[56:59], a[68:71], v[136:139], v[56:59]
    ds_read_b128 v[152:155], v40 offset:2880
    v_mfma_f32_16x16x32_bf16 v[60:63], a[68:71], v[140:143], v[60:63]
    ds_read2_b32 a[88:89], v37 offset0:80 offset1:81
    v_mfma_f32_16x16x32_bf16 v[52:55], a[72:75], v[128:131], v[52:55]
    ds_read2_b32 a[90:91], v37 offset0:82 offset1:83
    buffer_load_dwordx4 v[232:235], v4, s[36:39], s96 offen offset:2048
    v_mfma_f32_16x16x32_bf16 v[56:59], a[72:75], v[132:135], v[56:59]
    ds_read_b128 v[156:159], v40 offset:2368
    v_mfma_f32_16x16x32_bf16 v[60:63], a[72:75], v[136:139], v[60:63]
    ds_read2_b32 a[92:93], v37 offset0:208 offset1:209
    v_mfma_f32_16x16x32_bf16 v[64:67], a[72:75], v[140:143], v[64:67]
    ds_read2_b32 a[94:95], v37 offset0:210 offset1:211
    buffer_load_dwordx4 v[236:239], v4, s[36:39], s96 offen offset:3072
    s_waitcnt lgkmcnt(15)
    v_mfma_f32_16x16x32_bf16 v[56:59], a[76:79], v[128:131], v[56:59]
    ds_read2_b32 v[112:113], v38 offset0:80 offset1:81
    v_mfma_f32_16x16x32_bf16 v[60:63], a[76:79], v[132:135], v[60:63]
    ds_read2_b32 v[114:115], v38 offset0:82 offset1:83
    v_mfma_f32_16x16x32_bf16 v[64:67], a[76:79], v[136:139], v[64:67]
    ds_read2_b32 v[116:117], v38 offset0:208 offset1:209
    v_mfma_f32_16x16x32_bf16 v[68:71], a[76:79], v[140:143], v[68:71]
    ds_read2_b32 v[118:119], v38 offset0:210 offset1:211
    v_mfma_f32_16x16x32_bf16 v[60:63], v[96:99], v[128:131], v[60:63]
    ds_read2_b32 v[120:121], v39 offset0:80 offset1:81
    v_mfma_f32_16x16x32_bf16 v[64:67], v[96:99], v[132:135], v[64:67]
    ds_read2_b32 v[122:123], v39 offset0:82 offset1:83
    v_mfma_f32_16x16x32_bf16 v[68:71], v[96:99], v[136:139], v[68:71]
    ds_read2_b32 v[124:125], v39 offset0:208 offset1:209
    v_mfma_f32_16x16x32_bf16 v[72:75], v[96:99], v[140:143], v[72:75]
    ds_read2_b32 v[126:127], v39 offset0:210 offset1:211
    v_mfma_f32_16x16x32_bf16 v[64:67], v[100:103], v[128:131], v[64:67]
    v_mfma_f32_16x16x32_bf16 v[68:71], v[100:103], v[132:135], v[68:71]
    v_mfma_f32_16x16x32_bf16 v[72:75], v[100:103], v[136:139], v[72:75]
    s_waitcnt lgkmcnt(15)
    v_mfma_f32_16x16x32_bf16 v[68:71], v[104:107], v[128:131], v[68:71]
    v_mfma_f32_16x16x32_bf16 v[72:75], v[104:107], v[132:135], v[72:75]
    v_mfma_f32_16x16x32_bf16 v[72:75], v[108:111], v[128:131], v[72:75]
    v_mfma_f32_16x16x32_bf16 v[44:47], a[80:83], v[144:147], v[44:47]
    ds_read_b128 v[128:131], v40 offset:3968
    v_mfma_f32_16x16x32_bf16 v[48:51], a[80:83], v[148:151], v[48:51]
    ds_read2_b32 a[96:97], v36 offset0:96 offset1:97
    s_waitcnt lgkmcnt(15)
    v_mfma_f32_16x16x32_bf16 v[52:55], a[80:83], v[152:155], v[52:55]
    ds_read2_b32 a[98:99], v36 offset0:98 offset1:99
    s_waitcnt lgkmcnt(13)
    v_mfma_f32_16x16x32_bf16 v[56:59], a[80:83], v[156:159], v[56:59]
    ds_read_b128 v[132:135], v40 offset:3456
    v_mfma_f32_16x16x32_bf16 v[48:51], a[84:87], v[144:147], v[48:51]
    ds_read2_b32 a[100:101], v36 offset0:224 offset1:225
    v_mfma_f32_16x16x32_bf16 v[52:55], a[84:87], v[148:151], v[52:55]
    ds_read2_b32 a[102:103], v36 offset0:226 offset1:227
    v_mfma_f32_16x16x32_bf16 v[56:59], a[84:87], v[152:155], v[56:59]
    ds_read_b128 v[136:139], v40 offset:2944
    v_mfma_f32_16x16x32_bf16 v[60:63], a[84:87], v[156:159], v[60:63]
    ds_read2_b32 a[104:105], v37 offset0:96 offset1:97
    v_mfma_f32_16x16x32_bf16 v[52:55], a[88:91], v[144:147], v[52:55]
    ds_read2_b32 a[106:107], v37 offset0:98 offset1:99
    v_mfma_f32_16x16x32_bf16 v[56:59], a[88:91], v[148:151], v[56:59]
    ds_read_b128 v[140:143], v40 offset:2432
    v_mfma_f32_16x16x32_bf16 v[60:63], a[88:91], v[152:155], v[60:63]
    ds_read2_b32 a[108:109], v37 offset0:224 offset1:225
    v_mfma_f32_16x16x32_bf16 v[64:67], a[88:91], v[156:159], v[64:67]
    ds_read2_b32 a[110:111], v37 offset0:226 offset1:227
    s_waitcnt lgkmcnt(15)
    v_mfma_f32_16x16x32_bf16 v[56:59], a[92:95], v[144:147], v[56:59]
    ds_read2_b32 v[96:97], v38 offset0:96 offset1:97
    buffer_load_dword v42, v41, s[40:43], 0 offen
    v_mfma_f32_16x16x32_bf16 v[60:63], a[92:95], v[148:151], v[60:63]
    ds_read2_b32 v[98:99], v38 offset0:98 offset1:99
    v_mfma_f32_16x16x32_bf16 v[64:67], a[92:95], v[152:155], v[64:67]
    ds_read2_b32 v[100:101], v38 offset0:224 offset1:225
    v_mfma_f32_16x16x32_bf16 v[68:71], a[92:95], v[156:159], v[68:71]
    ds_read2_b32 v[102:103], v38 offset0:226 offset1:227
    v_mfma_f32_16x16x32_bf16 v[60:63], v[112:115], v[144:147], v[60:63]
    ds_read2_b32 v[104:105], v39 offset0:96 offset1:97
    v_mfma_f32_16x16x32_bf16 v[64:67], v[112:115], v[148:151], v[64:67]
    ds_read2_b32 v[106:107], v39 offset0:98 offset1:99
    v_mfma_f32_16x16x32_bf16 v[68:71], v[112:115], v[152:155], v[68:71]
    ds_read2_b32 v[108:109], v39 offset0:224 offset1:225
    v_mfma_f32_16x16x32_bf16 v[72:75], v[112:115], v[156:159], v[72:75]
    ds_read2_b32 v[110:111], v39 offset0:226 offset1:227
    v_mfma_f32_16x16x32_bf16 v[64:67], v[116:119], v[144:147], v[64:67]
    v_mfma_f32_16x16x32_bf16 v[68:71], v[116:119], v[148:151], v[68:71]
    v_mfma_f32_16x16x32_bf16 v[72:75], v[116:119], v[152:155], v[72:75]
    s_waitcnt lgkmcnt(15)
    v_mfma_f32_16x16x32_bf16 v[68:71], v[120:123], v[144:147], v[68:71]
    v_mfma_f32_16x16x32_bf16 v[72:75], v[120:123], v[148:151], v[72:75]
    v_mfma_f32_16x16x32_bf16 v[72:75], v[124:127], v[144:147], v[72:75]
    v_mfma_f32_16x16x32_bf16 v[44:47], a[96:99], v[128:131], v[44:47]
    ds_read_b128 v[144:147], v40 offset:4032
    v_mfma_f32_16x16x32_bf16 v[48:51], a[96:99], v[132:135], v[48:51]
    ds_read2_b32 a[112:113], v36 offset0:112 offset1:113
    s_waitcnt lgkmcnt(15)
    v_mfma_f32_16x16x32_bf16 v[52:55], a[96:99], v[136:139], v[52:55]
    ds_read2_b32 a[114:115], v36 offset0:114 offset1:115
    s_waitcnt lgkmcnt(13)
    v_mfma_f32_16x16x32_bf16 v[56:59], a[96:99], v[140:143], v[56:59]
    ds_read_b128 v[148:151], v40 offset:3520
    v_mfma_f32_16x16x32_bf16 v[48:51], a[100:103], v[128:131], v[48:51]
    ds_read2_b32 a[116:117], v36 offset0:240 offset1:241
    v_mfma_f32_16x16x32_bf16 v[52:55], a[100:103], v[132:135], v[52:55]
    ds_read2_b32 a[118:119], v36 offset0:242 offset1:243
    v_mfma_f32_16x16x32_bf16 v[56:59], a[100:103], v[136:139], v[56:59]
    ds_read_b128 v[152:155], v40 offset:3008
    v_mfma_f32_16x16x32_bf16 v[60:63], a[100:103], v[140:143], v[60:63]
    ds_read2_b32 a[120:121], v37 offset0:112 offset1:113
    v_mfma_f32_16x16x32_bf16 v[52:55], a[104:107], v[128:131], v[52:55]
    ds_read2_b32 a[122:123], v37 offset0:114 offset1:115
    v_mfma_f32_16x16x32_bf16 v[56:59], a[104:107], v[132:135], v[56:59]
    ds_read_b128 v[156:159], v40 offset:2496
    v_mfma_f32_16x16x32_bf16 v[60:63], a[104:107], v[136:139], v[60:63]
    ds_read2_b32 a[124:125], v37 offset0:240 offset1:241
    v_mfma_f32_16x16x32_bf16 v[64:67], a[104:107], v[140:143], v[64:67]
    ds_read2_b32 a[126:127], v37 offset0:242 offset1:243
    s_waitcnt lgkmcnt(15)
    v_mfma_f32_16x16x32_bf16 v[56:59], a[108:111], v[128:131], v[56:59]
    ds_read2_b32 v[112:113], v38 offset0:112 offset1:113
    v_mfma_f32_16x16x32_bf16 v[60:63], a[108:111], v[132:135], v[60:63]
    ds_read2_b32 v[114:115], v38 offset0:114 offset1:115
    v_mfma_f32_16x16x32_bf16 v[64:67], a[108:111], v[136:139], v[64:67]
    ds_read2_b32 v[116:117], v38 offset0:240 offset1:241
    v_mfma_f32_16x16x32_bf16 v[68:71], a[108:111], v[140:143], v[68:71]
    ds_read2_b32 v[118:119], v38 offset0:242 offset1:243
    v_mfma_f32_16x16x32_bf16 v[60:63], v[96:99], v[128:131], v[60:63]
    ds_read2_b32 v[120:121], v39 offset0:112 offset1:113
    v_mfma_f32_16x16x32_bf16 v[64:67], v[96:99], v[132:135], v[64:67]
    ds_read2_b32 v[122:123], v39 offset0:114 offset1:115
    v_mfma_f32_16x16x32_bf16 v[68:71], v[96:99], v[136:139], v[68:71]
    ds_read2_b32 v[124:125], v39 offset0:240 offset1:241
    v_mfma_f32_16x16x32_bf16 v[72:75], v[96:99], v[140:143], v[72:75]
    ds_read2_b32 v[126:127], v39 offset0:242 offset1:243
    v_mfma_f32_16x16x32_bf16 v[64:67], v[100:103], v[128:131], v[64:67]
    v_mfma_f32_16x16x32_bf16 v[68:71], v[100:103], v[132:135], v[68:71]
    v_mfma_f32_16x16x32_bf16 v[72:75], v[100:103], v[136:139], v[72:75]
    s_waitcnt lgkmcnt(15)
    v_mfma_f32_16x16x32_bf16 v[68:71], v[104:107], v[128:131], v[68:71]
    v_mfma_f32_16x16x32_bf16 v[72:75], v[104:107], v[132:135], v[72:75]
    v_mfma_f32_16x16x32_bf16 v[72:75], v[108:111], v[128:131], v[72:75]
    v_mfma_f32_16x16x32_bf16 v[44:47], a[112:115], v[144:147], v[44:47]
    v_mfma_f32_16x16x32_bf16 v[48:51], a[112:115], v[148:151], v[48:51]
    s_waitcnt lgkmcnt(13)
    v_mfma_f32_16x16x32_bf16 v[52:55], a[112:115], v[152:155], v[52:55]
    s_waitcnt lgkmcnt(10)
    v_mfma_f32_16x16x32_bf16 v[56:59], a[112:115], v[156:159], v[56:59]
    v_mfma_f32_16x16x32_bf16 v[48:51], a[116:119], v[144:147], v[48:51]
    v_mfma_f32_16x16x32_bf16 v[52:55], a[116:119], v[148:151], v[52:55]
    v_mfma_f32_16x16x32_bf16 v[56:59], a[116:119], v[152:155], v[56:59]
    v_mfma_f32_16x16x32_bf16 v[60:63], a[116:119], v[156:159], v[60:63]
    v_mfma_f32_16x16x32_bf16 v[52:55], a[120:123], v[144:147], v[52:55]
    v_mfma_f32_16x16x32_bf16 v[56:59], a[120:123], v[148:151], v[56:59]
    v_mfma_f32_16x16x32_bf16 v[60:63], a[120:123], v[152:155], v[60:63]
    s_waitcnt vmcnt(5)
    ds_write_b128 v7, v[8:11] offset:0
    v_mfma_f32_16x16x32_bf16 v[64:67], a[120:123], v[156:159], v[64:67]
    ds_write_b128 v7, v[12:15] offset:1024
    s_waitcnt lgkmcnt(10)
    v_mfma_f32_16x16x32_bf16 v[56:59], a[124:127], v[144:147], v[56:59]
    ds_read_b128 v[160:163], v40 offset:1536
    v_mfma_f32_16x16x32_bf16 v[60:63], a[124:127], v[148:151], v[60:63]
    ds_read_b128 v[164:167], v40 offset:1024
    v_mfma_f32_16x16x32_bf16 v[64:67], a[124:127], v[152:155], v[64:67]
    ds_read_b128 v[168:171], v40 offset:512
    v_mfma_f32_16x16x32_bf16 v[68:71], a[124:127], v[156:159], v[68:71]
    ds_read_b128 v[172:175], v40 offset:0
    s_waitcnt lgkmcnt(12)
    v_mfma_f32_16x16x32_bf16 v[60:63], v[112:115], v[144:147], v[60:63]
    ds_read_b128 v[176:179], v40 offset:1600
    v_mfma_f32_16x16x32_bf16 v[64:67], v[112:115], v[148:151], v[64:67]
    ds_read_b128 v[180:183], v40 offset:1088
    v_mfma_f32_16x16x32_bf16 v[68:71], v[112:115], v[152:155], v[68:71]
    ds_read_b128 v[184:187], v40 offset:576
    v_mfma_f32_16x16x32_bf16 v[72:75], v[112:115], v[156:159], v[72:75]
    ds_read_b128 v[188:191], v40 offset:64
    s_waitcnt lgkmcnt(14)
    v_mfma_f32_16x16x32_bf16 v[64:67], v[116:119], v[144:147], v[64:67]
    v_mfma_f32_16x16x32_bf16 v[68:71], v[116:119], v[148:151], v[68:71]
    v_mfma_f32_16x16x32_bf16 v[72:75], v[116:119], v[152:155], v[72:75]
    s_waitcnt lgkmcnt(12)
    v_mfma_f32_16x16x32_bf16 v[68:71], v[120:123], v[144:147], v[68:71]
    v_mfma_f32_16x16x32_bf16 v[72:75], v[120:123], v[148:151], v[72:75]
    s_waitcnt lgkmcnt(10)
    v_mfma_f32_16x16x32_bf16 v[72:75], v[124:127], v[144:147], v[72:75]
    s_waitcnt lgkmcnt(7)
    v_mfma_f32_16x16x32_bf16 v[60:63], a[0:3], v[160:163], v[60:63]
    ds_read_b128 v[192:195], v40 offset:1664
    v_mfma_f32_16x16x32_bf16 v[64:67], a[4:7], v[160:163], v[64:67]
    ds_read_b128 v[196:199], v40 offset:1152
    v_mfma_f32_16x16x32_bf16 v[68:71], a[8:11], v[160:163], v[68:71]
    ds_read_b128 v[200:203], v40 offset:640
    v_mfma_f32_16x16x32_bf16 v[72:75], a[12:15], v[160:163], v[72:75]
    ds_read_b128 v[204:207], v40 offset:128
    s_waitcnt lgkmcnt(10)
    v_mfma_f32_16x16x32_bf16 v[64:67], a[0:3], v[164:167], v[64:67]
    buffer_load_dword v42, v41, s[32:35], 0 offen
    v_mfma_f32_16x16x32_bf16 v[68:71], a[4:7], v[164:167], v[68:71]
    v_mfma_f32_16x16x32_bf16 v[72:75], a[8:11], v[164:167], v[72:75]
    s_waitcnt lgkmcnt(9)
    v_mfma_f32_16x16x32_bf16 v[68:71], a[0:3], v[168:171], v[68:71]
    v_mfma_f32_16x16x32_bf16 v[72:75], a[4:7], v[168:171], v[72:75]
    s_waitcnt lgkmcnt(8)
    v_mfma_f32_16x16x32_bf16 v[72:75], a[0:3], v[172:175], v[72:75]
    s_waitcnt lgkmcnt(7)
    v_mfma_f32_16x16x32_bf16 v[60:63], a[16:19], v[176:179], v[60:63]
    ds_read_b128 v[160:163], v40 offset:1728
    v_mfma_f32_16x16x32_bf16 v[64:67], a[20:23], v[176:179], v[64:67]
    ds_read_b128 v[164:167], v40 offset:1216
    v_mfma_f32_16x16x32_bf16 v[68:71], a[24:27], v[176:179], v[68:71]
    ds_read_b128 v[168:171], v40 offset:704
    v_mfma_f32_16x16x32_bf16 v[72:75], a[28:31], v[176:179], v[72:75]
    ds_read_b128 v[172:175], v40 offset:192
    s_waitcnt lgkmcnt(10)
    v_mfma_f32_16x16x32_bf16 v[64:67], a[16:19], v[180:183], v[64:67]
    v_mfma_f32_16x16x32_bf16 v[68:71], a[20:23], v[180:183], v[68:71]
    v_mfma_f32_16x16x32_bf16 v[72:75], a[24:27], v[180:183], v[72:75]
    s_waitcnt lgkmcnt(9)
    v_mfma_f32_16x16x32_bf16 v[68:71], a[16:19], v[184:187], v[68:71]
    v_mfma_f32_16x16x32_bf16 v[72:75], a[20:23], v[184:187], v[72:75]
    s_waitcnt lgkmcnt(8)
    v_mfma_f32_16x16x32_bf16 v[72:75], a[16:19], v[188:191], v[72:75]
    s_waitcnt lgkmcnt(7)
    v_mfma_f32_16x16x32_bf16 v[60:63], a[32:35], v[192:195], v[60:63]
    ds_read_b128 v[176:179], v40 offset:1792
    v_mfma_f32_16x16x32_bf16 v[64:67], a[36:39], v[192:195], v[64:67]
    ds_read_b128 v[180:183], v40 offset:1280
    v_mfma_f32_16x16x32_bf16 v[68:71], a[40:43], v[192:195], v[68:71]
    ds_read_b128 v[184:187], v40 offset:768
    v_mfma_f32_16x16x32_bf16 v[72:75], a[44:47], v[192:195], v[72:75]
    ds_read_b128 v[188:191], v40 offset:256
    s_waitcnt lgkmcnt(10)
    v_mfma_f32_16x16x32_bf16 v[64:67], a[32:35], v[196:199], v[64:67]
    v_mfma_f32_16x16x32_bf16 v[68:71], a[36:39], v[196:199], v[68:71]
    v_mfma_f32_16x16x32_bf16 v[72:75], a[40:43], v[196:199], v[72:75]
    s_waitcnt lgkmcnt(9)
    v_mfma_f32_16x16x32_bf16 v[68:71], a[32:35], v[200:203], v[68:71]
    v_mfma_f32_16x16x32_bf16 v[72:75], a[36:39], v[200:203], v[72:75]
    s_waitcnt lgkmcnt(8)
    v_mfma_f32_16x16x32_bf16 v[72:75], a[32:35], v[204:207], v[72:75]
    s_waitcnt lgkmcnt(7)
    v_mfma_f32_16x16x32_bf16 v[60:63], a[48:51], v[160:163], v[60:63]
    ds_read_b128 v[192:195], v40 offset:1856
    s_add_u32 m0, s73, 0
    v_mfma_f32_16x16x32_bf16 v[64:67], a[52:55], v[160:163], v[64:67]
    ds_read_b128 v[196:199], v40 offset:1344
    buffer_load_dwordx4 v248, s[68:71], s72 offen offset:0 lds
    v_mfma_f32_16x16x32_bf16 v[68:71], a[56:59], v[160:163], v[68:71]
    ds_read_b128 v[200:203], v40 offset:832
    buffer_load_dwordx4 v249, s[68:71], s72 offen offset:1024 lds
    v_mfma_f32_16x16x32_bf16 v[72:75], a[60:63], v[160:163], v[72:75]
    ds_read_b128 v[204:207], v40 offset:320
    s_waitcnt lgkmcnt(10)
    v_mfma_f32_16x16x32_bf16 v[64:67], a[48:51], v[164:167], v[64:67]
    v_mfma_f32_16x16x32_bf16 v[68:71], a[52:55], v[164:167], v[68:71]
    v_mfma_f32_16x16x32_bf16 v[72:75], a[56:59], v[164:167], v[72:75]
    s_waitcnt lgkmcnt(9)
    v_mfma_f32_16x16x32_bf16 v[68:71], a[48:51], v[168:171], v[68:71]
    v_mfma_f32_16x16x32_bf16 v[72:75], a[52:55], v[168:171], v[72:75]
    s_waitcnt lgkmcnt(8)
    v_mfma_f32_16x16x32_bf16 v[72:75], a[48:51], v[172:175], v[72:75]
    s_waitcnt lgkmcnt(7)
    v_mfma_f32_16x16x32_bf16 v[60:63], a[64:67], v[176:179], v[60:63]
    ds_read_b128 v[160:163], v40 offset:1920
    v_mfma_f32_16x16x32_bf16 v[64:67], a[68:71], v[176:179], v[64:67]
    ds_read_b128 v[164:167], v40 offset:1408
    buffer_load_dwordx4 v250, s[68:71], s72 offen offset:2048 lds
    v_mfma_f32_16x16x32_bf16 v[68:71], a[72:75], v[176:179], v[68:71]
    ds_read_b128 v[168:171], v40 offset:896
    v_mfma_f32_16x16x32_bf16 v[72:75], a[76:79], v[176:179], v[72:75]
    ds_read_b128 v[172:175], v40 offset:384
    buffer_load_dwordx4 v251, s[68:71], s72 offen offset:3072 lds
    s_add_u32 s72, s72, 131072
    s_waitcnt lgkmcnt(10)
    v_mfma_f32_16x16x32_bf16 v[64:67], a[64:67], v[180:183], v[64:67]
    v_mfma_f32_16x16x32_bf16 v[68:71], a[68:71], v[180:183], v[68:71]
    v_mfma_f32_16x16x32_bf16 v[72:75], a[72:75], v[180:183], v[72:75]
    s_waitcnt lgkmcnt(9)
    v_mfma_f32_16x16x32_bf16 v[68:71], a[64:67], v[184:187], v[68:71]
    v_mfma_f32_16x16x32_bf16 v[72:75], a[68:71], v[184:187], v[72:75]
    s_waitcnt lgkmcnt(8)
    v_mfma_f32_16x16x32_bf16 v[72:75], a[64:67], v[188:191], v[72:75]
    v_lshlrev_b32 v32, 5, v5
    v_lshl_add_u32 v32, v6, 3, v32
    v_sub_u32 v34, 504, v32
    v_add_u32 v34, s88, v34
    v_add_u32 v35, s88, v32
    s_waitcnt lgkmcnt(7)
    v_mfma_f32_16x16x32_bf16 v[60:63], a[80:83], v[192:195], v[60:63]
    ds_read_b128 v[176:179], v40 offset:1984
    s_add_u32 m0, s73, 4096
    v_mfma_f32_16x16x32_bf16 v[64:67], a[84:87], v[192:195], v[64:67]
    ds_read_b128 v[180:183], v40 offset:1472
    buffer_load_dwordx4 v248, s[68:71], s72 offen offset:0 lds
    v_mfma_f32_16x16x32_bf16 v[68:71], a[88:91], v[192:195], v[68:71]
    ds_read_b128 v[184:187], v40 offset:960
    buffer_load_dwordx4 v249, s[68:71], s72 offen offset:1024 lds
    v_mfma_f32_16x16x32_bf16 v[72:75], a[92:95], v[192:195], v[72:75]
    ds_read_b128 v[188:191], v40 offset:448
    s_waitcnt lgkmcnt(10)
    v_mfma_f32_16x16x32_bf16 v[64:67], a[80:83], v[196:199], v[64:67]
    v_mfma_f32_16x16x32_bf16 v[68:71], a[84:87], v[196:199], v[68:71]
    v_mfma_f32_16x16x32_bf16 v[72:75], a[88:91], v[196:199], v[72:75]
    s_waitcnt lgkmcnt(9)
    v_mfma_f32_16x16x32_bf16 v[68:71], a[80:83], v[200:203], v[68:71]
    v_mfma_f32_16x16x32_bf16 v[72:75], a[84:87], v[200:203], v[72:75]
    s_waitcnt lgkmcnt(8)
    v_mfma_f32_16x16x32_bf16 v[72:75], a[80:83], v[204:207], v[72:75]
    s_waitcnt lgkmcnt(7)
    v_mfma_f32_16x16x32_bf16 v[60:63], a[96:99], v[160:163], v[60:63]
    ds_read_b64 v[8:9], v34 offset:3584
    v_mfma_f32_16x16x32_bf16 v[64:67], a[100:103], v[160:163], v[64:67]
    ds_read_b64 v[10:11], v34 offset:3072
    buffer_load_dwordx4 v250, s[68:71], s72 offen offset:2048 lds
    v_mfma_f32_16x16x32_bf16 v[68:71], a[104:107], v[160:163], v[68:71]
    ds_read_b64 v[12:13], v34 offset:2560
    v_mfma_f32_16x16x32_bf16 v[72:75], a[108:111], v[160:163], v[72:75]
    ds_read_b64 v[14:15], v34 offset:2048
    buffer_load_dwordx4 v251, s[68:71], s72 offen offset:3072 lds
    s_add_u32 s72, s72, 131072
    s_waitcnt lgkmcnt(10)
    v_mfma_f32_16x16x32_bf16 v[64:67], a[96:99], v[164:167], v[64:67]
    v_mfma_f32_16x16x32_bf16 v[68:71], a[100:103], v[164:167], v[68:71]
    v_mfma_f32_16x16x32_bf16 v[72:75], a[104:107], v[164:167], v[72:75]
    s_waitcnt lgkmcnt(9)
    v_mfma_f32_16x16x32_bf16 v[68:71], a[96:99], v[168:171], v[68:71]
    v_mfma_f32_16x16x32_bf16 v[72:75], a[100:103], v[168:171], v[72:75]
    s_waitcnt lgkmcnt(8)
    v_mfma_f32_16x16x32_bf16 v[72:75], a[96:99], v[172:175], v[72:75]
    s_waitcnt lgkmcnt(7)
    v_mfma_f32_16x16x32_bf16 v[60:63], a[112:115], v[176:179], v[60:63]
    ds_read_b64 v[16:17], v34 offset:1536
    v_mfma_f32_16x16x32_bf16 v[64:67], a[116:119], v[176:179], v[64:67]
    ds_read_b64 v[18:19], v34 offset:1024
    v_mfma_f32_16x16x32_bf16 v[68:71], a[120:123], v[176:179], v[68:71]
    ds_read_b64 v[20:21], v34 offset:512
    v_mfma_f32_16x16x32_bf16 v[72:75], a[124:127], v[176:179], v[72:75]
    ds_read_b64 v[22:23], v34 offset:0
    s_waitcnt lgkmcnt(10)
    v_mfma_f32_16x16x32_bf16 v[64:67], a[112:115], v[180:183], v[64:67]
    v_mfma_f32_16x16x32_bf16 v[68:71], a[116:119], v[180:183], v[68:71]
    v_mfma_f32_16x16x32_bf16 v[72:75], a[120:123], v[180:183], v[72:75]
    s_waitcnt lgkmcnt(9)
    v_mfma_f32_16x16x32_bf16 v[68:71], a[112:115], v[184:187], v[68:71]
    v_mfma_f32_16x16x32_bf16 v[72:75], a[116:119], v[184:187], v[72:75]
    s_waitcnt lgkmcnt(8)
    v_mfma_f32_16x16x32_bf16 v[72:75], a[112:115], v[188:191], v[72:75]
    s_waitcnt lgkmcnt(0)
L_kbcode:
    v_lshlrev_b32 v99, 16, v8
    v_and_b32 v98, s90, v8
    v_lshlrev_b32 v97, 16, v9
    v_and_b32 v96, s90, v9
    v_lshlrev_b32 v103, 16, v10
    v_and_b32 v102, s90, v10
    v_lshlrev_b32 v101, 16, v11
    v_and_b32 v100, s90, v11
    v_lshlrev_b32 v107, 16, v12
    v_and_b32 v106, s90, v12
    v_lshlrev_b32 v105, 16, v13
    v_and_b32 v104, s90, v13
    v_lshlrev_b32 v111, 16, v14
    v_and_b32 v110, s90, v14
    v_lshlrev_b32 v109, 16, v15
    v_and_b32 v108, s90, v15
    v_lshlrev_b32 v115, 16, v16
    v_and_b32 v114, s90, v16
    v_lshlrev_b32 v113, 16, v17
    v_and_b32 v112, s90, v17
    v_lshlrev_b32 v119, 16, v18
    v_and_b32 v118, s90, v18
    v_lshlrev_b32 v117, 16, v19
    v_and_b32 v116, s90, v19
    v_lshlrev_b32 v123, 16, v20
    v_and_b32 v122, s90, v20
    v_lshlrev_b32 v121, 16, v21
    v_and_b32 v120, s90, v21
    v_lshlrev_b32 v127, 16, v22
    v_and_b32 v126, s90, v22
    v_lshlrev_b32 v125, 16, v23
    v_and_b32 v124, s90, v23
    v_fma_f32 v96, v96, s89, v44
    v_fma_f32 v97, v97, s89, v45
    v_fma_f32 v98, v98, s89, v46
    v_fma_f32 v99, v99, s89, v47
    v_cvt_pk_bf16_f32 v8, v96, v97
    v_cvt_pk_bf16_f32 v9, v98, v99
    ds_write_b64 v35, v[8:9] offset:4608
    v_fma_f32 v100, v100, s89, v48
    v_fma_f32 v101, v101, s89, v49
    v_fma_f32 v102, v102, s89, v50
    v_fma_f32 v103, v103, s89, v51
    v_cvt_pk_bf16_f32 v10, v100, v101
    v_cvt_pk_bf16_f32 v11, v102, v103
    ds_write_b64 v35, v[10:11] offset:5120
    v_fma_f32 v104, v104, s89, v52
    v_fma_f32 v105, v105, s89, v53
    v_fma_f32 v106, v106, s89, v54
    v_fma_f32 v107, v107, s89, v55
    v_cvt_pk_bf16_f32 v12, v104, v105
    v_cvt_pk_bf16_f32 v13, v106, v107
    ds_write_b64 v35, v[12:13] offset:5632
    v_fma_f32 v108, v108, s89, v56
    v_fma_f32 v109, v109, s89, v57
    v_fma_f32 v110, v110, s89, v58
    v_fma_f32 v111, v111, s89, v59
    v_cvt_pk_bf16_f32 v14, v108, v109
    v_cvt_pk_bf16_f32 v15, v110, v111
    ds_write_b64 v35, v[14:15] offset:6144
    v_fma_f32 v112, v112, s89, v60
    v_fma_f32 v113, v113, s89, v61
    v_fma_f32 v114, v114, s89, v62
    v_fma_f32 v115, v115, s89, v63
    v_cvt_pk_bf16_f32 v16, v112, v113
    v_cvt_pk_bf16_f32 v17, v114, v115
    ds_write_b64 v35, v[16:17] offset:6656
    v_fma_f32 v116, v116, s89, v64
    v_fma_f32 v117, v117, s89, v65
    v_fma_f32 v118, v118, s89, v66
    v_fma_f32 v119, v119, s89, v67
    v_cvt_pk_bf16_f32 v18, v116, v117
    v_cvt_pk_bf16_f32 v19, v118, v119
    ds_write_b64 v35, v[18:19] offset:7168
    v_fma_f32 v120, v120, s89, v68
    v_fma_f32 v121, v121, s89, v69
    v_fma_f32 v122, v122, s89, v70
    v_fma_f32 v123, v123, s89, v71
    v_cvt_pk_bf16_f32 v20, v120, v121
    v_cvt_pk_bf16_f32 v21, v122, v123
    ds_write_b64 v35, v[20:21] offset:7680
    v_fma_f32 v124, v124, s89, v72
    v_fma_f32 v125, v125, s89, v73
    v_fma_f32 v126, v126, s89, v74
    v_fma_f32 v127, v127, s89, v75
    v_cvt_pk_bf16_f32 v22, v124, v125
    v_cvt_pk_bf16_f32 v23, v126, v127
    ds_write_b64 v35, v[22:23] offset:8192
    v_lshlrev_b32 v32, 2, v0
    v_add_u32 v32, 98304, v32
    v_lshrrev_b32 v33, 3, v0
    v_lshlrev_b32 v33, 15, v33
    v_and_b32 v34, 7, v0
    v_lshl_add_u32 v33, v34, 4, v33
    s_lshl_b32 s56, s86, 7
    s_mov_b32 s57, 0x05040100
    s_mov_b32 s58, 0x07060302
    s_add_u32 s36, s28, 0x400000
    s_addc_u32 s37, s29, 0
    s_mov_b32 s38, 0x400000
    s_mov_b32 s39, 0x20000
    s_cmp_ge_u32 s30, 2
    s_waitcnt lgkmcnt(0)
    s_barrier
    ds_read_b32 v96, v32 offset:4608
    ds_read_b32 v97, v32 offset:17664
    ds_read_b32 v98, v32 offset:30720
    ds_read_b32 v99, v32 offset:43776
    ds_read_b32 v100, v32 offset:5632
    ds_read_b32 v101, v32 offset:18688
    ds_read_b32 v102, v32 offset:31744
    ds_read_b32 v103, v32 offset:44800
    ds_read_b32 v104, v32 offset:6656
    ds_read_b32 v105, v32 offset:19712
    ds_read_b32 v106, v32 offset:32768
    ds_read_b32 v107, v32 offset:45824
    ds_read_b32 v108, v32 offset:7680
    ds_read_b32 v109, v32 offset:20736
    ds_read_b32 v110, v32 offset:33792
    ds_read_b32 v111, v32 offset:46848
    s_waitcnt lgkmcnt(12)
    v_perm_b32 v128, v97, v96, s57
    v_perm_b32 v129, v99, v98, s57
    v_perm_b32 v130, v97, v96, s58
    v_perm_b32 v131, v99, v98, s58
    buffer_store_dwordx4 v[128:131], v33, s[36:39], s56 offen sc1
    s_add_u32 s56, s56, 0x100000
    s_waitcnt lgkmcnt(8)
    v_perm_b32 v132, v101, v100, s57
    v_perm_b32 v133, v103, v102, s57
    v_perm_b32 v134, v101, v100, s58
    v_perm_b32 v135, v103, v102, s58
    buffer_store_dwordx4 v[132:135], v33, s[36:39], s56 offen sc1
    s_add_u32 s56, s56, 0x100000
    s_waitcnt lgkmcnt(4)
    v_perm_b32 v136, v105, v104, s57
    v_perm_b32 v137, v107, v106, s57
    v_perm_b32 v138, v105, v104, s58
    v_perm_b32 v139, v107, v106, s58
    buffer_store_dwordx4 v[136:139], v33, s[36:39], s56 offen sc1
    s_add_u32 s56, s56, 0x100000
    s_waitcnt lgkmcnt(0)
    v_perm_b32 v140, v109, v108, s57
    v_perm_b32 v141, v111, v110, s57
    v_perm_b32 v142, v109, v108, s58
    v_perm_b32 v143, v111, v110, s58
    buffer_store_dwordx4 v[140:143], v33, s[36:39], s56 offen sc1
    s_waitcnt vmcnt(14)
    v_lshlrev_b32 v8, 16, v224
    v_and_b32 v9, s90, v224
    v_lshlrev_b32 v10, 16, v225
    v_and_b32 v11, s90, v225
    v_lshlrev_b32 v12, 16, v226
    v_and_b32 v13, s90, v226
    v_lshlrev_b32 v14, 16, v227
    v_and_b32 v15, s90, v227
    v_lshlrev_b32 v16, 16, v228
    v_and_b32 v17, s90, v228
    v_lshlrev_b32 v18, 16, v229
    v_and_b32 v19, s90, v229
    v_lshlrev_b32 v20, 16, v230
    v_and_b32 v21, s90, v230
    v_lshlrev_b32 v22, 16, v231
    v_and_b32 v23, s90, v231
    v_lshlrev_b32 v24, 16, v232
    v_and_b32 v25, s90, v232
    v_lshlrev_b32 v26, 16, v233
    v_and_b32 v27, s90, v233
    v_lshlrev_b32 v28, 16, v234
    v_and_b32 v29, s90, v234
    v_lshlrev_b32 v30, 16, v235
    v_and_b32 v31, s90, v235
    v_lshlrev_b32 v32, 16, v236
    v_and_b32 v33, s90, v236
    v_lshlrev_b32 v34, 16, v237
    v_and_b32 v35, s90, v237
    v_lshlrev_b32 v36, 16, v238
    v_and_b32 v37, s90, v238
    v_lshlrev_b32 v38, 16, v239
    v_and_b32 v39, s90, v239
    v_mov_b32 v80, 0x3a800000
    s_lshl_b32 s87, s2, 5
    s_add_u32 s87, s87, 32768
    v_mov_b32 v82, 0
    v_mov_b32 v83, s31
    s_cmp_eq_u32 s30, 0
    s_waitcnt vmcnt(0)
    s_barrier
    s_cbranch_scc0 L_sig4
    s_mov_b64 exec, 1
    buffer_store_dword v83, v82, s[92:95], s87 offen sc1
    s_mov_b64 exec, -1
L_sig4:
    ds_read_b64_tr_b16 a[128:129], v253 offset:0
    ds_read_b64_tr_b16 a[130:131], v253 offset:1024
    ds_read_b64_tr_b16 a[132:133], v254 offset:0
    ds_read_b64_tr_b16 a[134:135], v254 offset:1024
    ds_read_b64_tr_b16 a[136:137], v253 offset:2048
    ds_read_b64_tr_b16 a[138:139], v253 offset:3072
    ds_read_b64_tr_b16 a[140:141], v254 offset:2048
    ds_read_b64_tr_b16 a[142:143], v254 offset:3072
    ds_read_b64_tr_b16 a[144:145], v253 offset:4096
    ds_read_b64_tr_b16 a[146:147], v253 offset:5120
    ds_read_b64_tr_b16 a[148:149], v254 offset:4096
    ds_read_b64_tr_b16 a[150:151], v254 offset:5120
    ds_read_b64_tr_b16 a[152:153], v253 offset:6144
    ds_read_b64_tr_b16 a[154:155], v253 offset:7168
    ds_read_b64_tr_b16 a[156:157], v254 offset:6144
    ds_read_b64_tr_b16 a[158:159], v254 offset:7168
    v_pk_add_f32 v[40:41], v[8:9], v[10:11]
    v_pk_add_f32 v[56:57], v[24:25], v[26:27]
    v_pk_add_f32 v[42:43], v[12:13], v[14:15]
    v_pk_add_f32 v[58:59], v[28:29], v[30:31]
    v_pk_add_f32 v[44:45], v[16:17], v[18:19]
    v_pk_add_f32 v[60:61], v[32:33], v[34:35]
    s_mov_b32 m0, s98
    v_pk_add_f32 v[46:47], v[20:21], v[22:23]
    v_pk_add_f32 v[62:63], v[36:37], v[38:39]
    v_pk_add_f32 v[40:41], v[40:41], v[42:43]
    v_pk_add_f32 v[56:57], v[56:57], v[58:59]
    v_pk_add_f32 v[44:45], v[44:45], v[46:47]
    v_pk_add_f32 v[60:61], v[60:61], v[62:63]
    buffer_load_dwordx4 v240, s[52:55], s97 offen offset:0 lds
    v_pk_add_f32 v[40:41], v[40:41], v[44:45]
    v_pk_add_f32 v[56:57], v[56:57], v[60:61]
    v_add_f32 v40, v40, v41
    v_add_f32 v56, v56, v57
    s_nop 0
    v_add_f32_dpp v40, v40, v40 row_shr:1 row_mask:0xf bank_mask:0xf bound_ctrl:0
    buffer_load_dwordx4 v241, s[52:55], s97 offen offset:1024 lds
    v_add_f32_dpp v56, v56, v56 row_shr:1 row_mask:0xf bank_mask:0xf bound_ctrl:0
    s_nop 0
    v_add_f32_dpp v40, v40, v40 row_shr:2 row_mask:0xf bank_mask:0xf bound_ctrl:0
    v_add_f32_dpp v56, v56, v56 row_shr:2 row_mask:0xf bank_mask:0xf bound_ctrl:0
    s_nop 0
    v_add_f32_dpp v40, v40, v40 row_shr:4 row_mask:0xf bank_mask:0xf bound_ctrl:0
    buffer_load_dwordx4 v242, s[52:55], s97 offen offset:2048 lds
    v_add_f32_dpp v56, v56, v56 row_shr:4 row_mask:0xf bank_mask:0xf bound_ctrl:0
    s_nop 0
    v_add_f32_dpp v40, v40, v40 row_shr:8 row_mask:0xf bank_mask:0xf bound_ctrl:0
    v_add_f32_dpp v56, v56, v56 row_shr:8 row_mask:0xf bank_mask:0xf bound_ctrl:0
    s_nop 0
    v_add_f32_dpp v40, v40, v40 row_bcast:15 row_mask:0xa bank_mask:0xf
    buffer_load_dwordx4 v243, s[52:55], s97 offen offset:3072 lds
    v_add_f32_dpp v56, v56, v56 row_bcast:15 row_mask:0xa bank_mask:0xf
    s_nop 0
    v_add_f32_dpp v40, v40, v40 row_bcast:31 row_mask:0xc bank_mask:0xf
    v_add_f32_dpp v56, v56, v56 row_bcast:31 row_mask:0xc bank_mask:0xf
    v_readlane_b32 s56, v40, 63
    v_readlane_b32 s57, v56, 63
    s_add_u32 m0, s98, 4096
    s_nop 0
    v_mul_f32 v72, s56, v80
    v_mul_f32 v74, s57, v80
    v_mov_b32 v73, v72
    v_mov_b32 v75, v74
    v_pk_add_f32 v[40:41], v[8:9], v[72:73] neg_lo:[0,1] neg_hi:[0,1]
    buffer_load_dwordx4 v244, s[52:55], s97 offen offset:0 lds
    v_pk_add_f32 v[56:57], v[24:25], v[74:75] neg_lo:[0,1] neg_hi:[0,1]
    v_pk_add_f32 v[42:43], v[10:11], v[72:73] neg_lo:[0,1] neg_hi:[0,1]
    v_pk_add_f32 v[58:59], v[26:27], v[74:75] neg_lo:[0,1] neg_hi:[0,1]
    v_pk_add_f32 v[44:45], v[12:13], v[72:73] neg_lo:[0,1] neg_hi:[0,1]
    v_pk_add_f32 v[60:61], v[28:29], v[74:75] neg_lo:[0,1] neg_hi:[0,1]
    v_pk_add_f32 v[46:47], v[14:15], v[72:73] neg_lo:[0,1] neg_hi:[0,1]
    buffer_load_dwordx4 v245, s[52:55], s97 offen offset:1024 lds
    v_pk_add_f32 v[62:63], v[30:31], v[74:75] neg_lo:[0,1] neg_hi:[0,1]
    v_pk_add_f32 v[48:49], v[16:17], v[72:73] neg_lo:[0,1] neg_hi:[0,1]
    v_pk_add_f32 v[64:65], v[32:33], v[74:75] neg_lo:[0,1] neg_hi:[0,1]
    v_pk_add_f32 v[50:51], v[18:19], v[72:73] neg_lo:[0,1] neg_hi:[0,1]
    v_pk_add_f32 v[66:67], v[34:35], v[74:75] neg_lo:[0,1] neg_hi:[0,1]
    v_pk_add_f32 v[52:53], v[20:21], v[72:73] neg_lo:[0,1] neg_hi:[0,1]
    buffer_load_dwordx4 v246, s[52:55], s97 offen offset:2048 lds
    v_pk_add_f32 v[68:69], v[36:37], v[74:75] neg_lo:[0,1] neg_hi:[0,1]
    v_pk_add_f32 v[54:55], v[22:23], v[72:73] neg_lo:[0,1] neg_hi:[0,1]
    v_pk_add_f32 v[70:71], v[38:39], v[74:75] neg_lo:[0,1] neg_hi:[0,1]
    v_pk_mul_f32 v[76:77], v[40:41], v[40:41]
    v_pk_mul_f32 v[78:79], v[56:57], v[56:57]
    v_pk_fma_f32 v[76:77], v[42:43], v[42:43], v[76:77]
    buffer_load_dwordx4 v247, s[52:55], s97 offen offset:3072 lds
    s_add_u32 s97, s97, s100
    s_add_u32 s98, s98, 32768
    s_and_b32 s98, s98, 0x1ffff
    v_pk_fma_f32 v[78:79], v[58:59], v[58:59], v[78:79]
    v_pk_fma_f32 v[76:77], v[44:45], v[44:45], v[76:77]
    v_pk_fma_f32 v[78:79], v[60:61], v[60:61], v[78:79]
    v_pk_fma_f32 v[76:77], v[46:47], v[46:47], v[76:77]
    v_pk_fma_f32 v[78:79], v[62:63], v[62:63], v[78:79]
    v_pk_fma_f32 v[76:77], v[48:49], v[48:49], v[76:77]
    s_add_u32 m0, s73, 32768
    v_pk_fma_f32 v[78:79], v[64:65], v[64:65], v[78:79]
    v_pk_fma_f32 v[76:77], v[50:51], v[50:51], v[76:77]
    v_pk_fma_f32 v[78:79], v[66:67], v[66:67], v[78:79]
    v_pk_fma_f32 v[76:77], v[52:53], v[52:53], v[76:77]
    v_pk_fma_f32 v[78:79], v[68:69], v[68:69], v[78:79]
    v_pk_fma_f32 v[76:77], v[54:55], v[54:55], v[76:77]
    buffer_load_dwordx4 v248, s[68:71], s72 offen offset:0 lds
    v_pk_fma_f32 v[78:79], v[70:71], v[70:71], v[78:79]
    v_add_f32 v76, v76, v77
    v_add_f32 v78, v78, v79
    v_cvt_pk_bf16_f32 v72, v72, v72
    v_and_b32 v72, s90, v72
    v_cvt_pk_bf16_f32 v74, v74, v74
    buffer_load_dwordx4 v249, s[68:71], s72 offen offset:1024 lds
    v_and_b32 v74, s90, v74
    s_nop 0
    v_add_f32_dpp v76, v76, v76 row_shr:1 row_mask:0xf bank_mask:0xf bound_ctrl:0
    v_add_f32_dpp v78, v78, v78 row_shr:1 row_mask:0xf bank_mask:0xf bound_ctrl:0
    s_nop 0
    v_add_f32_dpp v76, v76, v76 row_shr:2 row_mask:0xf bank_mask:0xf bound_ctrl:0
    buffer_load_dwordx4 v250, s[68:71], s72 offen offset:2048 lds
    v_add_f32_dpp v78, v78, v78 row_shr:2 row_mask:0xf bank_mask:0xf bound_ctrl:0
    s_nop 0
    v_add_f32_dpp v76, v76, v76 row_shr:4 row_mask:0xf bank_mask:0xf bound_ctrl:0
    v_add_f32_dpp v78, v78, v78 row_shr:4 row_mask:0xf bank_mask:0xf bound_ctrl:0
    s_nop 0
    v_add_f32_dpp v76, v76, v76 row_shr:8 row_mask:0xf bank_mask:0xf bound_ctrl:0
    buffer_load_dwordx4 v251, s[68:71], s72 offen offset:3072 lds
    s_add_u32 s72, s72, 131072
    v_add_f32_dpp v78, v78, v78 row_shr:8 row_mask:0xf bank_mask:0xf bound_ctrl:0
    s_nop 0
    v_add_f32_dpp v76, v76, v76 row_bcast:15 row_mask:0xa bank_mask:0xf
    v_add_f32_dpp v78, v78, v78 row_bcast:15 row_mask:0xa bank_mask:0xf
    s_nop 0
    v_add_f32_dpp v76, v76, v76 row_bcast:31 row_mask:0xc bank_mask:0xf
    s_add_u32 m0, s73, 36864
    v_add_f32_dpp v78, v78, v78 row_bcast:31 row_mask:0xc bank_mask:0xf
    v_readlane_b32 s58, v76, 63
    v_readlane_b32 s59, v78, 63
    v_mov_b32 v73, v72
    v_mov_b32 v75, v74
    v_mul_f32 v76, s58, v80
    buffer_load_dwordx4 v248, s[68:71], s72 offen offset:0 lds
    v_mul_f32 v78, s59, v80
    v_cvt_pk_bf16_f32 v76, v76, v76
    v_and_b32 v76, s90, v76
    v_cvt_pk_bf16_f32 v78, v78, v78
    v_and_b32 v78, s90, v78
    v_add_f32 v76, 0x3727c5ac, v76
    buffer_load_dwordx4 v249, s[68:71], s72 offen offset:1024 lds
    v_add_f32 v78, 0x3727c5ac, v78
    v_cvt_pk_bf16_f32 v76, v76, v76
    v_and_b32 v76, s90, v76
    v_cvt_pk_bf16_f32 v78, v78, v78
    v_and_b32 v78, s90, v78
    v_sqrt_f32 v76, v76
    buffer_load_dwordx4 v250, s[68:71], s72 offen offset:2048 lds
    v_sqrt_f32 v78, v78
    v_pk_add_f32 v[140:141], v[8:9], v[72:73] neg_lo:[0,1] neg_hi:[0,1]
    v_pk_add_f32 v[156:157], v[24:25], v[74:75] neg_lo:[0,1] neg_hi:[0,1]
    v_pk_add_f32 v[142:143], v[10:11], v[72:73] neg_lo:[0,1] neg_hi:[0,1]
    v_pk_add_f32 v[158:159], v[26:27], v[74:75] neg_lo:[0,1] neg_hi:[0,1]
    v_cvt_pk_bf16_f32 v76, v76, v76
    buffer_load_dwordx4 v251, s[68:71], s72 offen offset:3072 lds
    s_add_u32 s72, s72, 131072
    v_and_b32 v76, s90, v76
    v_cvt_pk_bf16_f32 v78, v78, v78
    v_and_b32 v78, s90, v78
    v_rcp_f32 v76, v76
    v_rcp_f32 v78, v78
    v_pk_add_f32 v[144:145], v[12:13], v[72:73] neg_lo:[0,1] neg_hi:[0,1]
    v_pk_add_f32 v[160:161], v[28:29], v[74:75] neg_lo:[0,1] neg_hi:[0,1]
    v_pk_add_f32 v[146:147], v[14:15], v[72:73] neg_lo:[0,1] neg_hi:[0,1]
    v_pk_add_f32 v[162:163], v[30:31], v[74:75] neg_lo:[0,1] neg_hi:[0,1]
    v_pk_add_f32 v[148:149], v[16:17], v[72:73] neg_lo:[0,1] neg_hi:[0,1]
    v_pk_add_f32 v[164:165], v[32:33], v[74:75] neg_lo:[0,1] neg_hi:[0,1]
    v_pk_add_f32 v[150:151], v[18:19], v[72:73] neg_lo:[0,1] neg_hi:[0,1]
    v_pk_add_f32 v[166:167], v[34:35], v[74:75] neg_lo:[0,1] neg_hi:[0,1]
    v_pk_add_f32 v[152:153], v[20:21], v[72:73] neg_lo:[0,1] neg_hi:[0,1]
    v_pk_add_f32 v[168:169], v[36:37], v[74:75] neg_lo:[0,1] neg_hi:[0,1]
    v_pk_add_f32 v[154:155], v[22:23], v[72:73] neg_lo:[0,1] neg_hi:[0,1]
    v_pk_add_f32 v[170:171], v[38:39], v[74:75] neg_lo:[0,1] neg_hi:[0,1]
    v_mov_b32 v77, v76
    v_mov_b32 v79, v78
    v_pk_mul_f32 v[40:41], v[140:141], v[76:77]
    v_pk_mul_f32 v[56:57], v[156:157], v[78:79]
    v_pk_mul_f32 v[42:43], v[142:143], v[76:77]
    v_pk_mul_f32 v[58:59], v[158:159], v[78:79]
    v_pk_mul_f32 v[44:45], v[144:145], v[76:77]
    v_pk_mul_f32 v[60:61], v[160:161], v[78:79]
    v_pk_mul_f32 v[46:47], v[146:147], v[76:77]
    v_pk_mul_f32 v[62:63], v[162:163], v[78:79]
    v_pk_mul_f32 v[48:49], v[148:149], v[76:77]
    v_pk_mul_f32 v[64:65], v[164:165], v[78:79]
    v_pk_mul_f32 v[50:51], v[150:151], v[76:77]
    v_pk_mul_f32 v[66:67], v[166:167], v[78:79]
    v_pk_mul_f32 v[52:53], v[152:153], v[76:77]
    v_pk_mul_f32 v[68:69], v[168:169], v[78:79]
    v_pk_mul_f32 v[54:55], v[154:155], v[76:77]
    v_pk_mul_f32 v[70:71], v[170:171], v[78:79]
    v_lshlrev_b32 v5, 7, v2
    v_lshlrev_b32 v139, 8, v2
    v_add_u32 v6, 0x4000, v139
    s_lshr_b32 s82, s91, 1
    s_lshl_b32 s82, s82, 15
    s_and_b32 s83, s91, 1
    s_lshl_b32 s83, s83, 6
    s_add_u32 s82, s82, s83
    s_lshl_b32 s83, s30, 13
    s_add_u32 s82, s82, s83
    v_lshrrev_b32 v176, 4, v2
    v_xor_b32 v176, v176, v2
    v_and_b32 v176, 3, v176
    v_lshlrev_b32 v176, 4, v176
    v_lshrrev_b32 v177, 2, v2
    v_lshl_add_u32 v176, v177, 7, v176
    v_add_u32 v177, 1024, v176
    v_add_u32 v178, 2048, v176
    v_add_u32 v179, 3072, v176
    s_lshl_b32 s83, s30, 12
    s_add_u32 m0, s83, 114688
    v_bfe_u32 v180, v2, 1, 2
    v_xor_b32 v180, s30, v180
    v_lshl_add_u32 v180, v180, 4, v5
    v_add_u32 v180, 114688, v180
    s_add_u32 s40, s28, 0x800000
    s_addc_u32 s41, s29, 0
    s_mov_b32 s42, 0x400000
    s_mov_b32 s43, 0x20000
    s_add_u32 s44, s28, 0xc00000
    s_addc_u32 s45, s29, 0
    s_mov_b32 s46, 0x400000
    s_mov_b32 s47, 0x20000
    v_and_b32 v7, 7, v2
    s_lshl_b32 s83, s30, 1
    v_xor_b32 v132, s83, v7
    v_lshl_add_u32 v132, v132, 4, v5
    v_add_u32 v132, 98304, v132
    v_xor_b32 v133, 16, v132
    v_lshrrev_b32 v134, 3, v2
    v_xor_b32 v135, v134, v7
    v_lshlrev_b32 v135, 4, v135
    v_lshl_add_u32 v135, v134, 7, v135
    s_lshl_b32 s83, s30, 12
    s_add_u32 s83, s83, 98304
    v_add_u32 v135, s83, v135
    v_lshrrev_b32 v136, 5, v2
    v_lshlrev_b32 v136, 12, v136
    v_bfe_u32 v137, v2, 3, 2
    v_lshl_add_u32 v136, v137, 8, v136
    v_lshl_add_u32 v136, v7, 4, v136
    s_lshr_b32 s84, s91, 3
    s_lshl_b32 s84, s84, 17
    s_bfe_u32 s85, s91, 0x20001
    s_lshl_b32 s85, s85, 10
    s_add_u32 s84, s84, s85
    s_and_b32 s85, s91, 1
    s_lshl_b32 s85, s85, 7
    s_add_u32 s84, s84, s85
    s_lshl_b32 s85, s30, 15
    s_add_u32 s84, s84, s85
    s_mov_b32 s85, 32768
    s_waitcnt lgkmcnt(0)
    v_lshlrev_b32 v138, 5, v2
    s_cmp_lg_u32 s30, 0
    s_cbranch_scc1 L_poll5x
L_poll5:
    s_add_u32 s89, s85, 0
    buffer_load_dword v128, v138, s[92:95], s89 offen sc1
    s_add_u32 s89, s85, 2048
    buffer_load_dword v129, v138, s[92:95], s89 offen sc1
    s_add_u32 s89, s85, 4096
    buffer_load_dword v130, v138, s[92:95], s89 offen sc1
    s_add_u32 s89, s85, 6144
    buffer_load_dword v131, v138, s[92:95], s89 offen sc1
    s_waitcnt vmcnt(0)
    v_xor_b32 v128, s31, v128
    v_xor_b32 v129, s31, v129
    v_xor_b32 v130, s31, v130
    v_xor_b32 v131, s31, v131
    v_or3_b32 v128, v128, v129, v130
    v_or_b32 v128, v128, v131
    v_cmp_ne_u32 vcc, 0, v128
    s_add_u32 s3, s3, 1
    s_cmp_gt_u32 s3, 200000
    s_cbranch_scc1 L_poll5x
    s_cbranch_vccz L_poll5x
    s_branch L_poll5
L_poll5x:
    s_barrier
    buffer_load_dwordx4 v176, s[36:39], s82 offen offset:0 sc1 lds
    buffer_load_dwordx4 v177, s[36:39], s82 offen offset:1024 sc1 lds
    buffer_load_dwordx4 v178, s[36:39], s82 offen offset:2048 sc1 lds
    buffer_load_dwordx4 v179, s[36:39], s82 offen offset:3072 sc1 lds
    s_waitcnt vmcnt(4)
    ds_read_b64_tr_b16 a[160:161], v253 offset:32768
    ds_read_b64_tr_b16 a[162:163], v253 offset:33792
    ds_read_b64_tr_b16 a[164:165], v254 offset:32768
    ds_read_b64_tr_b16 a[166:167], v254 offset:33792
    ds_read_b64_tr_b16 a[168:169], v253 offset:34816
    ds_read_b64_tr_b16 a[170:171], v253 offset:35840
    ds_read_b64_tr_b16 a[172:173], v254 offset:34816
    ds_read_b64_tr_b16 a[174:175], v254 offset:35840
    ds_read_b64_tr_b16 a[176:177], v253 offset:36864
    ds_read_b64_tr_b16 a[178:179], v253 offset:37888
    ds_read_b64_tr_b16 a[180:181], v254 offset:36864
    ds_read_b64_tr_b16 a[182:183], v254 offset:37888
    ds_read_b64_tr_b16 a[184:185], v253 offset:38912
    ds_read_b64_tr_b16 a[186:187], v253 offset:39936
    ds_read_b64_tr_b16 a[188:189], v254 offset:38912
    ds_read_b64_tr_b16 a[190:191], v254 offset:39936
    s_waitcnt vmcnt(0)
    s_barrier
    ds_read_b128 v[84:87], v180
    ds_read_b128 v[88:91], v180 offset:64
    ds_read_b128 v[92:95], v180 offset:8192
    ds_read_b128 v[96:99], v180 offset:8256
    s_waitcnt lgkmcnt(3)
    v_lshlrev_b32 v100, 16, v84
    v_and_b32 v101, s90, v84
    v_lshlrev_b32 v102, 16, v85
    v_and_b32 v103, s90, v85
    v_lshlrev_b32 v116, 16, v86
    v_and_b32 v117, s90, v86
    v_lshlrev_b32 v118, 16, v87
    v_and_b32 v119, s90, v87
    v_pk_fma_f32 v[140:141], v[40:41], v[100:101], v[140:141]
    v_pk_fma_f32 v[142:143], v[42:43], v[102:103], v[142:143]
    v_pk_fma_f32 v[156:157], v[56:57], v[116:117], v[156:157]
    v_pk_fma_f32 v[158:159], v[58:59], v[118:119], v[158:159]
    v_pk_mul_f32 v[76:77], v[140:141], v[140:141]
    v_pk_fma_f32 v[76:77], v[142:143], v[142:143], v[76:77]
    v_pk_add_f32 v[172:173], v[140:141], v[142:143]
    v_pk_mul_f32 v[78:79], v[156:157], v[156:157]
    v_pk_fma_f32 v[78:79], v[158:159], v[158:159], v[78:79]
    v_pk_add_f32 v[174:175], v[156:157], v[158:159]
    s_waitcnt lgkmcnt(2)
    v_lshlrev_b32 v104, 16, v88
    v_and_b32 v105, s90, v88
    v_lshlrev_b32 v106, 16, v89
    v_and_b32 v107, s90, v89
    v_lshlrev_b32 v120, 16, v90
    v_and_b32 v121, s90, v90
    v_lshlrev_b32 v122, 16, v91
    v_and_b32 v123, s90, v91
    v_pk_fma_f32 v[144:145], v[44:45], v[104:105], v[144:145]
    v_pk_fma_f32 v[146:147], v[46:47], v[106:107], v[146:147]
    v_pk_fma_f32 v[160:161], v[60:61], v[120:121], v[160:161]
    v_pk_fma_f32 v[162:163], v[62:63], v[122:123], v[162:163]
    v_pk_fma_f32 v[76:77], v[144:145], v[144:145], v[76:77]
    v_pk_fma_f32 v[76:77], v[146:147], v[146:147], v[76:77]
    v_pk_add_f32 v[172:173], v[144:145], v[172:173]
    v_pk_add_f32 v[172:173], v[146:147], v[172:173]
    v_pk_fma_f32 v[78:79], v[160:161], v[160:161], v[78:79]
    v_pk_fma_f32 v[78:79], v[162:163], v[162:163], v[78:79]
    v_pk_add_f32 v[174:175], v[160:161], v[174:175]
    v_pk_add_f32 v[174:175], v[162:163], v[174:175]
    s_waitcnt lgkmcnt(1)
    v_lshlrev_b32 v108, 16, v92
    v_and_b32 v109, s90, v92
    v_lshlrev_b32 v110, 16, v93
    v_and_b32 v111, s90, v93
    v_lshlrev_b32 v124, 16, v94
    v_and_b32 v125, s90, v94
    v_lshlrev_b32 v126, 16, v95
    v_and_b32 v127, s90, v95
    v_pk_fma_f32 v[148:149], v[48:49], v[108:109], v[148:149]
    v_pk_fma_f32 v[150:151], v[50:51], v[110:111], v[150:151]
    v_pk_fma_f32 v[164:165], v[64:65], v[124:125], v[164:165]
    v_pk_fma_f32 v[166:167], v[66:67], v[126:127], v[166:167]
    v_pk_fma_f32 v[76:77], v[148:149], v[148:149], v[76:77]
    v_pk_fma_f32 v[76:77], v[150:151], v[150:151], v[76:77]
    v_pk_add_f32 v[172:173], v[148:149], v[172:173]
    v_pk_add_f32 v[172:173], v[150:151], v[172:173]
    v_pk_fma_f32 v[78:79], v[164:165], v[164:165], v[78:79]
    v_pk_fma_f32 v[78:79], v[166:167], v[166:167], v[78:79]
    v_pk_add_f32 v[174:175], v[164:165], v[174:175]
    v_pk_add_f32 v[174:175], v[166:167], v[174:175]
    s_waitcnt lgkmcnt(0)
    v_lshlrev_b32 v112, 16, v96
    v_and_b32 v113, s90, v96
    v_lshlrev_b32 v114, 16, v97
    v_and_b32 v115, s90, v97
    v_lshlrev_b32 v128, 16, v98
    v_and_b32 v129, s90, v98
    v_lshlrev_b32 v130, 16, v99
    v_and_b32 v131, s90, v99
    v_pk_fma_f32 v[152:153], v[52:53], v[112:113], v[152:153]
    v_pk_fma_f32 v[154:155], v[54:55], v[114:115], v[154:155]
    v_pk_fma_f32 v[168:169], v[68:69], v[128:129], v[168:169]
    v_pk_fma_f32 v[170:171], v[70:71], v[130:131], v[170:171]
    v_pk_fma_f32 v[76:77], v[152:153], v[152:153], v[76:77]
    v_pk_fma_f32 v[76:77], v[154:155], v[154:155], v[76:77]
    v_pk_add_f32 v[172:173], v[152:153], v[172:173]
    v_pk_add_f32 v[172:173], v[154:155], v[172:173]
    v_pk_fma_f32 v[78:79], v[168:169], v[168:169], v[78:79]
    v_pk_fma_f32 v[78:79], v[170:171], v[170:171], v[78:79]
    v_pk_add_f32 v[174:175], v[168:169], v[174:175]
    v_pk_add_f32 v[174:175], v[170:171], v[174:175]
    v_add_f32 v172, v172, v173
    v_add_f32 v76, v76, v77
    v_add_f32 v174, v174, v175
    v_add_f32 v78, v78, v79
    v_add_f32_dpp v172, v172, v172 row_shr:1 row_mask:0xf bank_mask:0xf bound_ctrl:0
    v_add_f32_dpp v174, v174, v174 row_shr:1 row_mask:0xf bank_mask:0xf bound_ctrl:0
    v_add_f32_dpp v76, v76, v76 row_shr:1 row_mask:0xf bank_mask:0xf bound_ctrl:0
    v_add_f32_dpp v78, v78, v78 row_shr:1 row_mask:0xf bank_mask:0xf bound_ctrl:0
    v_add_f32_dpp v172, v172, v172 row_shr:2 row_mask:0xf bank_mask:0xf bound_ctrl:0
    v_add_f32_dpp v174, v174, v174 row_shr:2 row_mask:0xf bank_mask:0xf bound_ctrl:0
    v_add_f32_dpp v76, v76, v76 row_shr:2 row_mask:0xf bank_mask:0xf bound_ctrl:0
    v_add_f32_dpp v78, v78, v78 row_shr:2 row_mask:0xf bank_mask:0xf bound_ctrl:0
    v_add_f32_dpp v172, v172, v172 row_shr:4 row_mask:0xf bank_mask:0xf bound_ctrl:0
    v_add_f32_dpp v174, v174, v174 row_shr:4 row_mask:0xf bank_mask:0xf bound_ctrl:0
    v_add_f32_dpp v76, v76, v76 row_shr:4 row_mask:0xf bank_mask:0xf bound_ctrl:0
    v_add_f32_dpp v78, v78, v78 row_shr:4 row_mask:0xf bank_mask:0xf bound_ctrl:0
    v_add_f32_dpp v172, v172, v172 row_shr:8 row_mask:0xf bank_mask:0xf bound_ctrl:0
    v_add_f32_dpp v174, v174, v174 row_shr:8 row_mask:0xf bank_mask:0xf bound_ctrl:0
    v_add_f32_dpp v76, v76, v76 row_shr:8 row_mask:0xf bank_mask:0xf bound_ctrl:0
    v_add_f32_dpp v78, v78, v78 row_shr:8 row_mask:0xf bank_mask:0xf bound_ctrl:0
    v_add_f32_dpp v172, v172, v172 row_bcast:15 row_mask:0xa bank_mask:0xf
    v_add_f32_dpp v174, v174, v174 row_bcast:15 row_mask:0xa bank_mask:0xf
    v_add_f32_dpp v76, v76, v76 row_bcast:15 row_mask:0xa bank_mask:0xf
    v_add_f32_dpp v78, v78, v78 row_bcast:15 row_mask:0xa bank_mask:0xf
    v_add_f32_dpp v172, v172, v172 row_bcast:31 row_mask:0xc bank_mask:0xf
    v_add_f32_dpp v174, v174, v174 row_bcast:31 row_mask:0xc bank_mask:0xf
    v_add_f32_dpp v76, v76, v76 row_bcast:31 row_mask:0xc bank_mask:0xf
    v_add_f32_dpp v78, v78, v78 row_bcast:31 row_mask:0xc bank_mask:0xf
    v_readlane_b32 s56, v172, 63
    v_readlane_b32 s57, v174, 63
    v_readlane_b32 s58, v76, 63
    v_readlane_b32 s59, v78, 63
    v_mul_f32 v172, s56, v80
    v_mul_f32 v174, s57, v80
    v_pk_fma_f32 v[8:9], v[40:41], v[100:101], v[8:9]
    v_pk_fma_f32 v[10:11], v[42:43], v[102:103], v[10:11]
    v_mul_f32 v76, s58, v80
    v_mul_f32 v78, s59, v80
    v_pk_fma_f32 v[12:13], v[44:45], v[104:105], v[12:13]
    v_pk_fma_f32 v[14:15], v[46:47], v[106:107], v[14:15]
    v_fma_f32 v76, -v172, v172, v76
    v_fma_f32 v78, -v174, v174, v78
    v_pk_fma_f32 v[16:17], v[48:49], v[108:109], v[16:17]
    v_pk_fma_f32 v[18:19], v[50:51], v[110:111], v[18:19]
    v_max_f32 v76, 0, v76
    v_max_f32 v78, 0, v78
    v_pk_fma_f32 v[20:21], v[52:53], v[112:113], v[20:21]
    v_pk_fma_f32 v[22:23], v[54:55], v[114:115], v[22:23]
    v_cvt_pk_bf16_f32 v76, v76, v76
    v_and_b32 v76, s90, v76
    v_cvt_pk_bf16_f32 v78, v78, v78
    v_and_b32 v78, s90, v78
    v_pk_fma_f32 v[24:25], v[56:57], v[116:117], v[24:25]
    v_pk_fma_f32 v[26:27], v[58:59], v[118:119], v[26:27]
    v_add_f32 v76, 0x3727c5ac, v76
    v_add_f32 v78, 0x3727c5ac, v78
    v_pk_fma_f32 v[28:29], v[60:61], v[120:121], v[28:29]
    v_pk_fma_f32 v[30:31], v[62:63], v[122:123], v[30:31]
    v_cvt_pk_bf16_f32 v76, v76, v76
    v_and_b32 v76, s90, v76
    v_cvt_pk_bf16_f32 v78, v78, v78
    v_and_b32 v78, s90, v78
    v_pk_fma_f32 v[32:33], v[64:65], v[124:125], v[32:33]
    v_pk_fma_f32 v[34:35], v[66:67], v[126:127], v[34:35]
    v_sqrt_f32 v76, v76
    v_sqrt_f32 v78, v78
    v_pk_fma_f32 v[36:37], v[68:69], v[128:129], v[36:37]
    v_pk_fma_f32 v[38:39], v[70:71], v[130:131], v[38:39]
    v_add_f32 v172, v172, v72
    v_add_f32 v174, v174, v74
    v_cvt_pk_bf16_f32 v224, v8, v9
    v_cvt_pk_bf16_f32 v225, v10, v11
    v_cvt_pk_bf16_f32 v76, v76, v76
    v_and_b32 v76, s90, v76
    v_cvt_pk_bf16_f32 v78, v78, v78
    v_and_b32 v78, s90, v78
    v_cvt_pk_bf16_f32 v226, v12, v13
    v_cvt_pk_bf16_f32 v227, v14, v15
    v_rcp_f32 v76, v76
    v_rcp_f32 v78, v78
    v_cvt_pk_bf16_f32 v228, v16, v17
    v_cvt_pk_bf16_f32 v229, v18, v19
    v_cvt_pk_bf16_f32 v172, v172, v172
    v_and_b32 v172, s90, v172
    v_cvt_pk_bf16_f32 v174, v174, v174
    v_and_b32 v174, s90, v174
    v_cvt_pk_bf16_f32 v230, v20, v21
    v_cvt_pk_bf16_f32 v231, v22, v23
    v_sub_f32 v172, v72, v172
    v_sub_f32 v174, v74, v174
    v_cvt_pk_bf16_f32 v232, v24, v25
    v_cvt_pk_bf16_f32 v233, v26, v27
    v_mul_f32 v172, v172, v76
    v_mul_f32 v174, v174, v78
    v_cvt_pk_bf16_f32 v234, v28, v29
    v_cvt_pk_bf16_f32 v235, v30, v31
    v_pk_fma_f32 v[40:41], v[140:141], v[76:77], v[172:173] op_sel_hi:[1,0,0]
    v_pk_fma_f32 v[56:57], v[156:157], v[78:79], v[174:175] op_sel_hi:[1,0,0]
    v_pk_fma_f32 v[42:43], v[142:143], v[76:77], v[172:173] op_sel_hi:[1,0,0]
    v_pk_fma_f32 v[58:59], v[158:159], v[78:79], v[174:175] op_sel_hi:[1,0,0]
    v_pk_fma_f32 v[44:45], v[144:145], v[76:77], v[172:173] op_sel_hi:[1,0,0]
    v_pk_fma_f32 v[60:61], v[160:161], v[78:79], v[174:175] op_sel_hi:[1,0,0]
    v_pk_fma_f32 v[46:47], v[146:147], v[76:77], v[172:173] op_sel_hi:[1,0,0]
    v_pk_fma_f32 v[62:63], v[162:163], v[78:79], v[174:175] op_sel_hi:[1,0,0]
    v_pk_fma_f32 v[48:49], v[148:149], v[76:77], v[172:173] op_sel_hi:[1,0,0]
    v_pk_fma_f32 v[64:65], v[164:165], v[78:79], v[174:175] op_sel_hi:[1,0,0]
    v_pk_fma_f32 v[50:51], v[150:151], v[76:77], v[172:173] op_sel_hi:[1,0,0]
    v_pk_fma_f32 v[66:67], v[166:167], v[78:79], v[174:175] op_sel_hi:[1,0,0]
    v_pk_fma_f32 v[52:53], v[152:153], v[76:77], v[172:173] op_sel_hi:[1,0,0]
    v_pk_fma_f32 v[68:69], v[168:169], v[78:79], v[174:175] op_sel_hi:[1,0,0]
    v_pk_fma_f32 v[54:55], v[154:155], v[76:77], v[172:173] op_sel_hi:[1,0,0]
    v_pk_fma_f32 v[70:71], v[170:171], v[78:79], v[174:175] op_sel_hi:[1,0,0]
    v_cvt_pk_bf16_f32 v84, v40, v41
    v_cvt_pk_bf16_f32 v85, v42, v43
    v_cvt_pk_bf16_f32 v86, v44, v45
    v_cvt_pk_bf16_f32 v87, v46, v47
    v_cvt_pk_bf16_f32 v88, v48, v49
    v_cvt_pk_bf16_f32 v89, v50, v51
    v_cvt_pk_bf16_f32 v90, v52, v53
    v_cvt_pk_bf16_f32 v91, v54, v55
    ds_write_b128 v132, v[84:87] offset:0
    ds_write_b128 v132, v[88:91] offset:8192
    v_cvt_pk_bf16_f32 v92, v56, v57
    v_cvt_pk_bf16_f32 v93, v58, v59
    v_cvt_pk_bf16_f32 v94, v60, v61
    v_cvt_pk_bf16_f32 v95, v62, v63
    v_cvt_pk_bf16_f32 v96, v64, v65
    v_cvt_pk_bf16_f32 v97, v66, v67
    v_cvt_pk_bf16_f32 v98, v68, v69
    v_cvt_pk_bf16_f32 v99, v70, v71
    ds_write_b128 v133, v[92:95] offset:0
    ds_write_b128 v133, v[96:99] offset:8192
    v_cvt_pk_bf16_f32 v236, v32, v33
    v_cvt_pk_bf16_f32 v237, v34, v35
    v_cvt_pk_bf16_f32 v238, v36, v37
    v_cvt_pk_bf16_f32 v239, v38, v39
    s_waitcnt lgkmcnt(0)
    s_barrier
    ds_read_b128 v[100:103], v135 offset:0
    ds_read_b128 v[104:107], v135 offset:1024
    ds_read_b128 v[108:111], v135 offset:2048
    ds_read_b128 v[112:115], v135 offset:3072
    s_waitcnt lgkmcnt(3)
    buffer_store_dwordx4 v[100:103], v136, s[44:47], s84 offen sc1
    s_add_u32 s84, s84, 8192
    s_waitcnt lgkmcnt(2)
    buffer_store_dwordx4 v[104:107], v136, s[44:47], s84 offen sc1
    s_add_u32 s84, s84, 8192
    s_waitcnt lgkmcnt(1)
    buffer_store_dwordx4 v[108:111], v136, s[44:47], s84 offen sc1
    s_add_u32 s84, s84, 8192
    s_waitcnt lgkmcnt(0)
    buffer_store_dwordx4 v[112:115], v136, s[44:47], s84 offen sc1
    s_lshl_b32 s87, s91, 5
    s_add_u32 s87, s87, 65536
    v_mov_b32 v28, v248
    v_mov_b32 v29, v249
    v_mov_b32 v30, v250
    v_mov_b32 v31, v251
    v_mov_b32 v7, v252
    v_mov_b32 v8, v240
    v_mov_b32 v9, v241
    v_mov_b32 v10, v242
    v_mov_b32 v11, v243
    v_mov_b32 v12, v244
    v_mov_b32 v13, v245
    v_mov_b32 v14, v246
    v_mov_b32 v15, v247
    v_accvgpr_write_b32 a92, v224
    v_accvgpr_write_b32 a93, v225
    v_accvgpr_write_b32 a94, v226
    v_accvgpr_write_b32 a95, v227
    v_accvgpr_write_b32 a96, v228
    v_accvgpr_write_b32 a97, v229
    v_accvgpr_write_b32 a98, v230
    v_accvgpr_write_b32 a99, v231
    v_accvgpr_write_b32 a100, v232
    v_accvgpr_write_b32 a101, v233
    v_accvgpr_write_b32 a102, v234
    v_accvgpr_write_b32 a103, v235
    v_accvgpr_write_b32 a104, v236
    v_accvgpr_write_b32 a105, v237
    v_accvgpr_write_b32 a106, v238
    v_accvgpr_write_b32 a107, v239
    v_mov_b32 v20, 0
    v_mov_b32 v21, 0
    v_mov_b32 v22, 0
    v_mov_b32 v23, 0
    s_nop 1
    v_mfma_f32_32x32x16_bf16 v[32:47], v[20:23], v[20:23], 0
    v_mfma_f32_32x32x16_bf16 v[48:63], v[20:23], v[20:23], 0
    v_mfma_f32_32x32x16_bf16 v[64:79], v[20:23], v[20:23], 0
    v_mfma_f32_32x32x16_bf16 v[80:95], v[20:23], v[20:23], 0
    v_mfma_f32_32x32x16_bf16 v[96:111], v[20:23], v[20:23], 0
    v_mfma_f32_32x32x16_bf16 v[112:127], v[20:23], v[20:23], 0
    v_mfma_f32_32x32x16_bf16 v[128:143], v[20:23], v[20:23], 0
    v_mfma_f32_32x32x16_bf16 v[144:159], v[20:23], v[20:23], 0
    v_mfma_f32_32x32x16_bf16 v[160:175], v[20:23], v[20:23], 0
    v_mfma_f32_32x32x16_bf16 v[176:191], v[20:23], v[20:23], 0
    v_mfma_f32_32x32x16_bf16 v[192:207], v[20:23], v[20:23], 0
    v_mfma_f32_32x32x16_bf16 v[208:223], v[20:23], v[20:23], 0
    v_mfma_f32_32x32x16_bf16 v[224:239], v[20:23], v[20:23], 0
    v_mfma_f32_32x32x16_bf16 v[240:255], v[20:23], v[20:23], 0
    v_lshlrev_b32 v16, 4, v2
    v_lshrrev_b32 v4, 4, v2
    v_lshlrev_b32 v4, 11, v4
    v_bfe_u32 v5, v2, 4, 1
    v_lshl_add_u32 v4, v5, 7, v4
    v_bfe_u32 v6, v2, 2, 2
    v_mul_u32_u24 v5, 224, v6
    v_and_b32 v6, 3, v2
    v_lshl_add_u32 v5, v6, 3, v5
    v_add_u32 v18, v4, v5
    v_mov_b32 v17, v18
    v_and_b32 v19, 31, v2
    v_lshlrev_b32 v19, 5, v19
    s_lshl_b32 s56, s80, 2
    s_add_u32 s56, s56, s30
    s_lshl_b32 s57, s56, 17
    s_add_u32 s32, s28, 0xc00000
    s_addc_u32 s33, s29, 0
    s_add_u32 s32, s32, s57
    s_addc_u32 s33, s33, 0
    s_mov_b32 s34, 0x20000
    s_mov_b32 s35, 0x20000
    s_lshl_b32 s57, s80, 2
    s_add_u32 s57, s57, s30
    s_mul_i32 s57, s57, 458752
    s_add_u32 s57, s57, 0x1000000
    s_add_u32 s36, s28, s57
    s_addc_u32 s37, s29, 0
    s_mov_b32 s38, 0x70000
    s_mov_b32 s39, 0x20000
    s_and_b32 s58, s81, 1
    s_mul_i32 s85, s81, 7
    s_add_u32 s85, s85, s58
    s_lshl_b32 s85, s85, 9
    s_movk_i32 s86, 3072
    s_cmp_eq_u32 s58, 0
    s_cselect_b32 s86, s86, 0xfffffe00
    s_add_u32 s86, s86, s85
    v_mov_b32 v4, 0
    v_mov_b32 v5, s31
    s_cmp_eq_u32 s30, 0
    s_waitcnt vmcnt(0)
    s_barrier
    s_cbranch_scc0 L_sig6
    s_mov_b64 exec, 1
    buffer_store_dword v5, v4, s[92:95], s87 offen sc1
    s_mov_b64 exec, -1
L_sig6:
    s_mul_i32 s56, s2, 28672
    s_mul_i32 s57, s30, 7168
    s_add_u32 s56, s56, s57
    s_add_u32 s44, s22, s56
    s_addc_u32 s45, s23, 0
    s_mov_b32 s46, 0x1c00
    s_mov_b32 s47, 0x20000
    v_min_u32 v21, 8, v2
    v_lshlrev_b32 v21, 7, v21
    s_mov_b32 s88, 0
    s_lshl_b32 s56, s80, 10
    s_add_u32 s56, s56, 65536
    s_add_u32 s89, s73, 98304
    s_mul_i32 s57, s2, 3584
    s_mul_i32 s58, s30, 896
    s_add_u32 s57, s57, s58
    s_add_u32 s48, s18, s57
    s_addc_u32 s49, s19, 0
    s_mov_b32 s51, 0x20000
    s_sub_u32 s50, 7340032, s57
    s_add_u32 s4, s20, s57
    s_addc_u32 s5, s21, 0
    s_mov_b32 s7, 0x20000
    s_mov_b32 s6, s50
    s_mov_b32 s101, 1835008
    v_min_u32 v6, 6, v2
    v_lshlrev_b32 v6, 7, v6
    s_getpc_b64 s[78:79]
L_pcg:
    s_lshl_b32 s77, s30, 13
    s_add_u32 s77, s77, L_g1epi-L_pcg
    v_lshl_add_u32 v24, v2, 7, s77
    v_min_u32 v24, L_end-L_pcg, v24
    v_mov_b32 v23, 0
    s_mov_b32 s82, 0
    s_mov_b32 s83, 0
    s_mov_b32 s84, 0
    s_mov_b32 m0, s98
    s_nop 0
    buffer_load_dwordx4 v8, s[52:55], s97 offen offset:0 lds
    buffer_load_dwordx4 v9, s[52:55], s97 offen offset:1024 lds
    buffer_load_dwordx4 v10, s[52:55], s97 offen offset:2048 lds
    buffer_load_dwordx4 v11, s[52:55], s97 offen offset:3072 lds
    s_add_u32 m0, s98, 4096
    s_nop 0
    buffer_load_dwordx4 v12, s[52:55], s97 offen offset:0 lds
    buffer_load_dwordx4 v13, s[52:55], s97 offen offset:1024 lds
    buffer_load_dwordx4 v14, s[52:55], s97 offen offset:2048 lds
    buffer_load_dwordx4 v15, s[52:55], s97 offen offset:3072 lds
    s_add_u32 s97, s97, s100
    s_add_u32 s98, s98, 32768
    s_and_b32 s98, s98, 0x1ffff
    s_mov_b32 m0, s98
    s_nop 0
    buffer_load_dwordx4 v8, s[52:55], s97 offen offset:0 lds
    buffer_load_dwordx4 v9, s[52:55], s97 offen offset:1024 lds
    ds_read_b64_tr_b16 a[0:1], v17 offset:0
    ds_read_b64_tr_b16 a[2:3], v17 offset:1024
    ds_read_b64_tr_b16 a[4:5], v17 offset:32
    ds_read_b64_tr_b16 a[6:7], v17 offset:1056
    ds_read_b64_tr_b16 a[8:9], v17 offset:64
    ds_read_b64_tr_b16 a[10:11], v17 offset:1088
    ds_read_b64_tr_b16 a[12:13], v17 offset:96
    ds_read_b64_tr_b16 a[14:15], v17 offset:1120
    ds_read_b64_tr_b16 a[16:17], v17 offset:128
    ds_read_b64_tr_b16 a[18:19], v17 offset:1152
    ds_read_b64_tr_b16 a[20:21], v17 offset:160
    ds_read_b64_tr_b16 a[22:23], v17 offset:1184
    s_waitcnt lgkmcnt(12)
    s_cmp_lg_u32 s30, 0
    s_cbranch_scc1 L_poll7x
L_poll7:
    buffer_load_dword v20, v19, s[92:95], s56 offen sc1
    s_waitcnt vmcnt(0)
    v_cmp_ne_u32 vcc, s31, v20
    s_add_u32 s3, s3, 1
    s_cmp_gt_u32 s3, 200000
    s_cbranch_scc1 L_poll7x
    s_cbranch_vccz L_poll7x
    s_branch L_poll7
L_poll7x:
    s_barrier
    buffer_load_dwordx4 a[28:31], v16, s[32:35], s82 offen offset:0 sc1
    buffer_load_dwordx4 a[32:35], v16, s[32:35], s82 offen offset:1024 sc1
    buffer_load_dwordx4 a[36:39], v16, s[32:35], s82 offen offset:2048 sc1
    buffer_load_dwordx4 a[40:43], v16, s[32:35], s82 offen offset:3072 sc1
    s_add_u32 s82, s82, 4096
    buffer_load_dwordx4 a[44:47], v16, s[32:35], s82 offen offset:0 sc1
    buffer_load_dwordx4 a[48:51], v16, s[32:35], s82 offen offset:1024 sc1
    buffer_load_dwordx4 a[52:55], v16, s[32:35], s82 offen offset:2048 sc1
    buffer_load_dwordx4 a[56:59], v16, s[32:35], s82 offen offset:3072 sc1
    s_add_u32 s82, s82, 4096
    buffer_load_dwordx4 a[60:63], v16, s[32:35], s82 offen offset:0 sc1
    buffer_load_dwordx4 a[64:67], v16, s[32:35], s82 offen offset:1024 sc1
    buffer_load_dwordx4 a[68:71], v16, s[32:35], s82 offen offset:2048 sc1
    buffer_load_dwordx4 a[72:75], v16, s[32:35], s82 offen offset:3072 sc1
    s_add_u32 s82, s82, 4096
    s_waitcnt vmcnt(8)
    s_branch L_g1_P1
.p2align 6
L_g1_loop:
    s_cmp_eq_u32 s84, 7
    s_cbranch_scc0 L_g1_notw
    v_mov_b32 v8, v28
    v_add_u32 v12, 131072, v28
    v_mov_b32 v9, v29
    v_add_u32 v13, 131072, v29
    v_mov_b32 v10, v30
    v_add_u32 v14, 131072, v30
    v_mov_b32 v11, v31
    v_add_u32 v15, 131072, v31
    s_mov_b64 s[52:53], s[68:69]
    s_mov_b32 s54, s70
    s_add_u32 s97, s72, 32768
    s_mov_b32 s100, 262144
L_g1_notw:
    s_add_u32 s83, s83, 32768
    s_and_b32 s83, s83, 0x1ffff
    s_waitcnt vmcnt(20)
    s_barrier
    s_waitcnt lgkmcnt(10)
    v_mfma_f32_16x16x32_bf16 v[144:147], a[0:3], a[76:79], v[144:147]
    ds_read_b64_tr_b16 a[24:25], v17 offset:24768
    v_mfma_f32_16x16x32_bf16 v[148:151], a[0:3], a[80:83], v[148:151]
    ds_read_b64_tr_b16 a[26:27], v17 offset:25792
    v_mfma_f32_16x16x32_bf16 v[152:155], a[0:3], a[84:87], v[152:155]
    v_add_u32 v17, s83, v18
    v_mfma_f32_16x16x32_bf16 v[156:159], a[0:3], a[88:91], v[156:159]
    s_waitcnt lgkmcnt(10)
    v_mfma_f32_16x16x32_bf16 v[172:175], a[4:7], a[88:91], v[172:175]
    s_mov_b32 m0, s98
    ds_read_b64_tr_b16 a[0:1], v17 offset:0
    v_mfma_f32_16x16x32_bf16 v[168:171], a[4:7], a[84:87], v[168:171]
    ds_read_b64_tr_b16 a[2:3], v17 offset:1024
    v_mfma_f32_16x16x32_bf16 v[164:167], a[4:7], a[80:83], v[164:167]
    buffer_load_dwordx4 v8, s[52:55], s97 offen offset:0 lds
    v_mfma_f32_16x16x32_bf16 v[160:163], a[4:7], a[76:79], v[160:163]
    s_waitcnt lgkmcnt(10)
    v_mfma_f32_16x16x32_bf16 v[176:179], a[8:11], a[76:79], v[176:179]
    ds_read_b64_tr_b16 a[4:5], v17 offset:32
    v_mfma_f32_16x16x32_bf16 v[180:183], a[8:11], a[80:83], v[180:183]
    ds_read_b64_tr_b16 a[6:7], v17 offset:1056
    v_mfma_f32_16x16x32_bf16 v[184:187], a[8:11], a[84:87], v[184:187]
    buffer_load_dwordx4 a[68:71], v16, s[32:35], s82 offen offset:2048 sc1
    v_mfma_f32_16x16x32_bf16 v[188:191], a[8:11], a[88:91], v[188:191]
    s_waitcnt lgkmcnt(10)
    v_mfma_f32_16x16x32_bf16 v[204:207], a[12:15], a[88:91], v[204:207]
    ds_read_b64_tr_b16 a[8:9], v17 offset:64
    v_mfma_f32_16x16x32_bf16 v[200:203], a[12:15], a[84:87], v[200:203]
    ds_read_b64_tr_b16 a[10:11], v17 offset:1088
    v_mfma_f32_16x16x32_bf16 v[196:199], a[12:15], a[80:83], v[196:199]
    v_mfma_f32_16x16x32_bf16 v[192:195], a[12:15], a[76:79], v[192:195]
    s_waitcnt lgkmcnt(10)
    v_mfma_f32_16x16x32_bf16 v[208:211], a[16:19], a[76:79], v[208:211]
    ds_read_b64_tr_b16 a[12:13], v17 offset:96
    v_mfma_f32_16x16x32_bf16 v[212:215], a[16:19], a[80:83], v[212:215]
    ds_read_b64_tr_b16 a[14:15], v17 offset:1120
    v_mfma_f32_16x16x32_bf16 v[216:219], a[16:19], a[84:87], v[216:219]
    buffer_load_dwordx4 v9, s[52:55], s97 offen offset:1024 lds
    v_mfma_f32_16x16x32_bf16 v[220:223], a[16:19], a[88:91], v[220:223]
    s_waitcnt lgkmcnt(10)
    v_mfma_f32_16x16x32_bf16 v[236:239], a[20:23], a[88:91], v[236:239]
    ds_read_b64_tr_b16 a[16:17], v17 offset:128
    v_mfma_f32_16x16x32_bf16 v[232:235], a[20:23], a[84:87], v[232:235]
    ds_read_b64_tr_b16 a[18:19], v17 offset:1152
    v_mfma_f32_16x16x32_bf16 v[228:231], a[20:23], a[80:83], v[228:231]
    buffer_load_dwordx4 a[72:75], v16, s[32:35], s82 offen offset:3072 sc1
    v_mfma_f32_16x16x32_bf16 v[224:227], a[20:23], a[76:79], v[224:227]
    s_add_u32 s82, s82, 4096
    s_waitcnt lgkmcnt(10)
    v_mfma_f32_16x16x32_bf16 v[240:243], a[24:27], a[76:79], v[240:243]
    ds_read_b64_tr_b16 a[20:21], v17 offset:160
    v_mfma_f32_16x16x32_bf16 v[244:247], a[24:27], a[80:83], v[244:247]
    ds_read_b64_tr_b16 a[22:23], v17 offset:1184
    v_mfma_f32_16x16x32_bf16 v[248:251], a[24:27], a[84:87], v[248:251]
    v_mfma_f32_16x16x32_bf16 v[252:255], a[24:27], a[88:91], v[252:255]
L_g1_P1:
    s_waitcnt vmcnt(18)
    s_waitcnt lgkmcnt(10)
    v_mfma_f32_16x16x32_bf16 v[44:47], a[0:3], a[40:43], v[44:47]
    ds_read_b64_tr_b16 a[24:25], v17 offset:192
    v_mfma_f32_16x16x32_bf16 v[40:43], a[0:3], a[36:39], v[40:43]
    ds_read_b64_tr_b16 a[26:27], v17 offset:1216
    v_mfma_f32_16x16x32_bf16 v[36:39], a[0:3], a[32:35], v[36:39]
    v_mfma_f32_16x16x32_bf16 v[32:35], a[0:3], a[28:31], v[32:35]
    s_waitcnt lgkmcnt(10)
    v_mfma_f32_16x16x32_bf16 v[48:51], a[4:7], a[28:31], v[48:51]
    ds_read_b64_tr_b16 a[0:1], v17 offset:16384
    v_mfma_f32_16x16x32_bf16 v[52:55], a[4:7], a[32:35], v[52:55]
    ds_read_b64_tr_b16 a[2:3], v17 offset:17408
    v_mfma_f32_16x16x32_bf16 v[56:59], a[4:7], a[36:39], v[56:59]
    buffer_load_dwordx4 v10, s[52:55], s97 offen offset:2048 lds
    v_mfma_f32_16x16x32_bf16 v[60:63], a[4:7], a[40:43], v[60:63]
    s_waitcnt lgkmcnt(10)
    v_mfma_f32_16x16x32_bf16 v[76:79], a[8:11], a[40:43], v[76:79]
    ds_read_b64_tr_b16 a[4:5], v17 offset:16416
    v_mfma_f32_16x16x32_bf16 v[72:75], a[8:11], a[36:39], v[72:75]
    ds_read_b64_tr_b16 a[6:7], v17 offset:17440
    v_mfma_f32_16x16x32_bf16 v[68:71], a[8:11], a[32:35], v[68:71]
    buffer_load_dwordx4 a[76:79], v16, s[32:35], s82 offen offset:0 sc1
    v_mfma_f32_16x16x32_bf16 v[64:67], a[8:11], a[28:31], v[64:67]
    s_waitcnt lgkmcnt(10)
    v_mfma_f32_16x16x32_bf16 v[80:83], a[12:15], a[28:31], v[80:83]
    ds_read_b64_tr_b16 a[8:9], v17 offset:16448
    v_mfma_f32_16x16x32_bf16 v[84:87], a[12:15], a[32:35], v[84:87]
    ds_read_b64_tr_b16 a[10:11], v17 offset:17472
    v_mfma_f32_16x16x32_bf16 v[88:91], a[12:15], a[36:39], v[88:91]
    v_mfma_f32_16x16x32_bf16 v[92:95], a[12:15], a[40:43], v[92:95]
    s_waitcnt lgkmcnt(10)
    v_mfma_f32_16x16x32_bf16 v[108:111], a[16:19], a[40:43], v[108:111]
    ds_read_b64_tr_b16 a[12:13], v17 offset:16480
    v_mfma_f32_16x16x32_bf16 v[104:107], a[16:19], a[36:39], v[104:107]
    ds_read_b64_tr_b16 a[14:15], v17 offset:17504
    v_mfma_f32_16x16x32_bf16 v[100:103], a[16:19], a[32:35], v[100:103]
    buffer_load_dwordx4 v11, s[52:55], s97 offen offset:3072 lds
    v_mfma_f32_16x16x32_bf16 v[96:99], a[16:19], a[28:31], v[96:99]
    s_waitcnt lgkmcnt(10)
    v_mfma_f32_16x16x32_bf16 v[112:115], a[20:23], a[28:31], v[112:115]
    ds_read_b64_tr_b16 a[16:17], v17 offset:16512
    v_mfma_f32_16x16x32_bf16 v[116:119], a[20:23], a[32:35], v[116:119]
    ds_read_b64_tr_b16 a[18:19], v17 offset:17536
    v_mfma_f32_16x16x32_bf16 v[120:123], a[20:23], a[36:39], v[120:123]
    buffer_load_dwordx4 a[80:83], v16, s[32:35], s82 offen offset:1024 sc1
    v_mfma_f32_16x16x32_bf16 v[124:127], a[20:23], a[40:43], v[124:127]
    s_waitcnt lgkmcnt(10)
    v_mfma_f32_16x16x32_bf16 v[140:143], a[24:27], a[40:43], v[140:143]
    ds_read_b64_tr_b16 a[20:21], v17 offset:16544
    v_mfma_f32_16x16x32_bf16 v[136:139], a[24:27], a[36:39], v[136:139]
    ds_read_b64_tr_b16 a[22:23], v17 offset:17568
    v_mfma_f32_16x16x32_bf16 v[132:135], a[24:27], a[32:35], v[132:135]
    buffer_load_dword v0, v21, s[44:47], s88 offen
    v_mfma_f32_16x16x32_bf16 v[128:131], a[24:27], a[28:31], v[128:131]
    s_add_u32 s88, s88, 1024
    s_waitcnt lgkmcnt(10)
    v_mfma_f32_16x16x32_bf16 v[144:147], a[0:3], a[28:31], v[144:147]
    ds_read_b64_tr_b16 a[24:25], v17 offset:16576
    v_mfma_f32_16x16x32_bf16 v[148:151], a[0:3], a[32:35], v[148:151]
    ds_read_b64_tr_b16 a[26:27], v17 offset:17600
    v_mfma_f32_16x16x32_bf16 v[152:155], a[0:3], a[36:39], v[152:155]
    v_mfma_f32_16x16x32_bf16 v[156:159], a[0:3], a[40:43], v[156:159]
    s_waitcnt lgkmcnt(10)
    v_mfma_f32_16x16x32_bf16 v[172:175], a[4:7], a[40:43], v[172:175]
    s_add_u32 m0, s98, 4096
    ds_read_b64_tr_b16 a[0:1], v17 offset:8192
    v_mfma_f32_16x16x32_bf16 v[168:171], a[4:7], a[36:39], v[168:171]
    ds_read_b64_tr_b16 a[2:3], v17 offset:9216
    v_mfma_f32_16x16x32_bf16 v[164:167], a[4:7], a[32:35], v[164:167]
    buffer_load_dwordx4 v12, s[52:55], s97 offen offset:0 lds
    v_mfma_f32_16x16x32_bf16 v[160:163], a[4:7], a[28:31], v[160:163]
    s_waitcnt lgkmcnt(10)
    v_mfma_f32_16x16x32_bf16 v[176:179], a[8:11], a[28:31], v[176:179]
    ds_read_b64_tr_b16 a[4:5], v17 offset:8224
    v_mfma_f32_16x16x32_bf16 v[180:183], a[8:11], a[32:35], v[180:183]
    ds_read_b64_tr_b16 a[6:7], v17 offset:9248
    v_mfma_f32_16x16x32_bf16 v[184:187], a[8:11], a[36:39], v[184:187]
    buffer_load_dwordx4 a[84:87], v16, s[32:35], s82 offen offset:2048 sc1
    v_mfma_f32_16x16x32_bf16 v[188:191], a[8:11], a[40:43], v[188:191]
    s_waitcnt lgkmcnt(10)
    v_mfma_f32_16x16x32_bf16 v[204:207], a[12:15], a[40:43], v[204:207]
    ds_read_b64_tr_b16 a[8:9], v17 offset:8256
    v_mfma_f32_16x16x32_bf16 v[200:203], a[12:15], a[36:39], v[200:203]
    ds_read_b64_tr_b16 a[10:11], v17 offset:9280
    v_mfma_f32_16x16x32_bf16 v[196:199], a[12:15], a[32:35], v[196:199]
    v_mfma_f32_16x16x32_bf16 v[192:195], a[12:15], a[28:31], v[192:195]
    s_waitcnt lgkmcnt(10)
    v_mfma_f32_16x16x32_bf16 v[208:211], a[16:19], a[28:31], v[208:211]
    ds_read_b64_tr_b16 a[12:13], v17 offset:8288
    v_mfma_f32_16x16x32_bf16 v[212:215], a[16:19], a[32:35], v[212:215]
    ds_read_b64_tr_b16 a[14:15], v17 offset:9312
    v_mfma_f32_16x16x32_bf16 v[216:219], a[16:19], a[36:39], v[216:219]
    buffer_load_dwordx4 v13, s[52:55], s97 offen offset:1024 lds
    v_mfma_f32_16x16x32_bf16 v[220:223], a[16:19], a[40:43], v[220:223]
    s_waitcnt lgkmcnt(10)
    v_mfma_f32_16x16x32_bf16 v[236:239], a[20:23], a[40:43], v[236:239]
    ds_read_b64_tr_b16 a[16:17], v17 offset:8320
    v_mfma_f32_16x16x32_bf16 v[232:235], a[20:23], a[36:39], v[232:235]
    ds_read_b64_tr_b16 a[18:19], v17 offset:9344
    v_mfma_f32_16x16x32_bf16 v[228:231], a[20:23], a[32:35], v[228:231]
    buffer_load_dwordx4 a[88:91], v16, s[32:35], s82 offen offset:3072 sc1
    v_mfma_f32_16x16x32_bf16 v[224:227], a[20:23], a[28:31], v[224:227]
    s_add_u32 s82, s82, 4096
    s_waitcnt lgkmcnt(10)
    v_mfma_f32_16x16x32_bf16 v[240:243], a[24:27], a[28:31], v[240:243]
    ds_read_b64_tr_b16 a[20:21], v17 offset:8352
    v_mfma_f32_16x16x32_bf16 v[244:247], a[24:27], a[32:35], v[244:247]
    ds_read_b64_tr_b16 a[22:23], v17 offset:9376
    v_mfma_f32_16x16x32_bf16 v[248:251], a[24:27], a[36:39], v[248:251]
    v_mfma_f32_16x16x32_bf16 v[252:255], a[24:27], a[40:43], v[252:255]
    s_waitcnt vmcnt(13)
    s_waitcnt lgkmcnt(10)
    v_mfma_f32_16x16x32_bf16 v[44:47], a[0:3], a[56:59], v[44:47]
    ds_read_b64_tr_b16 a[24:25], v17 offset:8384
    v_mfma_f32_16x16x32_bf16 v[40:43], a[0:3], a[52:55], v[40:43]
    ds_read_b64_tr_b16 a[26:27], v17 offset:9408
    v_mfma_f32_16x16x32_bf16 v[36:39], a[0:3], a[48:51], v[36:39]
    v_mfma_f32_16x16x32_bf16 v[32:35], a[0:3], a[44:47], v[32:35]
    s_waitcnt lgkmcnt(10)
    v_mfma_f32_16x16x32_bf16 v[48:51], a[4:7], a[44:47], v[48:51]
    ds_read_b64_tr_b16 a[0:1], v17 offset:24576
    v_mfma_f32_16x16x32_bf16 v[52:55], a[4:7], a[48:51], v[52:55]
    ds_read_b64_tr_b16 a[2:3], v17 offset:25600
    v_mfma_f32_16x16x32_bf16 v[56:59], a[4:7], a[52:55], v[56:59]
    buffer_load_dwordx4 v14, s[52:55], s97 offen offset:2048 lds
    v_mfma_f32_16x16x32_bf16 v[60:63], a[4:7], a[56:59], v[60:63]
    s_waitcnt lgkmcnt(10)
    v_mfma_f32_16x16x32_bf16 v[76:79], a[8:11], a[56:59], v[76:79]
    ds_read_b64_tr_b16 a[4:5], v17 offset:24608
    v_mfma_f32_16x16x32_bf16 v[72:75], a[8:11], a[52:55], v[72:75]
    ds_read_b64_tr_b16 a[6:7], v17 offset:25632
    v_mfma_f32_16x16x32_bf16 v[68:71], a[8:11], a[48:51], v[68:71]
    buffer_load_dwordx4 a[28:31], v16, s[32:35], s82 offen offset:0 sc1
    v_mfma_f32_16x16x32_bf16 v[64:67], a[8:11], a[44:47], v[64:67]
    s_waitcnt lgkmcnt(10)
    v_mfma_f32_16x16x32_bf16 v[80:83], a[12:15], a[44:47], v[80:83]
    ds_read_b64_tr_b16 a[8:9], v17 offset:24640
    v_mfma_f32_16x16x32_bf16 v[84:87], a[12:15], a[48:51], v[84:87]
    ds_read_b64_tr_b16 a[10:11], v17 offset:25664
    v_mfma_f32_16x16x32_bf16 v[88:91], a[12:15], a[52:55], v[88:91]
    v_mfma_f32_16x16x32_bf16 v[92:95], a[12:15], a[56:59], v[92:95]
    s_waitcnt lgkmcnt(10)
    v_mfma_f32_16x16x32_bf16 v[108:111], a[16:19], a[56:59], v[108:111]
    ds_read_b64_tr_b16 a[12:13], v17 offset:24672
    v_mfma_f32_16x16x32_bf16 v[104:107], a[16:19], a[52:55], v[104:107]
    ds_read_b64_tr_b16 a[14:15], v17 offset:25696
    v_mfma_f32_16x16x32_bf16 v[100:103], a[16:19], a[48:51], v[100:103]
    buffer_load_dwordx4 v15, s[52:55], s97 offen offset:3072 lds
    v_mfma_f32_16x16x32_bf16 v[96:99], a[16:19], a[44:47], v[96:99]
    s_add_u32 s97, s97, s100
    s_add_u32 s98, s98, 32768
    s_and_b32 s98, s98, 0x1ffff
    s_waitcnt lgkmcnt(10)
    v_mfma_f32_16x16x32_bf16 v[112:115], a[20:23], a[44:47], v[112:115]
    ds_read_b64_tr_b16 a[16:17], v17 offset:24704
    v_mfma_f32_16x16x32_bf16 v[116:119], a[20:23], a[48:51], v[116:119]
    ds_read_b64_tr_b16 a[18:19], v17 offset:25728
    v_mfma_f32_16x16x32_bf16 v[120:123], a[20:23], a[52:55], v[120:123]
    buffer_load_dwordx4 a[32:35], v16, s[32:35], s82 offen offset:1024 sc1
    v_mfma_f32_16x16x32_bf16 v[124:127], a[20:23], a[56:59], v[124:127]
    s_waitcnt lgkmcnt(10)
    v_mfma_f32_16x16x32_bf16 v[140:143], a[24:27], a[56:59], v[140:143]
    ds_read_b64_tr_b16 a[20:21], v17 offset:24736
    v_mfma_f32_16x16x32_bf16 v[136:139], a[24:27], a[52:55], v[136:139]
    ds_read_b64_tr_b16 a[22:23], v17 offset:25760
    v_mfma_f32_16x16x32_bf16 v[132:135], a[24:27], a[48:51], v[132:135]
    buffer_load_dword v0, v6, s[48:51], s101 offen
    v_mfma_f32_16x16x32_bf16 v[128:131], a[24:27], a[44:47], v[128:131]
    s_add_u32 s83, s83, 32768
    s_and_b32 s83, s83, 0x1ffff
    s_waitcnt vmcnt(20)
    s_barrier
    s_waitcnt lgkmcnt(10)
    v_mfma_f32_16x16x32_bf16 v[144:147], a[0:3], a[44:47], v[144:147]
    ds_read_b64_tr_b16 a[24:25], v17 offset:24768
    v_mfma_f32_16x16x32_bf16 v[148:151], a[0:3], a[48:51], v[148:151]
    ds_read_b64_tr_b16 a[26:27], v17 offset:25792
    v_mfma_f32_16x16x32_bf16 v[152:155], a[0:3], a[52:55], v[152:155]
    v_add_u32 v17, s83, v18
    v_mfma_f32_16x16x32_bf16 v[156:159], a[0:3], a[56:59], v[156:159]
    s_waitcnt lgkmcnt(10)
    v_mfma_f32_16x16x32_bf16 v[172:175], a[4:7], a[56:59], v[172:175]
    s_mov_b32 m0, s98
    ds_read_b64_tr_b16 a[0:1], v17 offset:0
    v_mfma_f32_16x16x32_bf16 v[168:171], a[4:7], a[52:55], v[168:171]
    ds_read_b64_tr_b16 a[2:3], v17 offset:1024
    v_mfma_f32_16x16x32_bf16 v[164:167], a[4:7], a[48:51], v[164:167]
    buffer_load_dwordx4 v8, s[52:55], s97 offen offset:0 lds
    v_mfma_f32_16x16x32_bf16 v[160:163], a[4:7], a[44:47], v[160:163]
    s_waitcnt lgkmcnt(10)
    v_mfma_f32_16x16x32_bf16 v[176:179], a[8:11], a[44:47], v[176:179]
    ds_read_b64_tr_b16 a[4:5], v17 offset:32
    v_mfma_f32_16x16x32_bf16 v[180:183], a[8:11], a[48:51], v[180:183]
    ds_read_b64_tr_b16 a[6:7], v17 offset:1056
    v_mfma_f32_16x16x32_bf16 v[184:187], a[8:11], a[52:55], v[184:187]
    buffer_load_dwordx4 a[36:39], v16, s[32:35], s82 offen offset:2048 sc1
    v_mfma_f32_16x16x32_bf16 v[188:191], a[8:11], a[56:59], v[188:191]
    s_waitcnt lgkmcnt(10)
    v_mfma_f32_16x16x32_bf16 v[204:207], a[12:15], a[56:59], v[204:207]
    ds_read_b64_tr_b16 a[8:9], v17 offset:64
    v_mfma_f32_16x16x32_bf16 v[200:203], a[12:15], a[52:55], v[200:203]
    ds_read_b64_tr_b16 a[10:11], v17 offset:1088
    v_mfma_f32_16x16x32_bf16 v[196:199], a[12:15], a[48:51], v[196:199]
    v_mfma_f32_16x16x32_bf16 v[192:195], a[12:15], a[44:47], v[192:195]
    s_waitcnt lgkmcnt(10)
    v_mfma_f32_16x16x32_bf16 v[208:211], a[16:19], a[44:47], v[208:211]
    ds_read_b64_tr_b16 a[12:13], v17 offset:96
    v_mfma_f32_16x16x32_bf16 v[212:215], a[16:19], a[48:51], v[212:215]
    ds_read_b64_tr_b16 a[14:15], v17 offset:1120
    v_mfma_f32_16x16x32_bf16 v[216:219], a[16:19], a[52:55], v[216:219]
    buffer_load_dwordx4 v9, s[52:55], s97 offen offset:1024 lds
    v_mfma_f32_16x16x32_bf16 v[220:223], a[16:19], a[56:59], v[220:223]
    s_waitcnt lgkmcnt(10)
    v_mfma_f32_16x16x32_bf16 v[236:239], a[20:23], a[56:59], v[236:239]
    ds_read_b64_tr_b16 a[16:17], v17 offset:128
    v_mfma_f32_16x16x32_bf16 v[232:235], a[20:23], a[52:55], v[232:235]
    ds_read_b64_tr_b16 a[18:19], v17 offset:1152
    v_mfma_f32_16x16x32_bf16 v[228:231], a[20:23], a[48:51], v[228:231]
    buffer_load_dwordx4 a[40:43], v16, s[32:35], s82 offen offset:3072 sc1
    v_mfma_f32_16x16x32_bf16 v[224:227], a[20:23], a[44:47], v[224:227]
    s_add_u32 s82, s82, 4096
    s_waitcnt lgkmcnt(10)
    v_mfma_f32_16x16x32_bf16 v[240:243], a[24:27], a[44:47], v[240:243]
    ds_read_b64_tr_b16 a[20:21], v17 offset:160
    v_mfma_f32_16x16x32_bf16 v[244:247], a[24:27], a[48:51], v[244:247]
    ds_read_b64_tr_b16 a[22:23], v17 offset:1184
    v_mfma_f32_16x16x32_bf16 v[248:251], a[24:27], a[52:55], v[248:251]
    v_mfma_f32_16x16x32_bf16 v[252:255], a[24:27], a[56:59], v[252:255]
    s_waitcnt vmcnt(18)
    s_waitcnt lgkmcnt(10)
    v_mfma_f32_16x16x32_bf16 v[44:47], a[0:3], a[72:75], v[44:47]
    ds_read_b64_tr_b16 a[24:25], v17 offset:192
    v_mfma_f32_16x16x32_bf16 v[40:43], a[0:3], a[68:71], v[40:43]
    ds_read_b64_tr_b16 a[26:27], v17 offset:1216
    v_mfma_f32_16x16x32_bf16 v[36:39], a[0:3], a[64:67], v[36:39]
    v_mfma_f32_16x16x32_bf16 v[32:35], a[0:3], a[60:63], v[32:35]
    s_waitcnt lgkmcnt(10)
    v_mfma_f32_16x16x32_bf16 v[48:51], a[4:7], a[60:63], v[48:51]
    ds_read_b64_tr_b16 a[0:1], v17 offset:16384
    v_mfma_f32_16x16x32_bf16 v[52:55], a[4:7], a[64:67], v[52:55]
    ds_read_b64_tr_b16 a[2:3], v17 offset:17408
    v_mfma_f32_16x16x32_bf16 v[56:59], a[4:7], a[68:71], v[56:59]
    buffer_load_dwordx4 v10, s[52:55], s97 offen offset:2048 lds
    v_mfma_f32_16x16x32_bf16 v[60:63], a[4:7], a[72:75], v[60:63]
    s_waitcnt lgkmcnt(10)
    v_mfma_f32_16x16x32_bf16 v[76:79], a[8:11], a[72:75], v[76:79]
    ds_read_b64_tr_b16 a[4:5], v17 offset:16416
    v_mfma_f32_16x16x32_bf16 v[72:75], a[8:11], a[68:71], v[72:75]
    ds_read_b64_tr_b16 a[6:7], v17 offset:17440
    v_mfma_f32_16x16x32_bf16 v[68:71], a[8:11], a[64:67], v[68:71]
    buffer_load_dwordx4 a[44:47], v16, s[32:35], s82 offen offset:0 sc1
    v_mfma_f32_16x16x32_bf16 v[64:67], a[8:11], a[60:63], v[64:67]
    s_waitcnt lgkmcnt(10)
    v_mfma_f32_16x16x32_bf16 v[80:83], a[12:15], a[60:63], v[80:83]
    ds_read_b64_tr_b16 a[8:9], v17 offset:16448
    v_mfma_f32_16x16x32_bf16 v[84:87], a[12:15], a[64:67], v[84:87]
    ds_read_b64_tr_b16 a[10:11], v17 offset:17472
    v_mfma_f32_16x16x32_bf16 v[88:91], a[12:15], a[68:71], v[88:91]
    v_mfma_f32_16x16x32_bf16 v[92:95], a[12:15], a[72:75], v[92:95]
    s_waitcnt lgkmcnt(10)
    v_mfma_f32_16x16x32_bf16 v[108:111], a[16:19], a[72:75], v[108:111]
    ds_read_b64_tr_b16 a[12:13], v17 offset:16480
    v_mfma_f32_16x16x32_bf16 v[104:107], a[16:19], a[68:71], v[104:107]
    ds_read_b64_tr_b16 a[14:15], v17 offset:17504
    v_mfma_f32_16x16x32_bf16 v[100:103], a[16:19], a[64:67], v[100:103]
    buffer_load_dwordx4 v11, s[52:55], s97 offen offset:3072 lds
    v_mfma_f32_16x16x32_bf16 v[96:99], a[16:19], a[60:63], v[96:99]
    s_waitcnt lgkmcnt(10)
    v_mfma_f32_16x16x32_bf16 v[112:115], a[20:23], a[60:63], v[112:115]
    ds_read_b64_tr_b16 a[16:17], v17 offset:16512
    v_mfma_f32_16x16x32_bf16 v[116:119], a[20:23], a[64:67], v[116:119]
    ds_read_b64_tr_b16 a[18:19], v17 offset:17536
    v_mfma_f32_16x16x32_bf16 v[120:123], a[20:23], a[68:71], v[120:123]
    buffer_load_dwordx4 a[48:51], v16, s[32:35], s82 offen offset:1024 sc1
    v_mfma_f32_16x16x32_bf16 v[124:127], a[20:23], a[72:75], v[124:127]
    s_waitcnt lgkmcnt(10)
    v_mfma_f32_16x16x32_bf16 v[140:143], a[24:27], a[72:75], v[140:143]
    s_mov_b32 m0, s89
    ds_read_b64_tr_b16 a[20:21], v17 offset:16544
    v_mfma_f32_16x16x32_bf16 v[136:139], a[24:27], a[68:71], v[136:139]
    ds_read_b64_tr_b16 a[22:23], v17 offset:17568
    v_mfma_f32_16x16x32_bf16 v[132:135], a[24:27], a[64:67], v[132:135]
    buffer_load_dwordx4 v28, s[68:71], s72 offen lds
    v_mfma_f32_16x16x32_bf16 v[128:131], a[24:27], a[60:63], v[128:131]
    s_add_u32 s72, s72, 32768
    s_add_u32 s89, s89, 1024
    s_waitcnt lgkmcnt(10)
    v_mfma_f32_16x16x32_bf16 v[144:147], a[0:3], a[60:63], v[144:147]
    ds_read_b64_tr_b16 a[24:25], v17 offset:16576
    v_mfma_f32_16x16x32_bf16 v[148:151], a[0:3], a[64:67], v[148:151]
    ds_read_b64_tr_b16 a[26:27], v17 offset:17600
    v_mfma_f32_16x16x32_bf16 v[152:155], a[0:3], a[68:71], v[152:155]
    v_mfma_f32_16x16x32_bf16 v[156:159], a[0:3], a[72:75], v[156:159]
    s_waitcnt lgkmcnt(10)
    v_mfma_f32_16x16x32_bf16 v[172:175], a[4:7], a[72:75], v[172:175]
    s_add_u32 m0, s98, 4096
    ds_read_b64_tr_b16 a[0:1], v17 offset:8192
    v_mfma_f32_16x16x32_bf16 v[168:171], a[4:7], a[68:71], v[168:171]
    ds_read_b64_tr_b16 a[2:3], v17 offset:9216
    v_mfma_f32_16x16x32_bf16 v[164:167], a[4:7], a[64:67], v[164:167]
    buffer_load_dwordx4 v12, s[52:55], s97 offen offset:0 lds
    v_mfma_f32_16x16x32_bf16 v[160:163], a[4:7], a[60:63], v[160:163]
    s_waitcnt lgkmcnt(10)
    v_mfma_f32_16x16x32_bf16 v[176:179], a[8:11], a[60:63], v[176:179]
    ds_read_b64_tr_b16 a[4:5], v17 offset:8224
    v_mfma_f32_16x16x32_bf16 v[180:183], a[8:11], a[64:67], v[180:183]
    ds_read_b64_tr_b16 a[6:7], v17 offset:9248
    v_mfma_f32_16x16x32_bf16 v[184:187], a[8:11], a[68:71], v[184:187]
    buffer_load_dwordx4 a[52:55], v16, s[32:35], s82 offen offset:2048 sc1
    v_mfma_f32_16x16x32_bf16 v[188:191], a[8:11], a[72:75], v[188:191]
    s_waitcnt lgkmcnt(10)
    v_mfma_f32_16x16x32_bf16 v[204:207], a[12:15], a[72:75], v[204:207]
    ds_read_b64_tr_b16 a[8:9], v17 offset:8256
    v_mfma_f32_16x16x32_bf16 v[200:203], a[12:15], a[68:71], v[200:203]
    ds_read_b64_tr_b16 a[10:11], v17 offset:9280
    v_mfma_f32_16x16x32_bf16 v[196:199], a[12:15], a[64:67], v[196:199]
    v_mfma_f32_16x16x32_bf16 v[192:195], a[12:15], a[60:63], v[192:195]
    s_waitcnt lgkmcnt(10)
    v_mfma_f32_16x16x32_bf16 v[208:211], a[16:19], a[60:63], v[208:211]
    ds_read_b64_tr_b16 a[12:13], v17 offset:8288
    v_mfma_f32_16x16x32_bf16 v[212:215], a[16:19], a[64:67], v[212:215]
    ds_read_b64_tr_b16 a[14:15], v17 offset:9312
    v_mfma_f32_16x16x32_bf16 v[216:219], a[16:19], a[68:71], v[216:219]
    buffer_load_dwordx4 v13, s[52:55], s97 offen offset:1024 lds
    v_mfma_f32_16x16x32_bf16 v[220:223], a[16:19], a[72:75], v[220:223]
    s_waitcnt lgkmcnt(10)
    v_mfma_f32_16x16x32_bf16 v[236:239], a[20:23], a[72:75], v[236:239]
    ds_read_b64_tr_b16 a[16:17], v17 offset:8320
    v_mfma_f32_16x16x32_bf16 v[232:235], a[20:23], a[68:71], v[232:235]
    ds_read_b64_tr_b16 a[18:19], v17 offset:9344
    v_mfma_f32_16x16x32_bf16 v[228:231], a[20:23], a[64:67], v[228:231]
    buffer_load_dwordx4 a[56:59], v16, s[32:35], s82 offen offset:3072 sc1
    v_mfma_f32_16x16x32_bf16 v[224:227], a[20:23], a[60:63], v[224:227]
    s_add_u32 s82, s82, 4096
    s_waitcnt lgkmcnt(10)
    v_mfma_f32_16x16x32_bf16 v[240:243], a[24:27], a[60:63], v[240:243]
    ds_read_b64_tr_b16 a[20:21], v17 offset:8352
    v_mfma_f32_16x16x32_bf16 v[244:247], a[24:27], a[64:67], v[244:247]
    ds_read_b64_tr_b16 a[22:23], v17 offset:9376
    v_mfma_f32_16x16x32_bf16 v[248:251], a[24:27], a[68:71], v[248:251]
    buffer_load_dword v0, v6, s[4:7], s101 offen
    v_mfma_f32_16x16x32_bf16 v[252:255], a[24:27], a[72:75], v[252:255]
    s_add_u32 s101, s101, 917504
    s_waitcnt vmcnt(13)
    s_waitcnt lgkmcnt(10)
    v_mfma_f32_16x16x32_bf16 v[44:47], a[0:3], a[88:91], v[44:47]
    ds_read_b64_tr_b16 a[24:25], v17 offset:8384
    v_mfma_f32_16x16x32_bf16 v[40:43], a[0:3], a[84:87], v[40:43]
    ds_read_b64_tr_b16 a[26:27], v17 offset:9408
    v_mfma_f32_16x16x32_bf16 v[36:39], a[0:3], a[80:83], v[36:39]
    v_mfma_f32_16x16x32_bf16 v[32:35], a[0:3], a[76:79], v[32:35]
    s_waitcnt lgkmcnt(10)
    v_mfma_f32_16x16x32_bf16 v[48:51], a[4:7], a[76:79], v[48:51]
    ds_read_b64_tr_b16 a[0:1], v17 offset:24576
    v_mfma_f32_16x16x32_bf16 v[52:55], a[4:7], a[80:83], v[52:55]
    ds_read_b64_tr_b16 a[2:3], v17 offset:25600
    v_mfma_f32_16x16x32_bf16 v[56:59], a[4:7], a[84:87], v[56:59]
    buffer_load_dwordx4 v14, s[52:55], s97 offen offset:2048 lds
    v_mfma_f32_16x16x32_bf16 v[60:63], a[4:7], a[88:91], v[60:63]
    s_waitcnt lgkmcnt(10)
    v_mfma_f32_16x16x32_bf16 v[76:79], a[8:11], a[88:91], v[76:79]
    ds_read_b64_tr_b16 a[4:5], v17 offset:24608
    v_mfma_f32_16x16x32_bf16 v[72:75], a[8:11], a[84:87], v[72:75]
    ds_read_b64_tr_b16 a[6:7], v17 offset:25632
    v_mfma_f32_16x16x32_bf16 v[68:71], a[8:11], a[80:83], v[68:71]
    buffer_load_dwordx4 a[60:63], v16, s[32:35], s82 offen offset:0 sc1
    v_mfma_f32_16x16x32_bf16 v[64:67], a[8:11], a[76:79], v[64:67]
    s_waitcnt lgkmcnt(10)
    v_mfma_f32_16x16x32_bf16 v[80:83], a[12:15], a[76:79], v[80:83]
    ds_read_b64_tr_b16 a[8:9], v17 offset:24640
    v_mfma_f32_16x16x32_bf16 v[84:87], a[12:15], a[80:83], v[84:87]
    ds_read_b64_tr_b16 a[10:11], v17 offset:25664
    v_mfma_f32_16x16x32_bf16 v[88:91], a[12:15], a[84:87], v[88:91]
    v_mfma_f32_16x16x32_bf16 v[92:95], a[12:15], a[88:91], v[92:95]
    s_waitcnt lgkmcnt(10)
    v_mfma_f32_16x16x32_bf16 v[108:111], a[16:19], a[88:91], v[108:111]
    ds_read_b64_tr_b16 a[12:13], v17 offset:24672
    v_mfma_f32_16x16x32_bf16 v[104:107], a[16:19], a[84:87], v[104:107]
    ds_read_b64_tr_b16 a[14:15], v17 offset:25696
    v_mfma_f32_16x16x32_bf16 v[100:103], a[16:19], a[80:83], v[100:103]
    buffer_load_dwordx4 v15, s[52:55], s97 offen offset:3072 lds
    v_mfma_f32_16x16x32_bf16 v[96:99], a[16:19], a[76:79], v[96:99]
    s_add_u32 s97, s97, s100
    s_add_u32 s98, s98, 32768
    s_and_b32 s98, s98, 0x1ffff
    s_waitcnt lgkmcnt(10)
    v_mfma_f32_16x16x32_bf16 v[112:115], a[20:23], a[76:79], v[112:115]
    ds_read_b64_tr_b16 a[16:17], v17 offset:24704
    v_mfma_f32_16x16x32_bf16 v[116:119], a[20:23], a[80:83], v[116:119]
    ds_read_b64_tr_b16 a[18:19], v17 offset:25728
    v_mfma_f32_16x16x32_bf16 v[120:123], a[20:23], a[84:87], v[120:123]
    buffer_load_dwordx4 a[64:67], v16, s[32:35], s82 offen offset:1024 sc1
    v_mfma_f32_16x16x32_bf16 v[124:127], a[20:23], a[88:91], v[124:127]
    s_waitcnt lgkmcnt(10)
    v_mfma_f32_16x16x32_bf16 v[140:143], a[24:27], a[88:91], v[140:143]
    ds_read_b64_tr_b16 a[20:21], v17 offset:24736
    v_mfma_f32_16x16x32_bf16 v[136:139], a[24:27], a[84:87], v[136:139]
    ds_read_b64_tr_b16 a[22:23], v17 offset:25760
    v_mfma_f32_16x16x32_bf16 v[132:135], a[24:27], a[80:83], v[132:135]
    global_load_dword v0, v23, s[78:79]
    v_mfma_f32_16x16x32_bf16 v[128:131], a[24:27], a[76:79], v[128:131]
    s_cmp_ge_u32 s84, 5
    s_cselect_b32 s99, -1, 0
    v_and_b32 v23, s99, v24
    s_add_u32 s84, s84, 1
    s_cmp_lt_u32 s84, 8
    s_cbranch_scc1 L_g1_loop
L_g1epi:
    s_waitcnt lgkmcnt(10)
    v_mfma_f32_16x16x32_bf16 v[144:147], a[0:3], a[76:79], v[144:147]
    ds_read_b64_tr_b16 a[24:25], v17 offset:24768
    v_mfma_f32_16x16x32_bf16 v[148:151], a[0:3], a[80:83], v[148:151]
    ds_read_b64_tr_b16 a[26:27], v17 offset:25792
    v_mfma_f32_16x16x32_bf16 v[152:155], a[0:3], a[84:87], v[152:155]
    v_mfma_f32_16x16x32_bf16 v[156:159], a[0:3], a[88:91], v[156:159]
    s_waitcnt lgkmcnt(10)
    v_mfma_f32_16x16x32_bf16 v[172:175], a[4:7], a[88:91], v[172:175]
    v_mfma_f32_16x16x32_bf16 v[168:171], a[4:7], a[84:87], v[168:171]
    v_mfma_f32_16x16x32_bf16 v[164:167], a[4:7], a[80:83], v[164:167]
    v_mfma_f32_16x16x32_bf16 v[160:163], a[4:7], a[76:79], v[160:163]
    s_waitcnt lgkmcnt(8)
    v_mfma_f32_16x16x32_bf16 v[176:179], a[8:11], a[76:79], v[176:179]
    v_mfma_f32_16x16x32_bf16 v[180:183], a[8:11], a[80:83], v[180:183]
    v_mfma_f32_16x16x32_bf16 v[184:187], a[8:11], a[84:87], v[184:187]
    v_mfma_f32_16x16x32_bf16 v[188:191], a[8:11], a[88:91], v[188:191]
    s_waitcnt lgkmcnt(6)
    v_mfma_f32_16x16x32_bf16 v[204:207], a[12:15], a[88:91], v[204:207]
    v_mfma_f32_16x16x32_bf16 v[200:203], a[12:15], a[84:87], v[200:203]
    v_mfma_f32_16x16x32_bf16 v[196:199], a[12:15], a[80:83], v[196:199]
    v_mfma_f32_16x16x32_bf16 v[192:195], a[12:15], a[76:79], v[192:195]
    s_waitcnt lgkmcnt(4)
    v_mfma_f32_16x16x32_bf16 v[208:211], a[16:19], a[76:79], v[208:211]
    v_mfma_f32_16x16x32_bf16 v[212:215], a[16:19], a[80:83], v[212:215]
    v_mfma_f32_16x16x32_bf16 v[216:219], a[16:19], a[84:87], v[216:219]
    v_mfma_f32_16x16x32_bf16 v[220:223], a[16:19], a[88:91], v[220:223]
    s_waitcnt lgkmcnt(2)
    v_mfma_f32_16x16x32_bf16 v[236:239], a[20:23], a[88:91], v[236:239]
    v_mfma_f32_16x16x32_bf16 v[232:235], a[20:23], a[84:87], v[232:235]
    v_mfma_f32_16x16x32_bf16 v[228:231], a[20:23], a[80:83], v[228:231]
    v_mfma_f32_16x16x32_bf16 v[224:227], a[20:23], a[76:79], v[224:227]
    s_waitcnt lgkmcnt(0)
    v_mfma_f32_16x16x32_bf16 v[240:243], a[24:27], a[76:79], v[240:243]
    v_mfma_f32_16x16x32_bf16 v[244:247], a[24:27], a[80:83], v[244:247]
    v_mfma_f32_16x16x32_bf16 v[248:251], a[24:27], a[84:87], v[248:251]
    v_mfma_f32_16x16x32_bf16 v[252:255], a[24:27], a[88:91], v[252:255]
    s_mov_b32 s58, 0xbfb8aa3b
    s_mov_b32 s59, 0xbfb8aa3b
    buffer_store_dwordx4 a[92:95], v16, s[40:43], s96 offen offset:0 sc1
    buffer_store_dwordx4 a[96:99], v16, s[40:43], s96 offen offset:1024 sc1
    buffer_store_dwordx4 a[100:103], v16, s[40:43], s96 offen offset:2048 sc1
    buffer_store_dwordx4 a[104:107], v16, s[40:43], s96 offen offset:3072 sc1
    s_mov_b32 s80, s74
    s_mov_b32 s81, s75
    s_mov_b32 s82, s76
    s_mul_i32 s98, s30, 40960
    v_add_u32 v3, s98, v7
    v_xor_b32 v4, 32, v3
    s_add_u32 s56, s73, 98304
    v_add_u32 v5, s56, v7
    v_xor_b32 v6, 32, v5
    s_mov_b32 s72, s97
    s_sub_u32 s56, s73, 32768
    v_add_u32 v18, s56, v7
    v_xor_b32 v19, 32, v18
    v_lshlrev_b32 v17, 3, v2
    v_pk_mul_f32 v[8:9], v[32:33], s[58:59]
    v_pk_mul_f32 v[10:11], v[34:35], s[58:59]
    s_waitcnt vmcnt(4)
    v_pk_mul_f32 v[12:13], v[48:49], s[58:59]
    v_pk_mul_f32 v[14:15], v[50:51], s[58:59]
    ds_read_b64_tr_b16 a[192:193], v5 offset:0
    v_exp_f32 v8, v8
    v_exp_f32 v9, v9
    ds_read_b64_tr_b16 a[194:195], v5 offset:1024
    v_exp_f32 v10, v10
    v_exp_f32 v11, v11
    ds_read_b64_tr_b16 a[196:197], v6 offset:0
    v_exp_f32 v12, v12
    v_exp_f32 v13, v13
    ds_read_b64_tr_b16 a[198:199], v6 offset:1024
    v_exp_f32 v14, v14
    v_exp_f32 v15, v15
    ds_read_b64_tr_b16 a[200:201], v5 offset:2048
    v_pk_add_f32 v[8:9], v[8:9], 1.0 op_sel_hi:[1,0]
    v_pk_add_f32 v[10:11], v[10:11], 1.0 op_sel_hi:[1,0]
    ds_read_b64_tr_b16 a[202:203], v5 offset:3072
    v_pk_add_f32 v[12:13], v[12:13], 1.0 op_sel_hi:[1,0]
    v_pk_add_f32 v[14:15], v[14:15], 1.0 op_sel_hi:[1,0]
    ds_read_b64_tr_b16 a[204:205], v6 offset:2048
    v_rcp_f32 v8, v8
    v_rcp_f32 v9, v9
    ds_read_b64_tr_b16 a[206:207], v6 offset:3072
    v_rcp_f32 v10, v10
    v_rcp_f32 v11, v11
    ds_read_b64_tr_b16 a[208:209], v5 offset:4096
    v_rcp_f32 v12, v12
    v_rcp_f32 v13, v13
    ds_read_b64_tr_b16 a[210:211], v5 offset:5120
    v_rcp_f32 v14, v14
    v_rcp_f32 v15, v15
    ds_read_b64_tr_b16 a[212:213], v6 offset:4096
    v_pk_mul_f32 v[32:33], v[32:33], v[144:145]
    v_pk_mul_f32 v[34:35], v[34:35], v[146:147]
    ds_read_b64_tr_b16 a[214:215], v6 offset:5120
    v_pk_mul_f32 v[48:49], v[48:49], v[160:161]
    v_pk_mul_f32 v[50:51], v[50:51], v[162:163]
    v_pk_mul_f32 v[8:9], v[8:9], v[32:33]
    v_pk_mul_f32 v[10:11], v[10:11], v[34:35]
    v_pk_mul_f32 v[12:13], v[12:13], v[48:49]
    v_pk_mul_f32 v[14:15], v[14:15], v[50:51]
    v_cvt_pk_bf16_f32 v20, v8, v9
    v_cvt_pk_bf16_f32 v21, v10, v11
    v_cvt_pk_bf16_f32 v22, v12, v13
    v_cvt_pk_bf16_f32 v23, v14, v15
    buffer_store_dwordx4 v[20:23], v16, s[36:39], s85 offen offset:0 sc1
    v_pk_mul_f32 v[8:9], v[64:65], s[58:59]
    v_pk_mul_f32 v[10:11], v[66:67], s[58:59]
    ds_read_b64_tr_b16 a[216:217], v5 offset:6144
    v_pk_mul_f32 v[12:13], v[80:81], s[58:59]
    v_pk_mul_f32 v[14:15], v[82:83], s[58:59]
    ds_read_b64_tr_b16 a[218:219], v5 offset:7168
    v_exp_f32 v8, v8
    v_exp_f32 v9, v9
    ds_read_b64_tr_b16 a[220:221], v6 offset:6144
    v_exp_f32 v10, v10
    v_exp_f32 v11, v11
    ds_read_b64_tr_b16 a[222:223], v6 offset:7168
    v_exp_f32 v12, v12
    v_exp_f32 v13, v13
    ds_read_b64_tr_b16 a[224:225], v18 offset:0
    v_exp_f32 v14, v14
    v_exp_f32 v15, v15
    ds_read_b64_tr_b16 a[226:227], v18 offset:1024
    v_pk_add_f32 v[8:9], v[8:9], 1.0 op_sel_hi:[1,0]
    v_pk_add_f32 v[10:11], v[10:11], 1.0 op_sel_hi:[1,0]
    ds_read_b64_tr_b16 a[228:229], v19 offset:0
    v_pk_add_f32 v[12:13], v[12:13], 1.0 op_sel_hi:[1,0]
    v_pk_add_f32 v[14:15], v[14:15], 1.0 op_sel_hi:[1,0]
    ds_read_b64_tr_b16 a[230:231], v19 offset:1024
    v_rcp_f32 v8, v8
    v_rcp_f32 v9, v9
    ds_read_b64_tr_b16 a[232:233], v18 offset:2048
    v_rcp_f32 v10, v10
    v_rcp_f32 v11, v11
    ds_read_b64_tr_b16 a[234:235], v18 offset:3072
    v_rcp_f32 v12, v12
    v_rcp_f32 v13, v13
    ds_read_b64_tr_b16 a[236:237], v19 offset:2048
    v_rcp_f32 v14, v14
    v_rcp_f32 v15, v15
    ds_read_b64_tr_b16 a[238:239], v19 offset:3072
    v_pk_mul_f32 v[64:65], v[64:65], v[176:177]
    v_pk_mul_f32 v[66:67], v[66:67], v[178:179]
    v_pk_mul_f32 v[80:81], v[80:81], v[192:193]
    v_pk_mul_f32 v[82:83], v[82:83], v[194:195]
    v_pk_mul_f32 v[8:9], v[8:9], v[64:65]
    v_pk_mul_f32 v[10:11], v[10:11], v[66:67]
    v_pk_mul_f32 v[12:13], v[12:13], v[80:81]
    v_pk_mul_f32 v[14:15], v[14:15], v[82:83]
    v_cvt_pk_bf16_f32 v24, v8, v9
    v_cvt_pk_bf16_f32 v25, v10, v11
    v_cvt_pk_bf16_f32 v26, v12, v13
    v_cvt_pk_bf16_f32 v27, v14, v15
    buffer_store_dwordx4 v[24:27], v16, s[36:39], s85 offen offset:1024 sc1
    v_pk_mul_f32 v[8:9], v[96:97], s[58:59]
    v_pk_mul_f32 v[10:11], v[98:99], s[58:59]
    ds_read_b64_tr_b16 a[240:241], v18 offset:4096
    v_pk_mul_f32 v[12:13], v[112:113], s[58:59]
    v_pk_mul_f32 v[14:15], v[114:115], s[58:59]
    ds_read_b64_tr_b16 a[242:243], v18 offset:5120
    v_exp_f32 v8, v8
    v_exp_f32 v9, v9
    ds_read_b64_tr_b16 a[244:245], v19 offset:4096
    v_exp_f32 v10, v10
    v_exp_f32 v11, v11
    ds_read_b64_tr_b16 a[246:247], v19 offset:5120
    v_exp_f32 v12, v12
    v_exp_f32 v13, v13
    ds_read_b64_tr_b16 a[248:249], v18 offset:6144
    v_exp_f32 v14, v14
    v_exp_f32 v15, v15
    ds_read_b64_tr_b16 a[250:251], v18 offset:7168
    v_pk_add_f32 v[8:9], v[8:9], 1.0 op_sel_hi:[1,0]
    v_pk_add_f32 v[10:11], v[10:11], 1.0 op_sel_hi:[1,0]
    ds_read_b64_tr_b16 a[252:253], v19 offset:6144
    v_pk_add_f32 v[12:13], v[12:13], 1.0 op_sel_hi:[1,0]
    v_pk_add_f32 v[14:15], v[14:15], 1.0 op_sel_hi:[1,0]
    ds_read_b64_tr_b16 a[254:255], v19 offset:7168
    v_rcp_f32 v8, v8
    v_rcp_f32 v9, v9
    ds_read_b64_tr_b16 a[0:1], v18 offset:32768
    v_rcp_f32 v10, v10
    v_rcp_f32 v11, v11
    ds_read_b64_tr_b16 a[2:3], v18 offset:33792
    v_rcp_f32 v12, v12
    v_rcp_f32 v13, v13
    ds_read_b64_tr_b16 a[4:5], v19 offset:32768
    v_rcp_f32 v14, v14
    v_rcp_f32 v15, v15
    ds_read_b64_tr_b16 a[6:7], v19 offset:33792
    v_pk_mul_f32 v[96:97], v[96:97], v[208:209]
    v_pk_mul_f32 v[98:99], v[98:99], v[210:211]
    v_pk_mul_f32 v[112:113], v[112:113], v[224:225]
    v_pk_mul_f32 v[114:115], v[114:115], v[226:227]
    v_pk_mul_f32 v[8:9], v[8:9], v[96:97]
    v_pk_mul_f32 v[10:11], v[10:11], v[98:99]
    v_pk_mul_f32 v[12:13], v[12:13], v[112:113]
    v_pk_mul_f32 v[14:15], v[14:15], v[114:115]
    v_cvt_pk_bf16_f32 v20, v8, v9
    v_cvt_pk_bf16_f32 v21, v10, v11
    v_cvt_pk_bf16_f32 v22, v12, v13
    v_cvt_pk_bf16_f32 v23, v14, v15
    buffer_store_dwordx4 v[20:23], v16, s[36:39], s85 offen offset:2048 sc1
    v_pk_mul_f32 v[8:9], v[128:129], s[58:59]
    ds_read_b64_tr_b16 a[8:9], v18 offset:34816
    v_pk_mul_f32 v[10:11], v[130:131], s[58:59]
    ds_read_b64_tr_b16 a[10:11], v18 offset:35840
    v_exp_f32 v8, v8
    ds_read_b64_tr_b16 a[12:13], v19 offset:34816
    v_exp_f32 v9, v9
    ds_read_b64_tr_b16 a[14:15], v19 offset:35840
    v_exp_f32 v10, v10
    ds_read_b64_tr_b16 a[16:17], v18 offset:36864
    v_exp_f32 v11, v11
    ds_read_b64_tr_b16 a[18:19], v18 offset:37888
    v_pk_add_f32 v[8:9], v[8:9], 1.0 op_sel_hi:[1,0]
    ds_read_b64_tr_b16 a[20:21], v19 offset:36864
    v_pk_add_f32 v[10:11], v[10:11], 1.0 op_sel_hi:[1,0]
    ds_read_b64_tr_b16 a[22:23], v19 offset:37888
    v_rcp_f32 v8, v8
    ds_read_b64_tr_b16 a[24:25], v18 offset:38912
    v_rcp_f32 v9, v9
    ds_read_b64_tr_b16 a[26:27], v18 offset:39936
    v_rcp_f32 v10, v10
    ds_read_b64_tr_b16 a[28:29], v19 offset:38912
    v_rcp_f32 v11, v11
    ds_read_b64_tr_b16 a[30:31], v19 offset:39936
    v_pk_mul_f32 v[128:129], v[128:129], v[240:241]
    v_pk_mul_f32 v[130:131], v[130:131], v[242:243]
    v_pk_mul_f32 v[8:9], v[8:9], v[128:129]
    v_pk_mul_f32 v[10:11], v[10:11], v[130:131]
    v_cvt_pk_bf16_f32 v24, v8, v9
    v_cvt_pk_bf16_f32 v25, v10, v11
    buffer_store_dwordx2 v[24:25], v17, s[36:39], s86 offen sc1
    s_add_u32 s85, s85, 114688
    s_add_u32 s86, s86, 114688
    v_pk_mul_f32 v[8:9], v[36:37], s[58:59]
    v_pk_mul_f32 v[10:11], v[38:39], s[58:59]
    v_pk_mul_f32 v[12:13], v[52:53], s[58:59]
    v_pk_mul_f32 v[14:15], v[54:55], s[58:59]
    v_exp_f32 v8, v8
    v_exp_f32 v9, v9
    v_exp_f32 v10, v10
    v_exp_f32 v11, v11
    v_exp_f32 v12, v12
    v_exp_f32 v13, v13
    v_exp_f32 v14, v14
    v_exp_f32 v15, v15
    v_pk_add_f32 v[8:9], v[8:9], 1.0 op_sel_hi:[1,0]
    v_pk_add_f32 v[10:11], v[10:11], 1.0 op_sel_hi:[1,0]
    v_pk_add_f32 v[12:13], v[12:13], 1.0 op_sel_hi:[1,0]
    v_pk_add_f32 v[14:15], v[14:15], 1.0 op_sel_hi:[1,0]
    v_rcp_f32 v8, v8
    v_rcp_f32 v9, v9
    v_rcp_f32 v10, v10
    v_rcp_f32 v11, v11
    v_rcp_f32 v12, v12
    v_rcp_f32 v13, v13
    v_rcp_f32 v14, v14
    v_rcp_f32 v15, v15
    v_pk_mul_f32 v[36:37], v[36:37], v[148:149]
    v_pk_mul_f32 v[38:39], v[38:39], v[150:151]
    v_pk_mul_f32 v[52:53], v[52:53], v[164:165]
    v_pk_mul_f32 v[54:55], v[54:55], v[166:167]
    v_pk_mul_f32 v[8:9], v[8:9], v[36:37]
    v_pk_mul_f32 v[10:11], v[10:11], v[38:39]
    v_pk_mul_f32 v[12:13], v[12:13], v[52:53]
    v_pk_mul_f32 v[14:15], v[14:15], v[54:55]
    v_cvt_pk_bf16_f32 v20, v8, v9
    v_cvt_pk_bf16_f32 v21, v10, v11
    v_cvt_pk_bf16_f32 v22, v12, v13
    v_cvt_pk_bf16_f32 v23, v14, v15
    buffer_store_dwordx4 v[20:23], v16, s[36:39], s85 offen offset:0 sc1
    v_pk_mul_f32 v[8:9], v[68:69], s[58:59]
    v_pk_mul_f32 v[10:11], v[70:71], s[58:59]
    v_pk_mul_f32 v[12:13], v[84:85], s[58:59]
    v_pk_mul_f32 v[14:15], v[86:87], s[58:59]
    v_exp_f32 v8, v8
    v_exp_f32 v9, v9
    v_exp_f32 v10, v10
    v_exp_f32 v11, v11
    v_exp_f32 v12, v12
    v_exp_f32 v13, v13
    v_exp_f32 v14, v14
    v_exp_f32 v15, v15
    v_pk_add_f32 v[8:9], v[8:9], 1.0 op_sel_hi:[1,0]
    v_pk_add_f32 v[10:11], v[10:11], 1.0 op_sel_hi:[1,0]
    v_pk_add_f32 v[12:13], v[12:13], 1.0 op_sel_hi:[1,0]
    v_pk_add_f32 v[14:15], v[14:15], 1.0 op_sel_hi:[1,0]
    v_rcp_f32 v8, v8
    v_rcp_f32 v9, v9
    v_rcp_f32 v10, v10
    v_rcp_f32 v11, v11
    v_rcp_f32 v12, v12
    v_rcp_f32 v13, v13
    v_rcp_f32 v14, v14
    v_rcp_f32 v15, v15
    v_pk_mul_f32 v[68:69], v[68:69], v[180:181]
    v_pk_mul_f32 v[70:71], v[70:71], v[182:183]
    v_pk_mul_f32 v[84:85], v[84:85], v[196:197]
    v_pk_mul_f32 v[86:87], v[86:87], v[198:199]
    v_pk_mul_f32 v[8:9], v[8:9], v[68:69]
    v_pk_mul_f32 v[10:11], v[10:11], v[70:71]
    v_pk_mul_f32 v[12:13], v[12:13], v[84:85]
    v_pk_mul_f32 v[14:15], v[14:15], v[86:87]
    v_cvt_pk_bf16_f32 v24, v8, v9
    v_cvt_pk_bf16_f32 v25, v10, v11
    v_cvt_pk_bf16_f32 v26, v12, v13
    v_cvt_pk_bf16_f32 v27, v14, v15
    buffer_store_dwordx4 v[24:27], v16, s[36:39], s85 offen offset:1024 sc1
    v_pk_mul_f32 v[8:9], v[100:101], s[58:59]
    v_pk_mul_f32 v[10:11], v[102:103], s[58:59]
    v_pk_mul_f32 v[12:13], v[116:117], s[58:59]
    v_pk_mul_f32 v[14:15], v[118:119], s[58:59]
    v_exp_f32 v8, v8
    v_exp_f32 v9, v9
    v_exp_f32 v10, v10
    v_exp_f32 v11, v11
    v_exp_f32 v12, v12
    v_exp_f32 v13, v13
    v_exp_f32 v14, v14
    v_exp_f32 v15, v15
    v_pk_add_f32 v[8:9], v[8:9], 1.0 op_sel_hi:[1,0]
    v_pk_add_f32 v[10:11], v[10:11], 1.0 op_sel_hi:[1,0]
    v_pk_add_f32 v[12:13], v[12:13], 1.0 op_sel_hi:[1,0]
    v_pk_add_f32 v[14:15], v[14:15], 1.0 op_sel_hi:[1,0]
    v_rcp_f32 v8, v8
    v_rcp_f32 v9, v9
    v_rcp_f32 v10, v10
    v_rcp_f32 v11, v11
    v_rcp_f32 v12, v12
    v_rcp_f32 v13, v13
    v_rcp_f32 v14, v14
    v_rcp_f32 v15, v15
    v_pk_mul_f32 v[100:101], v[100:101], v[212:213]
    v_pk_mul_f32 v[102:103], v[102:103], v[214:215]
    v_pk_mul_f32 v[116:117], v[116:117], v[228:229]
    v_pk_mul_f32 v[118:119], v[118:119], v[230:231]
    v_pk_mul_f32 v[8:9], v[8:9], v[100:101]
    v_pk_mul_f32 v[10:11], v[10:11], v[102:103]
    v_pk_mul_f32 v[12:13], v[12:13], v[116:117]
    v_pk_mul_f32 v[14:15], v[14:15], v[118:119]
    v_cvt_pk_bf16_f32 v20, v8, v9
    v_cvt_pk_bf16_f32 v21, v10, v11
    v_cvt_pk_bf16_f32 v22, v12, v13
    v_cvt_pk_bf16_f32 v23, v14, v15
    buffer_store_dwordx4 v[20:23], v16, s[36:39], s85 offen offset:2048 sc1
    v_pk_mul_f32 v[8:9], v[132:133], s[58:59]
    v_pk_mul_f32 v[10:11], v[134:135], s[58:59]
    v_exp_f32 v8, v8
    v_exp_f32 v9, v9
    v_exp_f32 v10, v10
    v_exp_f32 v11, v11
    v_pk_add_f32 v[8:9], v[8:9], 1.0 op_sel_hi:[1,0]
    v_pk_add_f32 v[10:11], v[10:11], 1.0 op_sel_hi:[1,0]
    v_rcp_f32 v8, v8
    v_rcp_f32 v9, v9
    v_rcp_f32 v10, v10
    v_rcp_f32 v11, v11
    v_pk_mul_f32 v[132:133], v[132:133], v[244:245]
    v_pk_mul_f32 v[134:135], v[134:135], v[246:247]
    v_pk_mul_f32 v[8:9], v[8:9], v[132:133]
    v_pk_mul_f32 v[10:11], v[10:11], v[134:135]
    v_cvt_pk_bf16_f32 v24, v8, v9
    v_cvt_pk_bf16_f32 v25, v10, v11
    buffer_store_dwordx2 v[24:25], v17, s[36:39], s86 offen sc1
    s_add_u32 s85, s85, 114688
    s_add_u32 s86, s86, 114688
    v_pk_mul_f32 v[8:9], v[40:41], s[58:59]
    v_pk_mul_f32 v[10:11], v[42:43], s[58:59]
    v_pk_mul_f32 v[12:13], v[56:57], s[58:59]
    v_pk_mul_f32 v[14:15], v[58:59], s[58:59]
    v_exp_f32 v8, v8
    v_exp_f32 v9, v9
    v_exp_f32 v10, v10
    v_exp_f32 v11, v11
    v_exp_f32 v12, v12
    v_exp_f32 v13, v13
    v_exp_f32 v14, v14
    v_exp_f32 v15, v15
    v_pk_add_f32 v[8:9], v[8:9], 1.0 op_sel_hi:[1,0]
    v_pk_add_f32 v[10:11], v[10:11], 1.0 op_sel_hi:[1,0]
    v_pk_add_f32 v[12:13], v[12:13], 1.0 op_sel_hi:[1,0]
    v_pk_add_f32 v[14:15], v[14:15], 1.0 op_sel_hi:[1,0]
    v_rcp_f32 v8, v8
    v_rcp_f32 v9, v9
    v_rcp_f32 v10, v10
    v_rcp_f32 v11, v11
    v_rcp_f32 v12, v12
    v_rcp_f32 v13, v13
    v_rcp_f32 v14, v14
    v_rcp_f32 v15, v15
    v_pk_mul_f32 v[40:41], v[40:41], v[152:153]
    v_pk_mul_f32 v[42:43], v[42:43], v[154:155]
    v_pk_mul_f32 v[56:57], v[56:57], v[168:169]
    v_pk_mul_f32 v[58:59], v[58:59], v[170:171]
    v_pk_mul_f32 v[8:9], v[8:9], v[40:41]
    v_pk_mul_f32 v[10:11], v[10:11], v[42:43]
    v_pk_mul_f32 v[12:13], v[12:13], v[56:57]
    v_pk_mul_f32 v[14:15], v[14:15], v[58:59]
    v_cvt_pk_bf16_f32 v20, v8, v9
    v_cvt_pk_bf16_f32 v21, v10, v11
    v_cvt_pk_bf16_f32 v22, v12, v13
    v_cvt_pk_bf16_f32 v23, v14, v15
    buffer_store_dwordx4 v[20:23], v16, s[36:39], s85 offen offset:0 sc1
    v_pk_mul_f32 v[8:9], v[72:73], s[58:59]
    v_pk_mul_f32 v[10:11], v[74:75], s[58:59]
    v_pk_mul_f32 v[12:13], v[88:89], s[58:59]
    v_pk_mul_f32 v[14:15], v[90:91], s[58:59]
    v_exp_f32 v8, v8
    v_exp_f32 v9, v9
    v_exp_f32 v10, v10
    v_exp_f32 v11, v11
    v_exp_f32 v12, v12
    v_exp_f32 v13, v13
    v_exp_f32 v14, v14
    v_exp_f32 v15, v15
    v_pk_add_f32 v[8:9], v[8:9], 1.0 op_sel_hi:[1,0]
    v_pk_add_f32 v[10:11], v[10:11], 1.0 op_sel_hi:[1,0]
    v_pk_add_f32 v[12:13], v[12:13], 1.0 op_sel_hi:[1,0]
    v_pk_add_f32 v[14:15], v[14:15], 1.0 op_sel_hi:[1,0]
    v_rcp_f32 v8, v8
    v_rcp_f32 v9, v9
    v_rcp_f32 v10, v10
    v_rcp_f32 v11, v11
    v_rcp_f32 v12, v12
    v_rcp_f32 v13, v13
    v_rcp_f32 v14, v14
    v_rcp_f32 v15, v15
    v_pk_mul_f32 v[72:73], v[72:73], v[184:185]
    v_pk_mul_f32 v[74:75], v[74:75], v[186:187]
    v_pk_mul_f32 v[88:89], v[88:89], v[200:201]
    v_pk_mul_f32 v[90:91], v[90:91], v[202:203]
    v_pk_mul_f32 v[8:9], v[8:9], v[72:73]
    v_pk_mul_f32 v[10:11], v[10:11], v[74:75]
    v_pk_mul_f32 v[12:13], v[12:13], v[88:89]
    v_pk_mul_f32 v[14:15], v[14:15], v[90:91]
    v_cvt_pk_bf16_f32 v24, v8, v9
    v_cvt_pk_bf16_f32 v25, v10, v11
    v_cvt_pk_bf16_f32 v26, v12, v13
    v_cvt_pk_bf16_f32 v27, v14, v15
    buffer_store_dwordx4 v[24:27], v16, s[36:39], s85 offen offset:1024 sc1
    v_pk_mul_f32 v[8:9], v[104:105], s[58:59]
    v_pk_mul_f32 v[10:11], v[106:107], s[58:59]
    v_pk_mul_f32 v[12:13], v[120:121], s[58:59]
    v_pk_mul_f32 v[14:15], v[122:123], s[58:59]
    v_exp_f32 v8, v8
    v_exp_f32 v9, v9
    v_exp_f32 v10, v10
    v_exp_f32 v11, v11
    v_exp_f32 v12, v12
    v_exp_f32 v13, v13
    v_exp_f32 v14, v14
    v_exp_f32 v15, v15
    v_pk_add_f32 v[8:9], v[8:9], 1.0 op_sel_hi:[1,0]
    v_pk_add_f32 v[10:11], v[10:11], 1.0 op_sel_hi:[1,0]
    v_pk_add_f32 v[12:13], v[12:13], 1.0 op_sel_hi:[1,0]
    v_pk_add_f32 v[14:15], v[14:15], 1.0 op_sel_hi:[1,0]
    v_rcp_f32 v8, v8
    v_rcp_f32 v9, v9
    v_rcp_f32 v10, v10
    v_rcp_f32 v11, v11
    v_rcp_f32 v12, v12
    v_rcp_f32 v13, v13
    v_rcp_f32 v14, v14
    v_rcp_f32 v15, v15
    v_pk_mul_f32 v[104:105], v[104:105], v[216:217]
    v_pk_mul_f32 v[106:107], v[106:107], v[218:219]
    v_pk_mul_f32 v[120:121], v[120:121], v[232:233]
    v_pk_mul_f32 v[122:123], v[122:123], v[234:235]
    v_pk_mul_f32 v[8:9], v[8:9], v[104:105]
    v_pk_mul_f32 v[10:11], v[10:11], v[106:107]
    v_pk_mul_f32 v[12:13], v[12:13], v[120:121]
    v_pk_mul_f32 v[14:15], v[14:15], v[122:123]
    v_cvt_pk_bf16_f32 v20, v8, v9
    v_cvt_pk_bf16_f32 v21, v10, v11
    v_cvt_pk_bf16_f32 v22, v12, v13
    v_cvt_pk_bf16_f32 v23, v14, v15
    buffer_store_dwordx4 v[20:23], v16, s[36:39], s85 offen offset:2048 sc1
    v_pk_mul_f32 v[8:9], v[136:137], s[58:59]
    v_pk_mul_f32 v[10:11], v[138:139], s[58:59]
    v_exp_f32 v8, v8
    v_exp_f32 v9, v9
    v_exp_f32 v10, v10
    v_exp_f32 v11, v11
    v_pk_add_f32 v[8:9], v[8:9], 1.0 op_sel_hi:[1,0]
    v_pk_add_f32 v[10:11], v[10:11], 1.0 op_sel_hi:[1,0]
    v_rcp_f32 v8, v8
    v_rcp_f32 v9, v9
    v_rcp_f32 v10, v10
    v_rcp_f32 v11, v11
    v_pk_mul_f32 v[136:137], v[136:137], v[248:249]
    v_pk_mul_f32 v[138:139], v[138:139], v[250:251]
    v_pk_mul_f32 v[8:9], v[8:9], v[136:137]
    v_pk_mul_f32 v[10:11], v[10:11], v[138:139]
    v_cvt_pk_bf16_f32 v24, v8, v9
    v_cvt_pk_bf16_f32 v25, v10, v11
    buffer_store_dwordx2 v[24:25], v17, s[36:39], s86 offen sc1
    s_add_u32 s85, s85, 114688
    s_add_u32 s86, s86, 114688
    v_pk_mul_f32 v[8:9], v[44:45], s[58:59]
    v_pk_mul_f32 v[10:11], v[46:47], s[58:59]
    v_pk_mul_f32 v[12:13], v[60:61], s[58:59]
    v_pk_mul_f32 v[14:15], v[62:63], s[58:59]
    v_exp_f32 v8, v8
    v_exp_f32 v9, v9
    v_exp_f32 v10, v10
    v_exp_f32 v11, v11
    v_exp_f32 v12, v12
    v_exp_f32 v13, v13
    v_exp_f32 v14, v14
    v_exp_f32 v15, v15
    v_pk_add_f32 v[8:9], v[8:9], 1.0 op_sel_hi:[1,0]
    v_pk_add_f32 v[10:11], v[10:11], 1.0 op_sel_hi:[1,0]
    v_pk_add_f32 v[12:13], v[12:13], 1.0 op_sel_hi:[1,0]
    v_pk_add_f32 v[14:15], v[14:15], 1.0 op_sel_hi:[1,0]
    v_rcp_f32 v8, v8
    v_rcp_f32 v9, v9
    v_rcp_f32 v10, v10
    v_rcp_f32 v11, v11
    v_rcp_f32 v12, v12
    v_rcp_f32 v13, v13
    v_rcp_f32 v14, v14
    v_rcp_f32 v15, v15
    v_pk_mul_f32 v[44:45], v[44:45], v[156:157]
    v_pk_mul_f32 v[46:47], v[46:47], v[158:159]
    v_pk_mul_f32 v[60:61], v[60:61], v[172:173]
    v_pk_mul_f32 v[62:63], v[62:63], v[174:175]
    v_pk_mul_f32 v[8:9], v[8:9], v[44:45]
    v_pk_mul_f32 v[10:11], v[10:11], v[46:47]
    v_pk_mul_f32 v[12:13], v[12:13], v[60:61]
    v_pk_mul_f32 v[14:15], v[14:15], v[62:63]
    v_cvt_pk_bf16_f32 v20, v8, v9
    v_cvt_pk_bf16_f32 v21, v10, v11
    v_cvt_pk_bf16_f32 v22, v12, v13
    v_cvt_pk_bf16_f32 v23, v14, v15
    buffer_store_dwordx4 v[20:23], v16, s[36:39], s85 offen offset:0 sc1
    v_pk_mul_f32 v[8:9], v[76:77], s[58:59]
    v_pk_mul_f32 v[10:11], v[78:79], s[58:59]
    v_pk_mul_f32 v[12:13], v[92:93], s[58:59]
    v_pk_mul_f32 v[14:15], v[94:95], s[58:59]
    v_exp_f32 v8, v8
    v_exp_f32 v9, v9
    v_exp_f32 v10, v10
    v_exp_f32 v11, v11
    v_exp_f32 v12, v12
    v_exp_f32 v13, v13
    v_exp_f32 v14, v14
    v_exp_f32 v15, v15
    v_pk_add_f32 v[8:9], v[8:9], 1.0 op_sel_hi:[1,0]
    v_pk_add_f32 v[10:11], v[10:11], 1.0 op_sel_hi:[1,0]
    v_pk_add_f32 v[12:13], v[12:13], 1.0 op_sel_hi:[1,0]
    v_pk_add_f32 v[14:15], v[14:15], 1.0 op_sel_hi:[1,0]
    v_rcp_f32 v8, v8
    v_rcp_f32 v9, v9
    v_rcp_f32 v10, v10
    v_rcp_f32 v11, v11
    v_rcp_f32 v12, v12
    v_rcp_f32 v13, v13
    v_rcp_f32 v14, v14
    v_rcp_f32 v15, v15
    v_pk_mul_f32 v[76:77], v[76:77], v[188:189]
    v_pk_mul_f32 v[78:79], v[78:79], v[190:191]
    v_pk_mul_f32 v[92:93], v[92:93], v[204:205]
    v_pk_mul_f32 v[94:95], v[94:95], v[206:207]
    v_pk_mul_f32 v[8:9], v[8:9], v[76:77]
    v_pk_mul_f32 v[10:11], v[10:11], v[78:79]
    v_pk_mul_f32 v[12:13], v[12:13], v[92:93]
    v_pk_mul_f32 v[14:15], v[14:15], v[94:95]
    v_cvt_pk_bf16_f32 v24, v8, v9
    v_cvt_pk_bf16_f32 v25, v10, v11
    v_cvt_pk_bf16_f32 v26, v12, v13
    v_cvt_pk_bf16_f32 v27, v14, v15
    buffer_store_dwordx4 v[24:27], v16, s[36:39], s85 offen offset:1024 sc1
    v_pk_mul_f32 v[8:9], v[108:109], s[58:59]
    v_pk_mul_f32 v[10:11], v[110:111], s[58:59]
    v_pk_mul_f32 v[12:13], v[124:125], s[58:59]
    v_pk_mul_f32 v[14:15], v[126:127], s[58:59]
    v_exp_f32 v8, v8
    v_exp_f32 v9, v9
    v_exp_f32 v10, v10
    v_exp_f32 v11, v11
    v_exp_f32 v12, v12
    v_exp_f32 v13, v13
    v_exp_f32 v14, v14
    v_exp_f32 v15, v15
    v_pk_add_f32 v[8:9], v[8:9], 1.0 op_sel_hi:[1,0]
    v_pk_add_f32 v[10:11], v[10:11], 1.0 op_sel_hi:[1,0]
    v_pk_add_f32 v[12:13], v[12:13], 1.0 op_sel_hi:[1,0]
    v_pk_add_f32 v[14:15], v[14:15], 1.0 op_sel_hi:[1,0]
    v_rcp_f32 v8, v8
    v_rcp_f32 v9, v9
    v_rcp_f32 v10, v10
    v_rcp_f32 v11, v11
    v_rcp_f32 v12, v12
    v_rcp_f32 v13, v13
    v_rcp_f32 v14, v14
    v_rcp_f32 v15, v15
    v_pk_mul_f32 v[108:109], v[108:109], v[220:221]
    v_pk_mul_f32 v[110:111], v[110:111], v[222:223]
    v_pk_mul_f32 v[124:125], v[124:125], v[236:237]
    v_pk_mul_f32 v[126:127], v[126:127], v[238:239]
    v_pk_mul_f32 v[8:9], v[8:9], v[108:109]
    v_pk_mul_f32 v[10:11], v[10:11], v[110:111]
    v_pk_mul_f32 v[12:13], v[12:13], v[124:125]
    v_pk_mul_f32 v[14:15], v[14:15], v[126:127]
    v_cvt_pk_bf16_f32 v20, v8, v9
    v_cvt_pk_bf16_f32 v21, v10, v11
    v_cvt_pk_bf16_f32 v22, v12, v13
    v_cvt_pk_bf16_f32 v23, v14, v15
    buffer_store_dwordx4 v[20:23], v16, s[36:39], s85 offen offset:2048 sc1
    v_pk_mul_f32 v[8:9], v[140:141], s[58:59]
    v_pk_mul_f32 v[10:11], v[142:143], s[58:59]
    v_exp_f32 v8, v8
    v_exp_f32 v9, v9
    v_exp_f32 v10, v10
    v_exp_f32 v11, v11
    v_pk_add_f32 v[8:9], v[8:9], 1.0 op_sel_hi:[1,0]
    v_pk_add_f32 v[10:11], v[10:11], 1.0 op_sel_hi:[1,0]
    v_rcp_f32 v8, v8
    v_rcp_f32 v9, v9
    v_rcp_f32 v10, v10
    v_rcp_f32 v11, v11
    v_pk_mul_f32 v[140:141], v[140:141], v[252:253]
    v_pk_mul_f32 v[142:143], v[142:143], v[254:255]
    v_pk_mul_f32 v[8:9], v[8:9], v[140:141]
    v_pk_mul_f32 v[10:11], v[10:11], v[142:143]
    v_cvt_pk_bf16_f32 v24, v8, v9
    v_cvt_pk_bf16_f32 v25, v10, v11
    buffer_store_dwordx2 v[24:25], v17, s[36:39], s86 offen sc1
    s_lshl_b32 s87, s91, 5
    s_add_u32 s87, s87, 98304
L_g2code:
    s_waitcnt lgkmcnt(0)
    v_mov_b32 v5, 0
    v_mov_b32 v6, s31
    s_cmp_eq_u32 s30, 0
    s_waitcnt vmcnt(0)
    s_barrier
    s_cbranch_scc0 L_sig8
    s_mov_b64 exec, 1
    buffer_store_dword v6, v5, s[92:95], s87 offen sc1
    s_mov_b64 exec, -1
L_sig8:
    v_mov_b32 v8, v16
    v_add_u32 v9, 40960, v16
    v_add_u32 v10, 81920, v16
    v_add_u32 v11, 122880, v16
    s_add_u32 m0, s98, 0
    v_add_u32 v12, 112640, v16
    v_add_u32 v24, 0, v17
    v_add_u32 v25, 40960, v17
    v_add_u32 v26, 81920, v17
    buffer_load_dwordx4 v28, s[68:71], s72 offen offset:0 lds
    v_add_u32 v27, 122880, v17
    v_mov_b32 v96, 0
    v_mov_b32 v97, 0
    v_mov_b32 v98, 0
    buffer_load_dwordx4 v29, s[68:71], s72 offen offset:1024 lds
    v_mov_b32 v99, 0
    s_nop 1
    v_mfma_f32_32x32x16_bf16 v[32:47], v[96:99], v[96:99], 0
    v_mfma_f32_32x32x16_bf16 v[48:63], v[96:99], v[96:99], 0
    buffer_load_dwordx4 v30, s[68:71], s72 offen offset:2048 lds
    v_mfma_f32_32x32x16_bf16 v[64:79], v[96:99], v[96:99], 0
    v_mfma_f32_32x32x16_bf16 v[80:95], v[96:99], v[96:99], 0
    buffer_load_dwordx4 v31, s[68:71], s72 offen offset:3072 lds
    s_add_u32 s72, s72, 131072
    s_add_u32 m0, s98, 4096
    s_nop 0
    buffer_load_dwordx4 v28, s[68:71], s72 offen offset:0 lds
    buffer_load_dwordx4 v29, s[68:71], s72 offen offset:1024 lds
    buffer_load_dwordx4 v30, s[68:71], s72 offen offset:2048 lds
    buffer_load_dwordx4 v31, s[68:71], s72 offen offset:3072 lds
    s_add_u32 s72, s72, 131072
    s_add_u32 m0, s98, 8192
    s_nop 0
    buffer_load_dwordx4 v28, s[68:71], s72 offen offset:0 lds
    buffer_load_dwordx4 v29, s[68:71], s72 offen offset:1024 lds
    buffer_load_dwordx4 v30, s[68:71], s72 offen offset:2048 lds
    buffer_load_dwordx4 v31, s[68:71], s72 offen offset:3072 lds
    s_add_u32 s72, s72, 131072
    s_lshl_b32 s56, s80, 3
    s_lshl_b32 s57, s30, 1
    s_lshl_b32 s58, s82, 2
    s_xor_b32 s57, s57, s58
    s_add_u32 s56, s56, s57
    s_lshr_b32 s83, s56, 4
    s_bfe_u32 s84, s56, 0x20002
    s_lshl_b32 s57, s83, 2
    s_add_u32 s57, s57, s84
    s_mul_i32 s57, s57, 458752
    s_add_u32 s57, s57, 0x1000000
    s_and_b32 s56, s56, 3
    s_mul_i32 s56, s56, 114688
    s_add_u32 s57, s57, s56
    s_mul_i32 s58, s82, 57344
    s_add_u32 s57, s57, s58
    s_add_u32 s32, s28, s57
    s_addc_u32 s33, s29, 0
    s_mov_b32 s34, 0x2a000
    s_mov_b32 s35, 0x20000
    v_and_b32 v5, 15, v2
    v_lshlrev_b32 v5, 11, v5
    v_bfe_u32 v6, v2, 4, 1
    v_lshl_add_u32 v5, v6, 5, v5
    v_lshrrev_b32 v6, 5, v2
    v_lshl_add_u32 v13, v6, 4, v5
    s_lshl_b32 s85, s80, 18
    s_lshl_b32 s57, s82, 17
    s_add_u32 s85, s85, s57
    s_lshl_b32 s57, s81, 8
    s_add_u32 s85, s85, s57
    s_lshl_b32 s57, s30, 6
    s_add_u32 s85, s85, s57
    v_and_b32 v14, 31, v2
    v_lshlrev_b32 v14, 5, v14
    s_lshr_b32 s56, s80, 1
    s_lshl_b32 s56, s56, 10
    s_add_u32 s56, s56, 98304
    s_add_u32 s44, s28, 0x800000
    s_addc_u32 s45, s29, 0
    s_mov_b32 s46, 0x400000
    s_mov_b32 s47, 0x20000
    s_mov_b32 s84, 0
    s_waitcnt vmcnt(0)
    ds_read_b64_tr_b16 a[32:33], v3 offset:0
    ds_read_b64_tr_b16 a[34:35], v3 offset:1024
    ds_read_b64_tr_b16 a[36:37], v4 offset:0
    ds_read_b64_tr_b16 a[38:39], v4 offset:1024
    ds_read_b64_tr_b16 a[40:41], v3 offset:2048
    ds_read_b64_tr_b16 a[42:43], v3 offset:3072
    ds_read_b64_tr_b16 a[44:45], v4 offset:2048
    ds_read_b64_tr_b16 a[46:47], v4 offset:3072
    ds_read_b64_tr_b16 a[48:49], v3 offset:4096
    ds_read_b64_tr_b16 a[50:51], v3 offset:5120
    ds_read_b64_tr_b16 a[52:53], v4 offset:4096
    ds_read_b64_tr_b16 a[54:55], v4 offset:5120
    ds_read_b64_tr_b16 a[56:57], v3 offset:6144
    ds_read_b64_tr_b16 a[58:59], v3 offset:7168
    ds_read_b64_tr_b16 a[60:61], v4 offset:6144
    ds_read_b64_tr_b16 a[62:63], v4 offset:7168
    ds_read_b64_tr_b16 a[64:65], v3 offset:8192
    ds_read_b64_tr_b16 a[66:67], v3 offset:9216
    ds_read_b64_tr_b16 a[68:69], v4 offset:8192
    ds_read_b64_tr_b16 a[70:71], v4 offset:9216
    ds_read_b64_tr_b16 a[72:73], v3 offset:10240
    ds_read_b64_tr_b16 a[74:75], v3 offset:11264
    ds_read_b64_tr_b16 a[76:77], v4 offset:10240
    ds_read_b64_tr_b16 a[78:79], v4 offset:11264
    s_waitcnt lgkmcnt(0)
    s_cmp_lg_u32 s30, 0
    s_cbranch_scc1 L_poll9x
L_poll9:
    buffer_load_dword v20, v14, s[92:95], s56 offen sc1
    s_waitcnt vmcnt(0)
    v_cmp_ne_u32 vcc, s31, v20
    s_add_u32 s3, s3, 1
    s_cmp_gt_u32 s3, 200000
    s_cbranch_scc1 L_poll9x
    s_cbranch_vccz L_poll9x
    s_branch L_poll9
L_poll9x:
    s_barrier
    s_add_u32 m0, s98, 12288
    s_nop 0
    buffer_load_dwordx4 v16, s[32:35], s84 offen offset:0 sc1 lds
    buffer_load_dwordx4 v16, s[32:35], s84 offen offset:1024 sc1 lds
    buffer_load_dwordx4 v12, s[32:35], s84 offen offset:2048 sc1 lds
    buffer_load_dwordx4 v12, s[32:35], s84 offen offset:3072 sc1 lds
    s_add_u32 s84, s84, 2048
    s_add_u32 m0, s98, 16384
    s_nop 0
    buffer_load_dwordx4 v16, s[32:35], s84 offen offset:0 sc1 lds
    buffer_load_dwordx4 v16, s[32:35], s84 offen offset:1024 sc1 lds
    buffer_load_dwordx4 v12, s[32:35], s84 offen offset:2048 sc1 lds
    buffer_load_dwordx4 v12, s[32:35], s84 offen offset:3072 sc1 lds
    s_add_u32 s84, s84, 2048
    s_add_u32 m0, s98, 20480
    s_nop 0
    buffer_load_dwordx4 v16, s[32:35], s84 offen offset:0 sc1 lds
    buffer_load_dwordx4 v16, s[32:35], s84 offen offset:1024 sc1 lds
    buffer_load_dwordx4 v12, s[32:35], s84 offen offset:2048 sc1 lds
    buffer_load_dwordx4 v12, s[32:35], s84 offen offset:3072 sc1 lds
    s_add_u32 s84, s84, 2048
    s_waitcnt vmcnt(8)
    s_barrier
    ds_read_b128 v[96:99], v8 offset:12288
    ds_read_b128 v[100:103], v8 offset:14336
    ds_read_b128 v[104:107], v9 offset:12288
    ds_read_b128 v[108:111], v9 offset:14336
    ds_read_b128 v[112:115], v10 offset:12288
    ds_read_b128 v[116:119], v10 offset:14336
    ds_read_b128 v[120:123], v11 offset:12288
    ds_read_b128 v[124:127], v11 offset:14336
    ds_read_b128 v[128:131], v8 offset:13312
    ds_read_b128 v[132:135], v8 offset:15360
    ds_read_b128 v[136:139], v9 offset:13312
    s_lshl_b32 s56, s2, 2
    s_add_u32 s56, s56, s30
    s_lshl_b32 s57, s56, 13
    s_xor_b32 s58, s57, 0x8000
    s_lshl_b32 s56, s56, 6
    s_add_u32 s56, s56, 131072
    s_xor_b32 s59, s56, 0x100
    s_add_u32 s40, s28, 0x2000000
    s_addc_u32 s41, s29, 0
    s_mov_b32 s42, 0x800000
    s_mov_b32 s43, 0x20000
    s_mov_b32 s48, s24
    s_mov_b32 s49, s25
    s_mov_b32 s50, 0x400000
    s_mov_b32 s51, 0x20000
    s_add_u32 s87, s57, 4096
    s_add_u32 s88, s58, 4096
    v_mov_b32 v20, 0
    v_mov_b32 v21, s31
    s_waitcnt lgkmcnt(10)
    v_mfma_f32_16x16x32_bf16 v[32:35], a[128:131], v[96:99], v[32:35]
    ds_read_b128 v[140:143], v9 offset:15360
    v_mfma_f32_16x16x32_bf16 v[36:39], a[132:135], v[96:99], v[36:39]
    s_add_u32 m0, s98, 24576
    s_waitcnt lgkmcnt(10)
    v_mfma_f32_16x16x32_bf16 v[44:47], a[132:135], v[100:103], v[44:47]
    ds_read_b128 v[96:99], v10 offset:13312
    v_mfma_f32_16x16x32_bf16 v[40:43], a[128:131], v[100:103], v[40:43]
    buffer_load_dwordx4 v16, s[32:35], s84 offen offset:0 sc1 lds
    s_waitcnt lgkmcnt(10)
    v_mfma_f32_16x16x32_bf16 v[48:51], a[128:131], v[104:107], v[48:51]
    ds_read_b128 v[100:103], v10 offset:15360
    v_mfma_f32_16x16x32_bf16 v[52:55], a[132:135], v[104:107], v[52:55]
    buffer_load_dwordx4 v16, s[32:35], s84 offen offset:1024 sc1 lds
    s_waitcnt lgkmcnt(10)
    v_mfma_f32_16x16x32_bf16 v[60:63], a[132:135], v[108:111], v[60:63]
    ds_read_b128 v[104:107], v11 offset:13312
    v_mfma_f32_16x16x32_bf16 v[56:59], a[128:131], v[108:111], v[56:59]
    buffer_load_dwordx4 v12, s[32:35], s84 offen offset:2048 sc1 lds
    s_waitcnt lgkmcnt(10)
    v_mfma_f32_16x16x32_bf16 v[64:67], a[128:131], v[112:115], v[64:67]
    ds_read_b128 v[108:111], v11 offset:15360
    v_mfma_f32_16x16x32_bf16 v[68:71], a[132:135], v[112:115], v[68:71]
    buffer_load_dwordx4 v12, s[32:35], s84 offen offset:3072 sc1 lds
    s_waitcnt vmcnt(8)
    s_barrier
    s_waitcnt lgkmcnt(10)
    v_mfma_f32_16x16x32_bf16 v[76:79], a[132:135], v[116:119], v[76:79]
    ds_read_b128 v[112:115], v8 offset:16384
    v_mfma_f32_16x16x32_bf16 v[72:75], a[128:131], v[116:119], v[72:75]
    s_add_u32 s84, s84, 2048
    s_waitcnt lgkmcnt(10)
    v_mfma_f32_16x16x32_bf16 v[80:83], a[128:131], v[120:123], v[80:83]
    ds_read_b128 v[116:119], v8 offset:18432
    v_mfma_f32_16x16x32_bf16 v[84:87], a[132:135], v[120:123], v[84:87]
    s_waitcnt lgkmcnt(10)
    v_mfma_f32_16x16x32_bf16 v[92:95], a[132:135], v[124:127], v[92:95]
    ds_read_b128 v[120:123], v9 offset:16384
    v_mfma_f32_16x16x32_bf16 v[88:91], a[128:131], v[124:127], v[88:91]
    s_waitcnt lgkmcnt(10)
    v_mfma_f32_16x16x32_bf16 v[32:35], a[136:139], v[128:131], v[32:35]
    ds_read_b128 v[124:127], v9 offset:18432
    v_mfma_f32_16x16x32_bf16 v[36:39], a[140:143], v[128:131], v[36:39]
    s_add_u32 m0, s98, 28672
    s_waitcnt lgkmcnt(10)
    v_mfma_f32_16x16x32_bf16 v[44:47], a[140:143], v[132:135], v[44:47]
    ds_read_b128 v[128:131], v10 offset:16384
    v_mfma_f32_16x16x32_bf16 v[40:43], a[136:139], v[132:135], v[40:43]
    buffer_load_dwordx4 v16, s[32:35], s84 offen offset:0 sc1 lds
    s_waitcnt lgkmcnt(10)
    v_mfma_f32_16x16x32_bf16 v[48:51], a[136:139], v[136:139], v[48:51]
    ds_read_b128 v[132:135], v10 offset:18432
    v_mfma_f32_16x16x32_bf16 v[52:55], a[140:143], v[136:139], v[52:55]
    buffer_load_dwordx4 v16, s[32:35], s84 offen offset:1024 sc1 lds
    s_waitcnt lgkmcnt(10)
    v_mfma_f32_16x16x32_bf16 v[60:63], a[140:143], v[140:143], v[60:63]
    ds_read_b128 v[136:139], v11 offset:16384
    v_mfma_f32_16x16x32_bf16 v[56:59], a[136:139], v[140:143], v[56:59]
    buffer_load_dwordx4 v12, s[32:35], s84 offen offset:2048 sc1 lds
    s_waitcnt lgkmcnt(10)
    v_mfma_f32_16x16x32_bf16 v[64:67], a[136:139], v[96:99], v[64:67]
    ds_read_b128 v[140:143], v11 offset:18432
    v_mfma_f32_16x16x32_bf16 v[68:71], a[140:143], v[96:99], v[68:71]
    buffer_load_dwordx4 v12, s[32:35], s84 offen offset:3072 sc1 lds
    s_waitcnt lgkmcnt(10)
    v_mfma_f32_16x16x32_bf16 v[76:79], a[140:143], v[100:103], v[76:79]
    ds_read2st64_b64 v[96:99], v24 offset0:34 offset1:35
    v_mfma_f32_16x16x32_bf16 v[72:75], a[136:139], v[100:103], v[72:75]
    s_add_u32 s84, s84, 2048
    s_waitcnt lgkmcnt(10)
    v_mfma_f32_16x16x32_bf16 v[80:83], a[136:139], v[104:107], v[80:83]
    ds_read2st64_b64 v[100:103], v24 offset0:38 offset1:39
    v_mfma_f32_16x16x32_bf16 v[84:87], a[140:143], v[104:107], v[84:87]
    s_waitcnt lgkmcnt(10)
    v_mfma_f32_16x16x32_bf16 v[92:95], a[140:143], v[108:111], v[92:95]
    ds_read2st64_b64 v[104:107], v25 offset0:34 offset1:35
    v_mfma_f32_16x16x32_bf16 v[88:91], a[136:139], v[108:111], v[88:91]
    s_waitcnt lgkmcnt(10)
    v_mfma_f32_16x16x32_bf16 v[32:35], a[144:147], v[112:115], v[32:35]
    ds_read2st64_b64 v[108:111], v25 offset0:38 offset1:39
    v_mfma_f32_16x16x32_bf16 v[36:39], a[148:151], v[112:115], v[36:39]
    s_add_u32 m0, s98, 32768
    s_waitcnt lgkmcnt(10)
    v_mfma_f32_16x16x32_bf16 v[44:47], a[148:151], v[116:119], v[44:47]
    ds_read2st64_b64 v[112:115], v26 offset0:34 offset1:35
    v_mfma_f32_16x16x32_bf16 v[40:43], a[144:147], v[116:119], v[40:43]
    buffer_load_dwordx4 v16, s[32:35], s84 offen offset:0 sc1 lds
    s_waitcnt lgkmcnt(10)
    v_mfma_f32_16x16x32_bf16 v[48:51], a[144:147], v[120:123], v[48:51]
    ds_read2st64_b64 v[116:119], v26 offset0:38 offset1:39
    v_mfma_f32_16x16x32_bf16 v[52:55], a[148:151], v[120:123], v[52:55]
    buffer_load_dwordx4 v16, s[32:35], s84 offen offset:1024 sc1 lds
    s_waitcnt lgkmcnt(10)
    v_mfma_f32_16x16x32_bf16 v[60:63], a[148:151], v[124:127], v[60:63]
    ds_read2st64_b64 v[120:123], v27 offset0:34 offset1:35
    v_mfma_f32_16x16x32_bf16 v[56:59], a[144:147], v[124:127], v[56:59]
    buffer_load_dwordx4 v12, s[32:35], s84 offen offset:2048 sc1 lds
    s_waitcnt lgkmcnt(10)
    v_mfma_f32_16x16x32_bf16 v[64:67], a[144:147], v[128:131], v[64:67]
    ds_read2st64_b64 v[124:127], v27 offset0:38 offset1:39
    v_mfma_f32_16x16x32_bf16 v[68:71], a[148:151], v[128:131], v[68:71]
    buffer_load_dwordx4 v12, s[32:35], s84 offen offset:3072 sc1 lds
    s_waitcnt vmcnt(12)
    s_barrier
    s_waitcnt lgkmcnt(10)
    v_mfma_f32_16x16x32_bf16 v[76:79], a[148:151], v[132:135], v[76:79]
    ds_read_b128 v[128:131], v8 offset:20480
    v_mfma_f32_16x16x32_bf16 v[72:75], a[144:147], v[132:135], v[72:75]
    s_add_u32 s84, s84, 2048
    s_waitcnt lgkmcnt(10)
    v_mfma_f32_16x16x32_bf16 v[80:83], a[144:147], v[136:139], v[80:83]
    ds_read_b128 v[132:135], v8 offset:22528
    v_mfma_f32_16x16x32_bf16 v[84:87], a[148:151], v[136:139], v[84:87]
    s_waitcnt lgkmcnt(10)
    v_mfma_f32_16x16x32_bf16 v[92:95], a[148:151], v[140:143], v[92:95]
    ds_read_b128 v[136:139], v9 offset:20480
    v_mfma_f32_16x16x32_bf16 v[88:91], a[144:147], v[140:143], v[88:91]
    s_waitcnt lgkmcnt(10)
    v_mfma_f32_16x16x32_bf16 v[32:35], a[152:155], v[96:99], v[32:35]
    ds_read_b128 v[140:143], v9 offset:22528
    v_mfma_f32_16x16x32_bf16 v[36:39], a[156:159], v[96:99], v[36:39]
    s_add_u32 m0, s98, 36864
    s_waitcnt lgkmcnt(10)
    v_mfma_f32_16x16x32_bf16 v[44:47], a[156:159], v[100:103], v[44:47]
    ds_read_b128 v[96:99], v10 offset:20480
    v_mfma_f32_16x16x32_bf16 v[40:43], a[152:155], v[100:103], v[40:43]
    buffer_load_dwordx4 v16, s[32:35], s84 offen offset:0 sc1 lds
    s_waitcnt lgkmcnt(10)
    v_mfma_f32_16x16x32_bf16 v[48:51], a[152:155], v[104:107], v[48:51]
    ds_read_b128 v[100:103], v10 offset:22528
    v_mfma_f32_16x16x32_bf16 v[52:55], a[156:159], v[104:107], v[52:55]
    buffer_load_dwordx4 v16, s[32:35], s84 offen offset:1024 sc1 lds
    s_waitcnt lgkmcnt(10)
    v_mfma_f32_16x16x32_bf16 v[60:63], a[156:159], v[108:111], v[60:63]
    ds_read_b128 v[104:107], v11 offset:20480
    v_mfma_f32_16x16x32_bf16 v[56:59], a[152:155], v[108:111], v[56:59]
    buffer_load_dwordx4 v12, s[32:35], s84 offen offset:2048 sc1 lds
    s_waitcnt lgkmcnt(10)
    v_mfma_f32_16x16x32_bf16 v[64:67], a[152:155], v[112:115], v[64:67]
    ds_read_b128 v[108:111], v11 offset:22528
    v_mfma_f32_16x16x32_bf16 v[68:71], a[156:159], v[112:115], v[68:71]
    buffer_load_dwordx4 v12, s[32:35], s84 offen offset:3072 sc1 lds
    s_waitcnt lgkmcnt(10)
    v_mfma_f32_16x16x32_bf16 v[76:79], a[156:159], v[116:119], v[76:79]
    ds_read_b128 v[112:115], v8 offset:21504
    v_mfma_f32_16x16x32_bf16 v[72:75], a[152:155], v[116:119], v[72:75]
    s_add_u32 s84, s84, 2048
    s_waitcnt lgkmcnt(10)
    v_mfma_f32_16x16x32_bf16 v[80:83], a[152:155], v[120:123], v[80:83]
    ds_read_b128 v[116:119], v8 offset:23552
    v_mfma_f32_16x16x32_bf16 v[84:87], a[156:159], v[120:123], v[84:87]
    s_waitcnt lgkmcnt(10)
    v_mfma_f32_16x16x32_bf16 v[92:95], a[156:159], v[124:127], v[92:95]
    ds_read_b128 v[120:123], v9 offset:21504
    v_mfma_f32_16x16x32_bf16 v[88:91], a[152:155], v[124:127], v[88:91]
    s_waitcnt lgkmcnt(10)
    v_mfma_f32_16x16x32_bf16 v[32:35], a[160:163], v[128:131], v[32:35]
    ds_read_b128 v[124:127], v9 offset:23552
    v_mfma_f32_16x16x32_bf16 v[36:39], a[164:167], v[128:131], v[36:39]
    s_add_u32 m0, s98, 12288
    s_waitcnt lgkmcnt(10)
    v_mfma_f32_16x16x32_bf16 v[44:47], a[164:167], v[132:135], v[44:47]
    ds_read_b128 v[128:131], v10 offset:21504
    v_mfma_f32_16x16x32_bf16 v[40:43], a[160:163], v[132:135], v[40:43]
    buffer_load_dwordx4 v16, s[32:35], s84 offen offset:0 sc1 lds
    s_waitcnt lgkmcnt(10)
    v_mfma_f32_16x16x32_bf16 v[48:51], a[160:163], v[136:139], v[48:51]
    ds_read_b128 v[132:135], v10 offset:23552
    v_mfma_f32_16x16x32_bf16 v[52:55], a[164:167], v[136:139], v[52:55]
    buffer_load_dwordx4 v16, s[32:35], s84 offen offset:1024 sc1 lds
    s_waitcnt lgkmcnt(10)
    v_mfma_f32_16x16x32_bf16 v[60:63], a[164:167], v[140:143], v[60:63]
    ds_read_b128 v[136:139], v11 offset:21504
    v_mfma_f32_16x16x32_bf16 v[56:59], a[160:163], v[140:143], v[56:59]
    buffer_load_dwordx4 v12, s[32:35], s84 offen offset:2048 sc1 lds
    s_waitcnt lgkmcnt(10)
    v_mfma_f32_16x16x32_bf16 v[64:67], a[160:163], v[96:99], v[64:67]
    ds_read_b128 v[140:143], v11 offset:23552
    v_mfma_f32_16x16x32_bf16 v[68:71], a[164:167], v[96:99], v[68:71]
    buffer_load_dwordx4 v12, s[32:35], s84 offen offset:3072 sc1 lds
    s_waitcnt vmcnt(16)
    s_barrier
    s_waitcnt lgkmcnt(10)
    v_mfma_f32_16x16x32_bf16 v[76:79], a[164:167], v[100:103], v[76:79]
    ds_read_b128 v[96:99], v8 offset:24576
    v_mfma_f32_16x16x32_bf16 v[72:75], a[160:163], v[100:103], v[72:75]
    s_add_u32 s84, s84, 2048
    s_waitcnt lgkmcnt(10)
    v_mfma_f32_16x16x32_bf16 v[80:83], a[160:163], v[104:107], v[80:83]
    ds_read_b128 v[100:103], v8 offset:26624
    v_mfma_f32_16x16x32_bf16 v[84:87], a[164:167], v[104:107], v[84:87]
    s_waitcnt lgkmcnt(10)
    v_mfma_f32_16x16x32_bf16 v[92:95], a[164:167], v[108:111], v[92:95]
    ds_read_b128 v[104:107], v9 offset:24576
    v_mfma_f32_16x16x32_bf16 v[88:91], a[160:163], v[108:111], v[88:91]
    s_waitcnt lgkmcnt(10)
    v_mfma_f32_16x16x32_bf16 v[32:35], a[168:171], v[112:115], v[32:35]
    ds_read_b128 v[108:111], v9 offset:26624
    v_mfma_f32_16x16x32_bf16 v[36:39], a[172:175], v[112:115], v[36:39]
    s_add_u32 m0, s98, 16384
    s_waitcnt lgkmcnt(10)
    v_mfma_f32_16x16x32_bf16 v[44:47], a[172:175], v[116:119], v[44:47]
    ds_read_b128 v[112:115], v10 offset:24576
    v_mfma_f32_16x16x32_bf16 v[40:43], a[168:171], v[116:119], v[40:43]
    buffer_load_dwordx4 v16, s[32:35], s84 offen offset:0 sc1 lds
    s_waitcnt lgkmcnt(10)
    v_mfma_f32_16x16x32_bf16 v[48:51], a[168:171], v[120:123], v[48:51]
    ds_read_b128 v[116:119], v10 offset:26624
    v_mfma_f32_16x16x32_bf16 v[52:55], a[172:175], v[120:123], v[52:55]
    buffer_load_dwordx4 v16, s[32:35], s84 offen offset:1024 sc1 lds
    s_waitcnt lgkmcnt(10)
    v_mfma_f32_16x16x32_bf16 v[60:63], a[172:175], v[124:127], v[60:63]
    ds_read_b128 v[120:123], v11 offset:24576
    v_mfma_f32_16x16x32_bf16 v[56:59], a[168:171], v[124:127], v[56:59]
    buffer_load_dwordx4 v12, s[32:35], s84 offen offset:2048 sc1 lds
    s_waitcnt lgkmcnt(10)
    v_mfma_f32_16x16x32_bf16 v[64:67], a[168:171], v[128:131], v[64:67]
    ds_read_b128 v[124:127], v11 offset:26624
    v_mfma_f32_16x16x32_bf16 v[68:71], a[172:175], v[128:131], v[68:71]
    buffer_load_dwordx4 v12, s[32:35], s84 offen offset:3072 sc1 lds
    s_waitcnt lgkmcnt(10)
    v_mfma_f32_16x16x32_bf16 v[76:79], a[172:175], v[132:135], v[76:79]
    ds_read_b128 v[128:131], v8 offset:25600
    v_mfma_f32_16x16x32_bf16 v[72:75], a[168:171], v[132:135], v[72:75]
    s_add_u32 s84, s84, 2048
    s_waitcnt lgkmcnt(10)
    v_mfma_f32_16x16x32_bf16 v[80:83], a[168:171], v[136:139], v[80:83]
    ds_read_b128 v[132:135], v8 offset:27648
    v_mfma_f32_16x16x32_bf16 v[84:87], a[172:175], v[136:139], v[84:87]
    s_waitcnt lgkmcnt(10)
    v_mfma_f32_16x16x32_bf16 v[92:95], a[172:175], v[140:143], v[92:95]
    ds_read_b128 v[136:139], v9 offset:25600
    v_mfma_f32_16x16x32_bf16 v[88:91], a[168:171], v[140:143], v[88:91]
    s_waitcnt lgkmcnt(10)
    v_mfma_f32_16x16x32_bf16 v[32:35], a[176:179], v[96:99], v[32:35]
    ds_read_b128 v[140:143], v9 offset:27648
    v_mfma_f32_16x16x32_bf16 v[36:39], a[180:183], v[96:99], v[36:39]
    s_waitcnt lgkmcnt(10)
    v_mfma_f32_16x16x32_bf16 v[44:47], a[180:183], v[100:103], v[44:47]
    ds_read_b128 v[96:99], v10 offset:25600
    v_mfma_f32_16x16x32_bf16 v[40:43], a[176:179], v[100:103], v[40:43]
    s_waitcnt lgkmcnt(10)
    v_mfma_f32_16x16x32_bf16 v[48:51], a[176:179], v[104:107], v[48:51]
    ds_read_b128 v[100:103], v10 offset:27648
    v_mfma_f32_16x16x32_bf16 v[52:55], a[180:183], v[104:107], v[52:55]
    s_waitcnt lgkmcnt(10)
    v_mfma_f32_16x16x32_bf16 v[60:63], a[180:183], v[108:111], v[60:63]
    ds_read_b128 v[104:107], v11 offset:25600
    v_mfma_f32_16x16x32_bf16 v[56:59], a[176:179], v[108:111], v[56:59]
    s_waitcnt lgkmcnt(10)
    v_mfma_f32_16x16x32_bf16 v[64:67], a[176:179], v[112:115], v[64:67]
    ds_read_b128 v[108:111], v11 offset:27648
    v_mfma_f32_16x16x32_bf16 v[68:71], a[180:183], v[112:115], v[68:71]
    s_waitcnt vmcnt(16)
    s_barrier
    s_waitcnt lgkmcnt(10)
    v_mfma_f32_16x16x32_bf16 v[76:79], a[180:183], v[116:119], v[76:79]
    ds_read_b128 v[112:115], v8 offset:28672
    v_mfma_f32_16x16x32_bf16 v[72:75], a[176:179], v[116:119], v[72:75]
    s_waitcnt lgkmcnt(10)
    v_mfma_f32_16x16x32_bf16 v[80:83], a[176:179], v[120:123], v[80:83]
    ds_read_b128 v[116:119], v8 offset:30720
    v_mfma_f32_16x16x32_bf16 v[84:87], a[180:183], v[120:123], v[84:87]
    s_waitcnt lgkmcnt(10)
    v_mfma_f32_16x16x32_bf16 v[92:95], a[180:183], v[124:127], v[92:95]
    ds_read_b128 v[120:123], v9 offset:28672
    v_mfma_f32_16x16x32_bf16 v[88:91], a[176:179], v[124:127], v[88:91]
    s_waitcnt lgkmcnt(10)
    v_mfma_f32_16x16x32_bf16 v[32:35], a[184:187], v[128:131], v[32:35]
    ds_read_b128 v[124:127], v9 offset:30720
    v_mfma_f32_16x16x32_bf16 v[36:39], a[188:191], v[128:131], v[36:39]
    s_add_u32 m0, s98, 20480
    s_waitcnt lgkmcnt(10)
    v_mfma_f32_16x16x32_bf16 v[44:47], a[188:191], v[132:135], v[44:47]
    ds_read_b128 v[128:131], v10 offset:28672
    v_mfma_f32_16x16x32_bf16 v[40:43], a[184:187], v[132:135], v[40:43]
    buffer_load_dwordx4 v16, s[32:35], s84 offen offset:0 sc1 lds
    s_waitcnt lgkmcnt(10)
    v_mfma_f32_16x16x32_bf16 v[48:51], a[184:187], v[136:139], v[48:51]
    ds_read_b128 v[132:135], v10 offset:30720
    v_mfma_f32_16x16x32_bf16 v[52:55], a[188:191], v[136:139], v[52:55]
    buffer_load_dwordx4 v16, s[32:35], s84 offen offset:1024 sc1 lds
    s_waitcnt lgkmcnt(10)
    v_mfma_f32_16x16x32_bf16 v[60:63], a[188:191], v[140:143], v[60:63]
    ds_read_b128 v[136:139], v11 offset:28672
    v_mfma_f32_16x16x32_bf16 v[56:59], a[184:187], v[140:143], v[56:59]
    buffer_load_dwordx4 v12, s[32:35], s84 offen offset:2048 sc1 lds
    s_waitcnt lgkmcnt(10)
    v_mfma_f32_16x16x32_bf16 v[64:67], a[184:187], v[96:99], v[64:67]
    ds_read_b128 v[140:143], v11 offset:30720
    v_mfma_f32_16x16x32_bf16 v[68:71], a[188:191], v[96:99], v[68:71]
    buffer_load_dwordx4 v12, s[32:35], s84 offen offset:3072 sc1 lds
    s_waitcnt lgkmcnt(10)
    v_mfma_f32_16x16x32_bf16 v[76:79], a[188:191], v[100:103], v[76:79]
    ds_read_b128 v[96:99], v8 offset:29696
    v_mfma_f32_16x16x32_bf16 v[72:75], a[184:187], v[100:103], v[72:75]
    s_add_u32 s84, s84, 2048
    s_waitcnt lgkmcnt(10)
    v_mfma_f32_16x16x32_bf16 v[80:83], a[184:187], v[104:107], v[80:83]
    ds_read_b128 v[100:103], v8 offset:31744
    v_mfma_f32_16x16x32_bf16 v[84:87], a[188:191], v[104:107], v[84:87]
    s_waitcnt lgkmcnt(10)
    v_mfma_f32_16x16x32_bf16 v[92:95], a[188:191], v[108:111], v[92:95]
    ds_read_b128 v[104:107], v9 offset:29696
    v_mfma_f32_16x16x32_bf16 v[88:91], a[184:187], v[108:111], v[88:91]
    s_waitcnt lgkmcnt(10)
    v_mfma_f32_16x16x32_bf16 v[32:35], a[192:195], v[112:115], v[32:35]
    ds_read_b128 v[108:111], v9 offset:31744
    v_mfma_f32_16x16x32_bf16 v[36:39], a[196:199], v[112:115], v[36:39]
    s_add_u32 m0, s98, 0
    s_waitcnt lgkmcnt(10)
    v_mfma_f32_16x16x32_bf16 v[44:47], a[196:199], v[116:119], v[44:47]
    ds_read_b128 v[112:115], v10 offset:29696
    v_mfma_f32_16x16x32_bf16 v[40:43], a[192:195], v[116:119], v[40:43]
    buffer_load_dwordx4 v28, s[68:71], s72 offen offset:0 lds
    s_waitcnt lgkmcnt(10)
    v_mfma_f32_16x16x32_bf16 v[48:51], a[192:195], v[120:123], v[48:51]
    ds_read_b128 v[116:119], v10 offset:31744
    v_mfma_f32_16x16x32_bf16 v[52:55], a[196:199], v[120:123], v[52:55]
    buffer_load_dwordx4 v29, s[68:71], s72 offen offset:1024 lds
    s_waitcnt lgkmcnt(10)
    v_mfma_f32_16x16x32_bf16 v[60:63], a[196:199], v[124:127], v[60:63]
    ds_read_b128 v[120:123], v11 offset:29696
    v_mfma_f32_16x16x32_bf16 v[56:59], a[192:195], v[124:127], v[56:59]
    buffer_load_dwordx4 v30, s[68:71], s72 offen offset:2048 lds
    s_waitcnt lgkmcnt(10)
    v_mfma_f32_16x16x32_bf16 v[64:67], a[192:195], v[128:131], v[64:67]
    ds_read_b128 v[124:127], v11 offset:31744
    v_mfma_f32_16x16x32_bf16 v[68:71], a[196:199], v[128:131], v[68:71]
    buffer_load_dwordx4 v31, s[68:71], s72 offen offset:3072 lds
    s_waitcnt vmcnt(20)
    s_barrier
    s_waitcnt lgkmcnt(10)
    v_mfma_f32_16x16x32_bf16 v[76:79], a[196:199], v[132:135], v[76:79]
    ds_read2st64_b64 v[128:131], v24 offset0:64 offset1:65
    v_mfma_f32_16x16x32_bf16 v[72:75], a[192:195], v[132:135], v[72:75]
    s_add_u32 s72, s72, 131072
    s_waitcnt lgkmcnt(10)
    v_mfma_f32_16x16x32_bf16 v[80:83], a[192:195], v[136:139], v[80:83]
    ds_read2st64_b64 v[132:135], v24 offset0:68 offset1:69
    v_mfma_f32_16x16x32_bf16 v[84:87], a[196:199], v[136:139], v[84:87]
    s_waitcnt lgkmcnt(10)
    v_mfma_f32_16x16x32_bf16 v[92:95], a[196:199], v[140:143], v[92:95]
    ds_read2st64_b64 v[136:139], v25 offset0:64 offset1:65
    v_mfma_f32_16x16x32_bf16 v[88:91], a[192:195], v[140:143], v[88:91]
    s_waitcnt lgkmcnt(10)
    v_mfma_f32_16x16x32_bf16 v[32:35], a[200:203], v[96:99], v[32:35]
    ds_read2st64_b64 v[140:143], v25 offset0:68 offset1:69
    v_mfma_f32_16x16x32_bf16 v[36:39], a[204:207], v[96:99], v[36:39]
    s_add_u32 m0, s98, 24576
    s_waitcnt lgkmcnt(10)
    v_mfma_f32_16x16x32_bf16 v[44:47], a[204:207], v[100:103], v[44:47]
    ds_read2st64_b64 v[96:99], v26 offset0:64 offset1:65
    v_mfma_f32_16x16x32_bf16 v[40:43], a[200:203], v[100:103], v[40:43]
    buffer_load_dwordx4 v16, s[32:35], s84 offen offset:0 sc1 lds
    s_waitcnt lgkmcnt(10)
    v_mfma_f32_16x16x32_bf16 v[48:51], a[200:203], v[104:107], v[48:51]
    ds_read2st64_b64 v[100:103], v26 offset0:68 offset1:69
    v_mfma_f32_16x16x32_bf16 v[52:55], a[204:207], v[104:107], v[52:55]
    buffer_load_dwordx4 v16, s[32:35], s84 offen offset:1024 sc1 lds
    s_waitcnt lgkmcnt(10)
    v_mfma_f32_16x16x32_bf16 v[60:63], a[204:207], v[108:111], v[60:63]
    ds_read2st64_b64 v[104:107], v27 offset0:64 offset1:65
    v_mfma_f32_16x16x32_bf16 v[56:59], a[200:203], v[108:111], v[56:59]
    buffer_load_dwordx4 v12, s[32:35], s84 offen offset:2048 sc1 lds
    s_waitcnt lgkmcnt(10)
    v_mfma_f32_16x16x32_bf16 v[64:67], a[200:203], v[112:115], v[64:67]
    ds_read2st64_b64 v[108:111], v27 offset0:68 offset1:69
    v_mfma_f32_16x16x32_bf16 v[68:71], a[204:207], v[112:115], v[68:71]
    buffer_load_dwordx4 v12, s[32:35], s84 offen offset:3072 sc1 lds
    s_waitcnt lgkmcnt(10)
    v_mfma_f32_16x16x32_bf16 v[76:79], a[204:207], v[116:119], v[76:79]
    ds_read_b128 v[112:115], v8 offset:33792
    v_mfma_f32_16x16x32_bf16 v[72:75], a[200:203], v[116:119], v[72:75]
    s_add_u32 s84, s84, 2048
    s_waitcnt lgkmcnt(10)
    v_mfma_f32_16x16x32_bf16 v[80:83], a[200:203], v[120:123], v[80:83]
    ds_read_b128 v[116:119], v8 offset:35840
    v_mfma_f32_16x16x32_bf16 v[84:87], a[204:207], v[120:123], v[84:87]
    s_waitcnt lgkmcnt(10)
    v_mfma_f32_16x16x32_bf16 v[92:95], a[204:207], v[124:127], v[92:95]
    ds_read_b128 v[120:123], v9 offset:33792
    v_mfma_f32_16x16x32_bf16 v[88:91], a[200:203], v[124:127], v[88:91]
    s_waitcnt lgkmcnt(10)
    v_mfma_f32_16x16x32_bf16 v[32:35], a[208:211], v[128:131], v[32:35]
    ds_read_b128 v[124:127], v9 offset:35840
    v_mfma_f32_16x16x32_bf16 v[36:39], a[212:215], v[128:131], v[36:39]
    s_add_u32 m0, s98, 4096
    s_waitcnt lgkmcnt(10)
    v_mfma_f32_16x16x32_bf16 v[44:47], a[212:215], v[132:135], v[44:47]
    ds_read_b128 v[128:131], v10 offset:33792
    v_mfma_f32_16x16x32_bf16 v[40:43], a[208:211], v[132:135], v[40:43]
    buffer_load_dwordx4 v28, s[68:71], s72 offen offset:0 lds
    s_waitcnt lgkmcnt(10)
    v_mfma_f32_16x16x32_bf16 v[48:51], a[208:211], v[136:139], v[48:51]
    ds_read_b128 v[132:135], v10 offset:35840
    v_mfma_f32_16x16x32_bf16 v[52:55], a[212:215], v[136:139], v[52:55]
    buffer_load_dwordx4 v29, s[68:71], s72 offen offset:1024 lds
    s_waitcnt lgkmcnt(10)
    v_mfma_f32_16x16x32_bf16 v[60:63], a[212:215], v[140:143], v[60:63]
    ds_read_b128 v[136:139], v11 offset:33792
    v_mfma_f32_16x16x32_bf16 v[56:59], a[208:211], v[140:143], v[56:59]
    buffer_load_dwordx4 v30, s[68:71], s72 offen offset:2048 lds
    s_waitcnt lgkmcnt(10)
    v_mfma_f32_16x16x32_bf16 v[64:67], a[208:211], v[96:99], v[64:67]
    ds_read_b128 v[140:143], v11 offset:35840
    v_mfma_f32_16x16x32_bf16 v[68:71], a[212:215], v[96:99], v[68:71]
    buffer_load_dwordx4 v31, s[68:71], s72 offen offset:3072 lds
    s_waitcnt vmcnt(24)
    s_barrier
    s_waitcnt lgkmcnt(10)
    v_mfma_f32_16x16x32_bf16 v[76:79], a[212:215], v[100:103], v[76:79]
    ds_read_b128 v[96:99], v8 offset:36864
    v_mfma_f32_16x16x32_bf16 v[72:75], a[208:211], v[100:103], v[72:75]
    s_add_u32 s72, s72, 131072
    s_waitcnt lgkmcnt(10)
    v_mfma_f32_16x16x32_bf16 v[80:83], a[208:211], v[104:107], v[80:83]
    ds_read_b128 v[100:103], v8 offset:38912
    v_mfma_f32_16x16x32_bf16 v[84:87], a[212:215], v[104:107], v[84:87]
    s_waitcnt lgkmcnt(10)
    v_mfma_f32_16x16x32_bf16 v[92:95], a[212:215], v[108:111], v[92:95]
    ds_read_b128 v[104:107], v9 offset:36864
    v_mfma_f32_16x16x32_bf16 v[88:91], a[208:211], v[108:111], v[88:91]
    s_waitcnt lgkmcnt(10)
    v_mfma_f32_16x16x32_bf16 v[32:35], a[216:219], v[112:115], v[32:35]
    ds_read_b128 v[108:111], v9 offset:38912
    v_mfma_f32_16x16x32_bf16 v[36:39], a[220:223], v[112:115], v[36:39]
    s_add_u32 m0, s98, 28672
    s_waitcnt lgkmcnt(10)
    v_mfma_f32_16x16x32_bf16 v[44:47], a[220:223], v[116:119], v[44:47]
    ds_read_b128 v[112:115], v10 offset:36864
    v_mfma_f32_16x16x32_bf16 v[40:43], a[216:219], v[116:119], v[40:43]
    buffer_load_dwordx4 v16, s[32:35], s84 offen offset:0 sc1 lds
    s_waitcnt lgkmcnt(10)
    v_mfma_f32_16x16x32_bf16 v[48:51], a[216:219], v[120:123], v[48:51]
    ds_read_b128 v[116:119], v10 offset:38912
    v_mfma_f32_16x16x32_bf16 v[52:55], a[220:223], v[120:123], v[52:55]
    buffer_load_dwordx4 v16, s[32:35], s84 offen offset:1024 sc1 lds
    s_waitcnt lgkmcnt(10)
    v_mfma_f32_16x16x32_bf16 v[60:63], a[220:223], v[124:127], v[60:63]
    ds_read_b128 v[120:123], v11 offset:36864
    v_mfma_f32_16x16x32_bf16 v[56:59], a[216:219], v[124:127], v[56:59]
    buffer_load_dwordx4 v12, s[32:35], s84 offen offset:2048 sc1 lds
    s_waitcnt lgkmcnt(10)
    v_mfma_f32_16x16x32_bf16 v[64:67], a[216:219], v[128:131], v[64:67]
    ds_read_b128 v[124:127], v11 offset:38912
    v_mfma_f32_16x16x32_bf16 v[68:71], a[220:223], v[128:131], v[68:71]
    buffer_load_dwordx4 v12, s[32:35], s84 offen offset:3072 sc1 lds
    s_waitcnt lgkmcnt(10)
    v_mfma_f32_16x16x32_bf16 v[76:79], a[220:223], v[132:135], v[76:79]
    ds_read_b128 v[128:131], v8 offset:37888
    v_mfma_f32_16x16x32_bf16 v[72:75], a[216:219], v[132:135], v[72:75]
    s_add_u32 s84, s84, 2048
    s_waitcnt lgkmcnt(10)
    v_mfma_f32_16x16x32_bf16 v[80:83], a[216:219], v[136:139], v[80:83]
    ds_read_b128 v[132:135], v8 offset:39936
    v_mfma_f32_16x16x32_bf16 v[84:87], a[220:223], v[136:139], v[84:87]
    s_waitcnt lgkmcnt(10)
    v_mfma_f32_16x16x32_bf16 v[92:95], a[220:223], v[140:143], v[92:95]
    ds_read_b128 v[136:139], v9 offset:37888
    v_mfma_f32_16x16x32_bf16 v[88:91], a[216:219], v[140:143], v[88:91]
    s_waitcnt lgkmcnt(10)
    v_mfma_f32_16x16x32_bf16 v[32:35], a[224:227], v[96:99], v[32:35]
    ds_read_b128 v[140:143], v9 offset:39936
    v_mfma_f32_16x16x32_bf16 v[36:39], a[228:231], v[96:99], v[36:39]
    s_waitcnt vmcnt(12)
    ds_read_b64_tr_b16 a[80:81], v3 offset:0
    s_waitcnt lgkmcnt(11)
    v_mfma_f32_16x16x32_bf16 v[44:47], a[228:231], v[100:103], v[44:47]
    ds_read_b128 v[96:99], v10 offset:37888
    v_mfma_f32_16x16x32_bf16 v[40:43], a[224:227], v[100:103], v[40:43]
    ds_read_b64_tr_b16 a[82:83], v3 offset:1024
    ds_read_b64_tr_b16 a[84:85], v4 offset:0
    s_waitcnt lgkmcnt(13)
    v_mfma_f32_16x16x32_bf16 v[48:51], a[224:227], v[104:107], v[48:51]
    ds_read_b128 v[100:103], v10 offset:39936
    v_mfma_f32_16x16x32_bf16 v[52:55], a[228:231], v[104:107], v[52:55]
    ds_read_b64_tr_b16 a[86:87], v4 offset:1024
    ds_read_b64_tr_b16 a[88:89], v3 offset:2048
    s_waitcnt lgkmcnt(15)
    v_mfma_f32_16x16x32_bf16 v[60:63], a[228:231], v[108:111], v[60:63]
    ds_read_b128 v[104:107], v11 offset:37888
    v_mfma_f32_16x16x32_bf16 v[56:59], a[224:227], v[108:111], v[56:59]
    ds_read_b64_tr_b16 a[90:91], v3 offset:3072
    ds_read_b64_tr_b16 a[92:93], v4 offset:2048
    s_waitcnt lgkmcnt(15)
    v_mfma_f32_16x16x32_bf16 v[64:67], a[224:227], v[112:115], v[64:67]
    ds_read_b128 v[108:111], v11 offset:39936
    v_mfma_f32_16x16x32_bf16 v[68:71], a[228:231], v[112:115], v[68:71]
    ds_read_b64_tr_b16 a[94:95], v4 offset:3072
    s_add_u32 m0, s98, 8192
    s_barrier
    v_mfma_f32_16x16x32_bf16 v[76:79], a[228:231], v[116:119], v[76:79]
    ds_read_b128 v[112:115], v8 offset:12288
    v_mfma_f32_16x16x32_bf16 v[72:75], a[224:227], v[116:119], v[72:75]
    buffer_load_dwordx4 v28, s[68:71], s72 offen offset:0 lds
    buffer_load_dwordx4 v29, s[68:71], s72 offen offset:1024 lds
    v_mfma_f32_16x16x32_bf16 v[80:83], a[224:227], v[120:123], v[80:83]
    ds_read_b128 v[116:119], v8 offset:14336
    v_mfma_f32_16x16x32_bf16 v[84:87], a[228:231], v[120:123], v[84:87]
    buffer_load_dwordx4 v30, s[68:71], s72 offen offset:2048 lds
    buffer_load_dwordx4 v31, s[68:71], s72 offen offset:3072 lds
    s_waitcnt lgkmcnt(15)
    v_mfma_f32_16x16x32_bf16 v[92:95], a[228:231], v[124:127], v[92:95]
    ds_read_b128 v[120:123], v9 offset:12288
    v_mfma_f32_16x16x32_bf16 v[88:91], a[224:227], v[124:127], v[88:91]
    s_add_u32 s72, s72, 131072
    v_mfma_f32_16x16x32_bf16 v[32:35], a[232:235], v[128:131], v[32:35]
    ds_read_b128 v[124:127], v9 offset:14336
    v_mfma_f32_16x16x32_bf16 v[36:39], a[236:239], v[128:131], v[36:39]
    s_add_u32 m0, s98, 32768
    v_mfma_f32_16x16x32_bf16 v[44:47], a[236:239], v[132:135], v[44:47]
    ds_read_b128 v[128:131], v10 offset:12288
    v_mfma_f32_16x16x32_bf16 v[40:43], a[232:235], v[132:135], v[40:43]
    buffer_load_dwordx4 v16, s[32:35], s84 offen offset:0 sc1 lds
    v_mfma_f32_16x16x32_bf16 v[48:51], a[232:235], v[136:139], v[48:51]
    ds_read_b128 v[132:135], v10 offset:14336
    v_mfma_f32_16x16x32_bf16 v[52:55], a[236:239], v[136:139], v[52:55]
    buffer_load_dwordx4 v16, s[32:35], s84 offen offset:1024 sc1 lds
    s_waitcnt lgkmcnt(15)
    v_mfma_f32_16x16x32_bf16 v[60:63], a[236:239], v[140:143], v[60:63]
    ds_read_b128 v[136:139], v11 offset:12288
    v_mfma_f32_16x16x32_bf16 v[56:59], a[232:235], v[140:143], v[56:59]
    buffer_load_dwordx4 v12, s[32:35], s84 offen offset:2048 sc1 lds
    v_mfma_f32_16x16x32_bf16 v[64:67], a[232:235], v[96:99], v[64:67]
    ds_read_b128 v[140:143], v11 offset:14336
    v_mfma_f32_16x16x32_bf16 v[68:71], a[236:239], v[96:99], v[68:71]
    buffer_load_dwordx4 v12, s[32:35], s84 offen offset:3072 sc1 lds
    s_waitcnt lgkmcnt(15)
    v_mfma_f32_16x16x32_bf16 v[76:79], a[236:239], v[100:103], v[76:79]
    ds_read_b128 v[96:99], v8 offset:13312
    v_mfma_f32_16x16x32_bf16 v[72:75], a[232:235], v[100:103], v[72:75]
    s_add_u32 s84, s84, 2048
    s_waitcnt lgkmcnt(13)
    v_mfma_f32_16x16x32_bf16 v[80:83], a[232:235], v[104:107], v[80:83]
    ds_read_b128 v[100:103], v8 offset:15360
    v_mfma_f32_16x16x32_bf16 v[84:87], a[236:239], v[104:107], v[84:87]
    s_waitcnt lgkmcnt(11)
    v_mfma_f32_16x16x32_bf16 v[92:95], a[236:239], v[108:111], v[92:95]
    ds_read_b128 v[104:107], v9 offset:13312
    v_mfma_f32_16x16x32_bf16 v[88:91], a[232:235], v[108:111], v[88:91]
    s_waitcnt lgkmcnt(10)
    v_mfma_f32_16x16x32_bf16 v[32:35], a[240:243], v[112:115], v[32:35]
    ds_read_b128 v[108:111], v9 offset:15360
    v_mfma_f32_16x16x32_bf16 v[36:39], a[244:247], v[112:115], v[36:39]
    s_waitcnt vmcnt(12)
    ds_read_b64_tr_b16 a[96:97], v3 offset:4096
    s_waitcnt lgkmcnt(11)
    v_mfma_f32_16x16x32_bf16 v[44:47], a[244:247], v[116:119], v[44:47]
    ds_read_b128 v[112:115], v10 offset:13312
    v_mfma_f32_16x16x32_bf16 v[40:43], a[240:243], v[116:119], v[40:43]
    ds_read_b64_tr_b16 a[98:99], v3 offset:5120
    ds_read_b64_tr_b16 a[100:101], v4 offset:4096
    s_waitcnt lgkmcnt(13)
    v_mfma_f32_16x16x32_bf16 v[48:51], a[240:243], v[120:123], v[48:51]
    ds_read_b128 v[116:119], v10 offset:15360
    v_mfma_f32_16x16x32_bf16 v[52:55], a[244:247], v[120:123], v[52:55]
    ds_read_b64_tr_b16 a[102:103], v4 offset:5120
    ds_read_b64_tr_b16 a[104:105], v3 offset:6144
    s_waitcnt lgkmcnt(15)
    v_mfma_f32_16x16x32_bf16 v[60:63], a[244:247], v[124:127], v[60:63]
    ds_read_b128 v[120:123], v11 offset:13312
    v_mfma_f32_16x16x32_bf16 v[56:59], a[240:243], v[124:127], v[56:59]
    ds_read_b64_tr_b16 a[106:107], v3 offset:7168
    ds_read_b64_tr_b16 a[108:109], v4 offset:6144
    s_waitcnt lgkmcnt(15)
    v_mfma_f32_16x16x32_bf16 v[64:67], a[240:243], v[128:131], v[64:67]
    ds_read_b128 v[124:127], v11 offset:15360
    v_mfma_f32_16x16x32_bf16 v[68:71], a[244:247], v[128:131], v[68:71]
    ds_read_b64_tr_b16 a[110:111], v4 offset:7168
    s_barrier
    v_mfma_f32_16x16x32_bf16 v[76:79], a[244:247], v[132:135], v[76:79]
    ds_read_b128 v[128:131], v8 offset:16384
    v_mfma_f32_16x16x32_bf16 v[72:75], a[240:243], v[132:135], v[72:75]
    v_mfma_f32_16x16x32_bf16 v[80:83], a[240:243], v[136:139], v[80:83]
    ds_read_b128 v[132:135], v8 offset:18432
    v_mfma_f32_16x16x32_bf16 v[84:87], a[244:247], v[136:139], v[84:87]
    s_waitcnt lgkmcnt(15)
    v_mfma_f32_16x16x32_bf16 v[92:95], a[244:247], v[140:143], v[92:95]
    ds_read_b128 v[136:139], v9 offset:16384
    v_mfma_f32_16x16x32_bf16 v[88:91], a[240:243], v[140:143], v[88:91]
    v_mfma_f32_16x16x32_bf16 v[32:35], a[248:251], v[96:99], v[32:35]
    ds_read_b128 v[140:143], v9 offset:18432
    v_mfma_f32_16x16x32_bf16 v[36:39], a[252:255], v[96:99], v[36:39]
    s_add_u32 m0, s98, 36864
    v_mfma_f32_16x16x32_bf16 v[44:47], a[252:255], v[100:103], v[44:47]
    ds_read_b128 v[96:99], v10 offset:16384
    v_mfma_f32_16x16x32_bf16 v[40:43], a[248:251], v[100:103], v[40:43]
    buffer_load_dwordx4 v16, s[32:35], s84 offen offset:0 sc1 lds
    v_mfma_f32_16x16x32_bf16 v[48:51], a[248:251], v[104:107], v[48:51]
    ds_read_b128 v[100:103], v10 offset:18432
    v_mfma_f32_16x16x32_bf16 v[52:55], a[252:255], v[104:107], v[52:55]
    buffer_load_dwordx4 v16, s[32:35], s84 offen offset:1024 sc1 lds
    s_waitcnt lgkmcnt(15)
    v_mfma_f32_16x16x32_bf16 v[60:63], a[252:255], v[108:111], v[60:63]
    ds_read_b128 v[104:107], v11 offset:16384
    v_mfma_f32_16x16x32_bf16 v[56:59], a[248:251], v[108:111], v[56:59]
    buffer_load_dwordx4 v12, s[32:35], s84 offen offset:2048 sc1 lds
    v_mfma_f32_16x16x32_bf16 v[64:67], a[248:251], v[112:115], v[64:67]
    ds_read_b128 v[108:111], v11 offset:18432
    v_mfma_f32_16x16x32_bf16 v[68:71], a[252:255], v[112:115], v[68:71]
    buffer_load_dwordx4 v12, s[32:35], s84 offen offset:3072 sc1 lds
    s_waitcnt lgkmcnt(15)
    v_mfma_f32_16x16x32_bf16 v[76:79], a[252:255], v[116:119], v[76:79]
    ds_read2st64_b64 v[112:115], v24 offset0:34 offset1:35
    v_mfma_f32_16x16x32_bf16 v[72:75], a[248:251], v[116:119], v[72:75]
    s_add_u32 s84, s84, 2048
    s_waitcnt lgkmcnt(13)
    v_mfma_f32_16x16x32_bf16 v[80:83], a[248:251], v[120:123], v[80:83]
    ds_read2st64_b64 v[116:119], v24 offset0:38 offset1:39
    v_mfma_f32_16x16x32_bf16 v[84:87], a[252:255], v[120:123], v[84:87]
    s_waitcnt lgkmcnt(11)
    v_mfma_f32_16x16x32_bf16 v[92:95], a[252:255], v[124:127], v[92:95]
    ds_read2st64_b64 v[120:123], v25 offset0:34 offset1:35
    v_mfma_f32_16x16x32_bf16 v[88:91], a[248:251], v[124:127], v[88:91]
    s_waitcnt lgkmcnt(10)
    v_mfma_f32_16x16x32_bf16 v[32:35], a[0:3], v[128:131], v[32:35]
    ds_read2st64_b64 v[124:127], v25 offset0:38 offset1:39
    v_mfma_f32_16x16x32_bf16 v[36:39], a[4:7], v[128:131], v[36:39]
    s_waitcnt vmcnt(8)
    ds_read_b64_tr_b16 a[112:113], v3 offset:8192
    s_waitcnt lgkmcnt(11)
    v_mfma_f32_16x16x32_bf16 v[44:47], a[4:7], v[132:135], v[44:47]
    ds_read2st64_b64 v[128:131], v26 offset0:34 offset1:35
    v_mfma_f32_16x16x32_bf16 v[40:43], a[0:3], v[132:135], v[40:43]
    ds_read_b64_tr_b16 a[114:115], v3 offset:9216
    ds_read_b64_tr_b16 a[116:117], v4 offset:8192
    s_waitcnt lgkmcnt(13)
    v_mfma_f32_16x16x32_bf16 v[48:51], a[0:3], v[136:139], v[48:51]
    ds_read2st64_b64 v[132:135], v26 offset0:38 offset1:39
    v_mfma_f32_16x16x32_bf16 v[52:55], a[4:7], v[136:139], v[52:55]
    ds_read_b64_tr_b16 a[118:119], v4 offset:9216
    ds_read_b64_tr_b16 a[120:121], v3 offset:10240
    s_waitcnt lgkmcnt(15)
    v_mfma_f32_16x16x32_bf16 v[60:63], a[4:7], v[140:143], v[60:63]
    ds_read2st64_b64 v[136:139], v27 offset0:34 offset1:35
    v_mfma_f32_16x16x32_bf16 v[56:59], a[0:3], v[140:143], v[56:59]
    ds_read_b64_tr_b16 a[122:123], v3 offset:11264
    ds_read_b64_tr_b16 a[124:125], v4 offset:10240
    s_waitcnt lgkmcnt(15)
    v_mfma_f32_16x16x32_bf16 v[64:67], a[0:3], v[96:99], v[64:67]
    ds_read2st64_b64 v[140:143], v27 offset0:38 offset1:39
    v_mfma_f32_16x16x32_bf16 v[68:71], a[4:7], v[96:99], v[68:71]
    ds_read_b64_tr_b16 a[126:127], v4 offset:11264
    s_add_u32 m0, s98, 0
    s_barrier
    v_mfma_f32_16x16x32_bf16 v[76:79], a[4:7], v[100:103], v[76:79]
    ds_read_b128 v[96:99], v8 offset:20480
    v_mfma_f32_16x16x32_bf16 v[72:75], a[0:3], v[100:103], v[72:75]
    buffer_load_dwordx4 v28, s[68:71], s72 offen offset:0 lds
    buffer_load_dwordx4 v29, s[68:71], s72 offen offset:1024 lds
    v_mfma_f32_16x16x32_bf16 v[80:83], a[0:3], v[104:107], v[80:83]
    ds_read_b128 v[100:103], v8 offset:22528
    v_mfma_f32_16x16x32_bf16 v[84:87], a[4:7], v[104:107], v[84:87]
    buffer_load_dwordx4 v30, s[68:71], s72 offen offset:2048 lds
    buffer_load_dwordx4 v31, s[68:71], s72 offen offset:3072 lds
    s_waitcnt lgkmcnt(15)
    v_mfma_f32_16x16x32_bf16 v[92:95], a[4:7], v[108:111], v[92:95]
    ds_read_b128 v[104:107], v9 offset:20480
    v_mfma_f32_16x16x32_bf16 v[88:91], a[0:3], v[108:111], v[88:91]
    s_add_u32 s72, s72, 131072
    v_mfma_f32_16x16x32_bf16 v[32:35], a[8:11], v[112:115], v[32:35]
    ds_read_b128 v[108:111], v9 offset:22528
    v_mfma_f32_16x16x32_bf16 v[36:39], a[12:15], v[112:115], v[36:39]
    s_add_u32 m0, s98, 12288
    v_mfma_f32_16x16x32_bf16 v[44:47], a[12:15], v[116:119], v[44:47]
    ds_read_b128 v[112:115], v10 offset:20480
    v_mfma_f32_16x16x32_bf16 v[40:43], a[8:11], v[116:119], v[40:43]
    buffer_load_dwordx4 v16, s[32:35], s84 offen offset:0 sc1 lds
    v_mfma_f32_16x16x32_bf16 v[48:51], a[8:11], v[120:123], v[48:51]
    ds_read_b128 v[116:119], v10 offset:22528
    v_mfma_f32_16x16x32_bf16 v[52:55], a[12:15], v[120:123], v[52:55]
    buffer_load_dwordx4 v16, s[32:35], s84 offen offset:1024 sc1 lds
    s_waitcnt lgkmcnt(15)
    v_mfma_f32_16x16x32_bf16 v[60:63], a[12:15], v[124:127], v[60:63]
    ds_read_b128 v[120:123], v11 offset:20480
    v_mfma_f32_16x16x32_bf16 v[56:59], a[8:11], v[124:127], v[56:59]
    buffer_load_dwordx4 v12, s[32:35], s84 offen offset:2048 sc1 lds
    v_mfma_f32_16x16x32_bf16 v[64:67], a[8:11], v[128:131], v[64:67]
    ds_read_b128 v[124:127], v11 offset:22528
    v_mfma_f32_16x16x32_bf16 v[68:71], a[12:15], v[128:131], v[68:71]
    buffer_load_dwordx4 v12, s[32:35], s84 offen offset:3072 sc1 lds
    s_waitcnt lgkmcnt(15)
    v_mfma_f32_16x16x32_bf16 v[76:79], a[12:15], v[132:135], v[76:79]
    ds_read_b128 v[128:131], v8 offset:21504
    v_mfma_f32_16x16x32_bf16 v[72:75], a[8:11], v[132:135], v[72:75]
    s_add_u32 s84, s84, 2048
    s_waitcnt lgkmcnt(13)
    v_mfma_f32_16x16x32_bf16 v[80:83], a[8:11], v[136:139], v[80:83]
    ds_read_b128 v[132:135], v8 offset:23552
    v_mfma_f32_16x16x32_bf16 v[84:87], a[12:15], v[136:139], v[84:87]
    s_waitcnt lgkmcnt(11)
    v_mfma_f32_16x16x32_bf16 v[92:95], a[12:15], v[140:143], v[92:95]
    ds_read_b128 v[136:139], v9 offset:21504
    v_mfma_f32_16x16x32_bf16 v[88:91], a[8:11], v[140:143], v[88:91]
    s_waitcnt lgkmcnt(10)
    v_mfma_f32_16x16x32_bf16 v[32:35], a[16:19], v[96:99], v[32:35]
    ds_read_b128 v[140:143], v9 offset:23552
    v_mfma_f32_16x16x32_bf16 v[36:39], a[20:23], v[96:99], v[36:39]
    s_add_u32 m0, s98, 4096
    s_waitcnt lgkmcnt(10)
    v_mfma_f32_16x16x32_bf16 v[44:47], a[20:23], v[100:103], v[44:47]
    ds_read_b128 v[96:99], v10 offset:21504
    v_mfma_f32_16x16x32_bf16 v[40:43], a[16:19], v[100:103], v[40:43]
    buffer_load_dwordx4 v28, s[68:71], s72 offen offset:0 lds
    s_waitcnt lgkmcnt(10)
    v_mfma_f32_16x16x32_bf16 v[48:51], a[16:19], v[104:107], v[48:51]
    ds_read_b128 v[100:103], v10 offset:23552
    v_mfma_f32_16x16x32_bf16 v[52:55], a[20:23], v[104:107], v[52:55]
    buffer_load_dwordx4 v29, s[68:71], s72 offen offset:1024 lds
    s_waitcnt lgkmcnt(10)
    v_mfma_f32_16x16x32_bf16 v[60:63], a[20:23], v[108:111], v[60:63]
    ds_read_b128 v[104:107], v11 offset:21504
    v_mfma_f32_16x16x32_bf16 v[56:59], a[16:19], v[108:111], v[56:59]
    buffer_load_dwordx4 v30, s[68:71], s72 offen offset:2048 lds
    s_waitcnt lgkmcnt(10)
    v_mfma_f32_16x16x32_bf16 v[64:67], a[16:19], v[112:115], v[64:67]
    ds_read_b128 v[108:111], v11 offset:23552
    v_mfma_f32_16x16x32_bf16 v[68:71], a[20:23], v[112:115], v[68:71]
    buffer_load_dwordx4 v31, s[68:71], s72 offen offset:3072 lds
    s_barrier
    s_waitcnt lgkmcnt(10)
    v_mfma_f32_16x16x32_bf16 v[76:79], a[20:23], v[116:119], v[76:79]
    ds_read_b128 v[112:115], v8 offset:24576
    v_mfma_f32_16x16x32_bf16 v[72:75], a[16:19], v[116:119], v[72:75]
    s_add_u32 s72, s72, 131072
    s_waitcnt lgkmcnt(10)
    v_mfma_f32_16x16x32_bf16 v[80:83], a[16:19], v[120:123], v[80:83]
    ds_read_b128 v[116:119], v8 offset:26624
    v_mfma_f32_16x16x32_bf16 v[84:87], a[20:23], v[120:123], v[84:87]
    s_waitcnt lgkmcnt(10)
    v_mfma_f32_16x16x32_bf16 v[92:95], a[20:23], v[124:127], v[92:95]
    ds_read_b128 v[120:123], v9 offset:24576
    v_mfma_f32_16x16x32_bf16 v[88:91], a[16:19], v[124:127], v[88:91]
    s_waitcnt lgkmcnt(10)
    v_mfma_f32_16x16x32_bf16 v[32:35], a[24:27], v[128:131], v[32:35]
    ds_read_b128 v[124:127], v9 offset:26624
    v_mfma_f32_16x16x32_bf16 v[36:39], a[28:31], v[128:131], v[36:39]
    s_add_u32 m0, s98, 16384
    s_waitcnt lgkmcnt(10)
    v_mfma_f32_16x16x32_bf16 v[44:47], a[28:31], v[132:135], v[44:47]
    ds_read_b128 v[128:131], v10 offset:24576
    v_mfma_f32_16x16x32_bf16 v[40:43], a[24:27], v[132:135], v[40:43]
    buffer_load_dwordx4 v16, s[32:35], s84 offen offset:0 sc1 lds
    s_waitcnt lgkmcnt(10)
    v_mfma_f32_16x16x32_bf16 v[48:51], a[24:27], v[136:139], v[48:51]
    ds_read_b128 v[132:135], v10 offset:26624
    v_mfma_f32_16x16x32_bf16 v[52:55], a[28:31], v[136:139], v[52:55]
    buffer_load_dwordx4 v16, s[32:35], s84 offen offset:1024 sc1 lds
    s_waitcnt lgkmcnt(10)
    v_mfma_f32_16x16x32_bf16 v[60:63], a[28:31], v[140:143], v[60:63]
    ds_read_b128 v[136:139], v11 offset:24576
    v_mfma_f32_16x16x32_bf16 v[56:59], a[24:27], v[140:143], v[56:59]
    buffer_load_dwordx4 v12, s[32:35], s84 offen offset:2048 sc1 lds
    s_waitcnt lgkmcnt(10)
    v_mfma_f32_16x16x32_bf16 v[64:67], a[24:27], v[96:99], v[64:67]
    ds_read_b128 v[140:143], v11 offset:26624
    v_mfma_f32_16x16x32_bf16 v[68:71], a[28:31], v[96:99], v[68:71]
    buffer_load_dwordx4 v12, s[32:35], s84 offen offset:3072 sc1 lds
    s_waitcnt lgkmcnt(10)
    v_mfma_f32_16x16x32_bf16 v[76:79], a[28:31], v[100:103], v[76:79]
    ds_read_b128 v[96:99], v8 offset:25600
    v_mfma_f32_16x16x32_bf16 v[72:75], a[24:27], v[100:103], v[72:75]
    s_add_u32 s84, s84, 2048
    s_waitcnt lgkmcnt(10)
    v_mfma_f32_16x16x32_bf16 v[80:83], a[24:27], v[104:107], v[80:83]
    ds_read_b128 v[100:103], v8 offset:27648
    v_mfma_f32_16x16x32_bf16 v[84:87], a[28:31], v[104:107], v[84:87]
    s_waitcnt lgkmcnt(10)
    v_mfma_f32_16x16x32_bf16 v[92:95], a[28:31], v[108:111], v[92:95]
    ds_read_b128 v[104:107], v9 offset:25600
    v_mfma_f32_16x16x32_bf16 v[88:91], a[24:27], v[108:111], v[88:91]
    s_waitcnt lgkmcnt(10)
    v_mfma_f32_16x16x32_bf16 v[32:35], a[32:35], v[112:115], v[32:35]
    ds_read_b128 v[108:111], v9 offset:27648
    v_mfma_f32_16x16x32_bf16 v[36:39], a[36:39], v[112:115], v[36:39]
    s_waitcnt vmcnt(12)
    ds_read_b64_tr_b16 v[144:145], v3 offset:0
    s_waitcnt lgkmcnt(11)
    v_mfma_f32_16x16x32_bf16 v[44:47], a[36:39], v[116:119], v[44:47]
    ds_read_b128 v[112:115], v10 offset:25600
    v_mfma_f32_16x16x32_bf16 v[40:43], a[32:35], v[116:119], v[40:43]
    ds_read_b64_tr_b16 v[146:147], v3 offset:1024
    ds_read_b64_tr_b16 v[148:149], v4 offset:0
    s_waitcnt lgkmcnt(13)
    v_mfma_f32_16x16x32_bf16 v[48:51], a[32:35], v[120:123], v[48:51]
    ds_read_b128 v[116:119], v10 offset:27648
    v_mfma_f32_16x16x32_bf16 v[52:55], a[36:39], v[120:123], v[52:55]
    ds_read_b64_tr_b16 v[150:151], v4 offset:1024
    ds_read_b64_tr_b16 v[152:153], v3 offset:2048
    s_waitcnt lgkmcnt(15)
    v_mfma_f32_16x16x32_bf16 v[60:63], a[36:39], v[124:127], v[60:63]
    ds_read_b128 v[120:123], v11 offset:25600
    v_mfma_f32_16x16x32_bf16 v[56:59], a[32:35], v[124:127], v[56:59]
    ds_read_b64_tr_b16 v[154:155], v3 offset:3072
    ds_read_b64_tr_b16 v[156:157], v4 offset:2048
    s_waitcnt lgkmcnt(15)
    v_mfma_f32_16x16x32_bf16 v[64:67], a[32:35], v[128:131], v[64:67]
    ds_read_b128 v[124:127], v11 offset:27648
    v_mfma_f32_16x16x32_bf16 v[68:71], a[36:39], v[128:131], v[68:71]
    ds_read_b64_tr_b16 v[158:159], v4 offset:3072
    s_add_u32 m0, s98, 8192
    s_barrier
    v_mfma_f32_16x16x32_bf16 v[76:79], a[36:39], v[132:135], v[76:79]
    ds_read_b128 v[128:131], v8 offset:28672
    v_mfma_f32_16x16x32_bf16 v[72:75], a[32:35], v[132:135], v[72:75]
    buffer_load_dwordx4 v28, s[68:71], s72 offen offset:0 lds
    buffer_load_dwordx4 v29, s[68:71], s72 offen offset:1024 lds
    v_mfma_f32_16x16x32_bf16 v[80:83], a[32:35], v[136:139], v[80:83]
    ds_read_b128 v[132:135], v8 offset:30720
    v_mfma_f32_16x16x32_bf16 v[84:87], a[36:39], v[136:139], v[84:87]
    buffer_load_dwordx4 v30, s[68:71], s72 offen offset:2048 lds
    buffer_load_dwordx4 v31, s[68:71], s72 offen offset:3072 lds
    s_waitcnt lgkmcnt(15)
    v_mfma_f32_16x16x32_bf16 v[92:95], a[36:39], v[140:143], v[92:95]
    ds_read_b128 v[136:139], v9 offset:28672
    v_mfma_f32_16x16x32_bf16 v[88:91], a[32:35], v[140:143], v[88:91]
    s_add_u32 s72, s72, 131072
    v_mfma_f32_16x16x32_bf16 v[32:35], a[40:43], v[96:99], v[32:35]
    ds_read_b128 v[140:143], v9 offset:30720
    v_mfma_f32_16x16x32_bf16 v[36:39], a[44:47], v[96:99], v[36:39]
    s_add_u32 m0, s98, 20480
    v_mfma_f32_16x16x32_bf16 v[44:47], a[44:47], v[100:103], v[44:47]
    ds_read_b128 v[96:99], v10 offset:28672
    v_mfma_f32_16x16x32_bf16 v[40:43], a[40:43], v[100:103], v[40:43]
    buffer_load_dwordx4 v16, s[32:35], s84 offen offset:0 sc1 lds
    v_mfma_f32_16x16x32_bf16 v[48:51], a[40:43], v[104:107], v[48:51]
    ds_read_b128 v[100:103], v10 offset:30720
    v_mfma_f32_16x16x32_bf16 v[52:55], a[44:47], v[104:107], v[52:55]
    buffer_load_dwordx4 v16, s[32:35], s84 offen offset:1024 sc1 lds
    s_waitcnt lgkmcnt(15)
    v_mfma_f32_16x16x32_bf16 v[60:63], a[44:47], v[108:111], v[60:63]
    ds_read_b128 v[104:107], v11 offset:28672
    v_mfma_f32_16x16x32_bf16 v[56:59], a[40:43], v[108:111], v[56:59]
    buffer_load_dwordx4 v12, s[32:35], s84 offen offset:2048 sc1 lds
    v_mfma_f32_16x16x32_bf16 v[64:67], a[40:43], v[112:115], v[64:67]
    ds_read_b128 v[108:111], v11 offset:30720
    v_mfma_f32_16x16x32_bf16 v[68:71], a[44:47], v[112:115], v[68:71]
    buffer_load_dwordx4 v12, s[32:35], s84 offen offset:3072 sc1 lds
    s_waitcnt lgkmcnt(15)
    v_mfma_f32_16x16x32_bf16 v[76:79], a[44:47], v[116:119], v[76:79]
    ds_read_b128 v[112:115], v8 offset:29696
    v_mfma_f32_16x16x32_bf16 v[72:75], a[40:43], v[116:119], v[72:75]
    s_add_u32 s84, s84, 2048
    s_waitcnt lgkmcnt(13)
    v_mfma_f32_16x16x32_bf16 v[80:83], a[40:43], v[120:123], v[80:83]
    ds_read_b128 v[116:119], v8 offset:31744
    v_mfma_f32_16x16x32_bf16 v[84:87], a[44:47], v[120:123], v[84:87]
    s_waitcnt lgkmcnt(11)
    v_mfma_f32_16x16x32_bf16 v[92:95], a[44:47], v[124:127], v[92:95]
    ds_read_b128 v[120:123], v9 offset:29696
    v_mfma_f32_16x16x32_bf16 v[88:91], a[40:43], v[124:127], v[88:91]
    s_waitcnt lgkmcnt(10)
    v_mfma_f32_16x16x32_bf16 v[32:35], a[48:51], v[128:131], v[32:35]
    ds_read_b128 v[124:127], v9 offset:31744
    v_mfma_f32_16x16x32_bf16 v[36:39], a[52:55], v[128:131], v[36:39]
    s_waitcnt vmcnt(12)
    ds_read_b64_tr_b16 v[160:161], v3 offset:4096
    s_waitcnt lgkmcnt(11)
    v_mfma_f32_16x16x32_bf16 v[44:47], a[52:55], v[132:135], v[44:47]
    ds_read_b128 v[128:131], v10 offset:29696
    v_mfma_f32_16x16x32_bf16 v[40:43], a[48:51], v[132:135], v[40:43]
    ds_read_b64_tr_b16 v[162:163], v3 offset:5120
    ds_read_b64_tr_b16 v[164:165], v4 offset:4096
    s_waitcnt lgkmcnt(13)
    v_mfma_f32_16x16x32_bf16 v[48:51], a[48:51], v[136:139], v[48:51]
    ds_read_b128 v[132:135], v10 offset:31744
    v_mfma_f32_16x16x32_bf16 v[52:55], a[52:55], v[136:139], v[52:55]
    ds_read_b64_tr_b16 v[166:167], v4 offset:5120
    ds_read_b64_tr_b16 v[168:169], v3 offset:6144
    s_waitcnt lgkmcnt(15)
    v_mfma_f32_16x16x32_bf16 v[60:63], a[52:55], v[140:143], v[60:63]
    ds_read_b128 v[136:139], v11 offset:29696
    v_mfma_f32_16x16x32_bf16 v[56:59], a[48:51], v[140:143], v[56:59]
    ds_read_b64_tr_b16 v[170:171], v3 offset:7168
    ds_read_b64_tr_b16 v[172:173], v4 offset:6144
    s_waitcnt lgkmcnt(15)
    v_mfma_f32_16x16x32_bf16 v[64:67], a[48:51], v[96:99], v[64:67]
    ds_read_b128 v[140:143], v11 offset:31744
    v_mfma_f32_16x16x32_bf16 v[68:71], a[52:55], v[96:99], v[68:71]
    ds_read_b64_tr_b16 v[174:175], v4 offset:7168
    s_barrier
    v_mfma_f32_16x16x32_bf16 v[76:79], a[52:55], v[100:103], v[76:79]
    ds_read2st64_b64 v[96:99], v24 offset0:64 offset1:65
    v_mfma_f32_16x16x32_bf16 v[72:75], a[48:51], v[100:103], v[72:75]
    v_mfma_f32_16x16x32_bf16 v[80:83], a[48:51], v[104:107], v[80:83]
    ds_read2st64_b64 v[100:103], v24 offset0:68 offset1:69
    v_mfma_f32_16x16x32_bf16 v[84:87], a[52:55], v[104:107], v[84:87]
    s_waitcnt lgkmcnt(15)
    v_mfma_f32_16x16x32_bf16 v[92:95], a[52:55], v[108:111], v[92:95]
    ds_read2st64_b64 v[104:107], v25 offset0:64 offset1:65
    v_mfma_f32_16x16x32_bf16 v[88:91], a[48:51], v[108:111], v[88:91]
    v_mfma_f32_16x16x32_bf16 v[32:35], a[56:59], v[112:115], v[32:35]
    ds_read2st64_b64 v[108:111], v25 offset0:68 offset1:69
    v_mfma_f32_16x16x32_bf16 v[36:39], a[60:63], v[112:115], v[36:39]
    s_add_u32 m0, s98, 24576
    v_mfma_f32_16x16x32_bf16 v[44:47], a[60:63], v[116:119], v[44:47]
    ds_read2st64_b64 v[112:115], v26 offset0:64 offset1:65
    v_mfma_f32_16x16x32_bf16 v[40:43], a[56:59], v[116:119], v[40:43]
    buffer_load_dwordx4 v16, s[32:35], s84 offen offset:0 sc1 lds
    v_mfma_f32_16x16x32_bf16 v[48:51], a[56:59], v[120:123], v[48:51]
    ds_read2st64_b64 v[116:119], v26 offset0:68 offset1:69
    v_mfma_f32_16x16x32_bf16 v[52:55], a[60:63], v[120:123], v[52:55]
    buffer_load_dwordx4 v16, s[32:35], s84 offen offset:1024 sc1 lds
    s_waitcnt lgkmcnt(15)
    v_mfma_f32_16x16x32_bf16 v[60:63], a[60:63], v[124:127], v[60:63]
    ds_read2st64_b64 v[120:123], v27 offset0:64 offset1:65
    v_mfma_f32_16x16x32_bf16 v[56:59], a[56:59], v[124:127], v[56:59]
    buffer_load_dwordx4 v12, s[32:35], s84 offen offset:2048 sc1 lds
    v_mfma_f32_16x16x32_bf16 v[64:67], a[56:59], v[128:131], v[64:67]
    ds_read2st64_b64 v[124:127], v27 offset0:68 offset1:69
    v_mfma_f32_16x16x32_bf16 v[68:71], a[60:63], v[128:131], v[68:71]
    buffer_load_dwordx4 v12, s[32:35], s84 offen offset:3072 sc1 lds
    s_waitcnt lgkmcnt(15)
    v_mfma_f32_16x16x32_bf16 v[76:79], a[60:63], v[132:135], v[76:79]
    ds_read_b128 v[128:131], v8 offset:33792
    v_mfma_f32_16x16x32_bf16 v[72:75], a[56:59], v[132:135], v[72:75]
    s_add_u32 s84, s84, 2048
    s_waitcnt lgkmcnt(13)
    v_mfma_f32_16x16x32_bf16 v[80:83], a[56:59], v[136:139], v[80:83]
    ds_read_b128 v[132:135], v8 offset:35840
    v_mfma_f32_16x16x32_bf16 v[84:87], a[60:63], v[136:139], v[84:87]
    s_waitcnt lgkmcnt(11)
    v_mfma_f32_16x16x32_bf16 v[92:95], a[60:63], v[140:143], v[92:95]
    ds_read_b128 v[136:139], v9 offset:33792
    v_mfma_f32_16x16x32_bf16 v[88:91], a[56:59], v[140:143], v[88:91]
    s_waitcnt lgkmcnt(10)
    v_mfma_f32_16x16x32_bf16 v[32:35], a[64:67], v[96:99], v[32:35]
    ds_read_b128 v[140:143], v9 offset:35840
    v_mfma_f32_16x16x32_bf16 v[36:39], a[68:71], v[96:99], v[36:39]
    s_waitcnt vmcnt(8)
    ds_read_b64_tr_b16 v[176:177], v3 offset:8192
    s_waitcnt lgkmcnt(11)
    v_mfma_f32_16x16x32_bf16 v[44:47], a[68:71], v[100:103], v[44:47]
    ds_read_b128 v[96:99], v10 offset:33792
    v_mfma_f32_16x16x32_bf16 v[40:43], a[64:67], v[100:103], v[40:43]
    ds_read_b64_tr_b16 v[178:179], v3 offset:9216
    ds_read_b64_tr_b16 v[180:181], v4 offset:8192
    s_waitcnt lgkmcnt(13)
    v_mfma_f32_16x16x32_bf16 v[48:51], a[64:67], v[104:107], v[48:51]
    ds_read_b128 v[100:103], v10 offset:35840
    v_mfma_f32_16x16x32_bf16 v[52:55], a[68:71], v[104:107], v[52:55]
    ds_read_b64_tr_b16 v[182:183], v4 offset:9216
    ds_read_b64_tr_b16 v[184:185], v3 offset:10240
    s_waitcnt lgkmcnt(15)
    v_mfma_f32_16x16x32_bf16 v[60:63], a[68:71], v[108:111], v[60:63]
    ds_read_b128 v[104:107], v11 offset:33792
    v_mfma_f32_16x16x32_bf16 v[56:59], a[64:67], v[108:111], v[56:59]
    ds_read_b64_tr_b16 v[186:187], v3 offset:11264
    ds_read_b64_tr_b16 v[188:189], v4 offset:10240
    s_waitcnt lgkmcnt(15)
    v_mfma_f32_16x16x32_bf16 v[64:67], a[64:67], v[112:115], v[64:67]
    ds_read_b128 v[108:111], v11 offset:35840
    v_mfma_f32_16x16x32_bf16 v[68:71], a[68:71], v[112:115], v[68:71]
    ds_read_b64_tr_b16 v[190:191], v4 offset:11264
    s_add_u32 m0, s98, 0
    s_barrier
    v_mfma_f32_16x16x32_bf16 v[76:79], a[68:71], v[116:119], v[76:79]
    ds_read_b128 v[112:115], v8 offset:36864
    v_mfma_f32_16x16x32_bf16 v[72:75], a[64:67], v[116:119], v[72:75]
    buffer_load_dwordx4 v28, s[68:71], s72 offen offset:0 lds
    buffer_load_dwordx4 v29, s[68:71], s72 offen offset:1024 lds
    v_mfma_f32_16x16x32_bf16 v[80:83], a[64:67], v[120:123], v[80:83]
    ds_read_b128 v[116:119], v8 offset:38912
    v_mfma_f32_16x16x32_bf16 v[84:87], a[68:71], v[120:123], v[84:87]
    buffer_load_dwordx4 v30, s[68:71], s72 offen offset:2048 lds
    buffer_load_dwordx4 v31, s[68:71], s72 offen offset:3072 lds
    s_waitcnt lgkmcnt(15)
    v_mfma_f32_16x16x32_bf16 v[92:95], a[68:71], v[124:127], v[92:95]
    ds_read_b128 v[120:123], v9 offset:36864
    v_mfma_f32_16x16x32_bf16 v[88:91], a[64:67], v[124:127], v[88:91]
    s_add_u32 s72, s72, 131072
    v_mfma_f32_16x16x32_bf16 v[32:35], a[72:75], v[128:131], v[32:35]
    ds_read_b128 v[124:127], v9 offset:38912
    v_mfma_f32_16x16x32_bf16 v[36:39], a[76:79], v[128:131], v[36:39]
    s_add_u32 m0, s98, 28672
    v_mfma_f32_16x16x32_bf16 v[44:47], a[76:79], v[132:135], v[44:47]
    ds_read_b128 v[128:131], v10 offset:36864
    v_mfma_f32_16x16x32_bf16 v[40:43], a[72:75], v[132:135], v[40:43]
    buffer_load_dwordx4 v16, s[32:35], s84 offen offset:0 sc1 lds
    v_mfma_f32_16x16x32_bf16 v[48:51], a[72:75], v[136:139], v[48:51]
    ds_read_b128 v[132:135], v10 offset:38912
    v_mfma_f32_16x16x32_bf16 v[52:55], a[76:79], v[136:139], v[52:55]
    buffer_load_dwordx4 v16, s[32:35], s84 offen offset:1024 sc1 lds
    s_waitcnt lgkmcnt(15)
    v_mfma_f32_16x16x32_bf16 v[60:63], a[76:79], v[140:143], v[60:63]
    ds_read_b128 v[136:139], v11 offset:36864
    v_mfma_f32_16x16x32_bf16 v[56:59], a[72:75], v[140:143], v[56:59]
    buffer_load_dwordx4 v12, s[32:35], s84 offen offset:2048 sc1 lds
    v_mfma_f32_16x16x32_bf16 v[64:67], a[72:75], v[96:99], v[64:67]
    ds_read_b128 v[140:143], v11 offset:38912
    v_mfma_f32_16x16x32_bf16 v[68:71], a[76:79], v[96:99], v[68:71]
    buffer_load_dwordx4 v12, s[32:35], s84 offen offset:3072 sc1 lds
    s_waitcnt lgkmcnt(15)
    v_mfma_f32_16x16x32_bf16 v[76:79], a[76:79], v[100:103], v[76:79]
    ds_read_b128 v[96:99], v8 offset:37888
    v_mfma_f32_16x16x32_bf16 v[72:75], a[72:75], v[100:103], v[72:75]
    s_add_u32 s84, s84, 2048
    s_waitcnt lgkmcnt(13)
    v_mfma_f32_16x16x32_bf16 v[80:83], a[72:75], v[104:107], v[80:83]
    ds_read_b128 v[100:103], v8 offset:39936
    v_mfma_f32_16x16x32_bf16 v[84:87], a[76:79], v[104:107], v[84:87]
    s_waitcnt lgkmcnt(11)
    v_mfma_f32_16x16x32_bf16 v[92:95], a[76:79], v[108:111], v[92:95]
    ds_read_b128 v[104:107], v9 offset:37888
    v_mfma_f32_16x16x32_bf16 v[88:91], a[72:75], v[108:111], v[88:91]
    s_waitcnt lgkmcnt(10)
    v_mfma_f32_16x16x32_bf16 v[32:35], a[80:83], v[112:115], v[32:35]
    ds_read_b128 v[108:111], v9 offset:39936
    v_mfma_f32_16x16x32_bf16 v[36:39], a[84:87], v[112:115], v[36:39]
    s_add_u32 m0, s98, 4096
    s_waitcnt lgkmcnt(10)
    v_mfma_f32_16x16x32_bf16 v[44:47], a[84:87], v[116:119], v[44:47]
    ds_read_b128 v[112:115], v10 offset:37888
    v_mfma_f32_16x16x32_bf16 v[40:43], a[80:83], v[116:119], v[40:43]
    buffer_load_dwordx4 v28, s[68:71], s72 offen offset:0 lds
    s_waitcnt lgkmcnt(10)
    v_mfma_f32_16x16x32_bf16 v[48:51], a[80:83], v[120:123], v[48:51]
    ds_read_b128 v[116:119], v10 offset:39936
    v_mfma_f32_16x16x32_bf16 v[52:55], a[84:87], v[120:123], v[52:55]
    buffer_load_dwordx4 v29, s[68:71], s72 offen offset:1024 lds
    s_waitcnt lgkmcnt(10)
    v_mfma_f32_16x16x32_bf16 v[60:63], a[84:87], v[124:127], v[60:63]
    ds_read_b128 v[120:123], v11 offset:37888
    v_mfma_f32_16x16x32_bf16 v[56:59], a[80:83], v[124:127], v[56:59]
    buffer_load_dwordx4 v30, s[68:71], s72 offen offset:2048 lds
    s_waitcnt lgkmcnt(10)
    v_mfma_f32_16x16x32_bf16 v[64:67], a[80:83], v[128:131], v[64:67]
    ds_read_b128 v[124:127], v11 offset:39936
    v_mfma_f32_16x16x32_bf16 v[68:71], a[84:87], v[128:131], v[68:71]
    buffer_load_dwordx4 v31, s[68:71], s72 offen offset:3072 lds
    s_barrier
    s_waitcnt lgkmcnt(10)
    v_mfma_f32_16x16x32_bf16 v[76:79], a[84:87], v[132:135], v[76:79]
    ds_read_b128 v[128:131], v8 offset:12288
    v_mfma_f32_16x16x32_bf16 v[72:75], a[80:83], v[132:135], v[72:75]
    s_add_u32 s72, s72, 131072
    s_waitcnt lgkmcnt(10)
    v_mfma_f32_16x16x32_bf16 v[80:83], a[80:83], v[136:139], v[80:83]
    ds_read_b128 v[132:135], v8 offset:14336
    v_mfma_f32_16x16x32_bf16 v[84:87], a[84:87], v[136:139], v[84:87]
    s_waitcnt lgkmcnt(10)
    v_mfma_f32_16x16x32_bf16 v[92:95], a[84:87], v[140:143], v[92:95]
    ds_read_b128 v[136:139], v9 offset:12288
    v_mfma_f32_16x16x32_bf16 v[88:91], a[80:83], v[140:143], v[88:91]
    s_waitcnt lgkmcnt(10)
    v_mfma_f32_16x16x32_bf16 v[32:35], a[88:91], v[96:99], v[32:35]
    ds_read_b128 v[140:143], v9 offset:14336
    v_mfma_f32_16x16x32_bf16 v[36:39], a[92:95], v[96:99], v[36:39]
    s_add_u32 m0, s98, 32768
    s_waitcnt lgkmcnt(10)
    v_mfma_f32_16x16x32_bf16 v[44:47], a[92:95], v[100:103], v[44:47]
    ds_read_b128 v[96:99], v10 offset:12288
    v_mfma_f32_16x16x32_bf16 v[40:43], a[88:91], v[100:103], v[40:43]
    buffer_load_dwordx4 v16, s[32:35], s84 offen offset:0 sc1 lds
    s_waitcnt lgkmcnt(10)
    v_mfma_f32_16x16x32_bf16 v[48:51], a[88:91], v[104:107], v[48:51]
    ds_read_b128 v[100:103], v10 offset:14336
    v_mfma_f32_16x16x32_bf16 v[52:55], a[92:95], v[104:107], v[52:55]
    buffer_load_dwordx4 v16, s[32:35], s84 offen offset:1024 sc1 lds
    s_waitcnt lgkmcnt(10)
    v_mfma_f32_16x16x32_bf16 v[60:63], a[92:95], v[108:111], v[60:63]
    ds_read_b128 v[104:107], v11 offset:12288
    v_mfma_f32_16x16x32_bf16 v[56:59], a[88:91], v[108:111], v[56:59]
    buffer_load_dwordx4 v12, s[32:35], s84 offen offset:2048 sc1 lds
    s_waitcnt lgkmcnt(10)
    v_mfma_f32_16x16x32_bf16 v[64:67], a[88:91], v[112:115], v[64:67]
    ds_read_b128 v[108:111], v11 offset:14336
    v_mfma_f32_16x16x32_bf16 v[68:71], a[92:95], v[112:115], v[68:71]
    buffer_load_dwordx4 v12, s[32:35], s84 offen offset:3072 sc1 lds
    s_waitcnt lgkmcnt(10)
    v_mfma_f32_16x16x32_bf16 v[76:79], a[92:95], v[116:119], v[76:79]
    ds_read_b128 v[112:115], v8 offset:13312
    v_mfma_f32_16x16x32_bf16 v[72:75], a[88:91], v[116:119], v[72:75]
    s_add_u32 s84, s84, 2048
    s_waitcnt lgkmcnt(10)
    v_mfma_f32_16x16x32_bf16 v[80:83], a[88:91], v[120:123], v[80:83]
    ds_read_b128 v[116:119], v8 offset:15360
    v_mfma_f32_16x16x32_bf16 v[84:87], a[92:95], v[120:123], v[84:87]
    s_waitcnt lgkmcnt(10)
    v_mfma_f32_16x16x32_bf16 v[92:95], a[92:95], v[124:127], v[92:95]
    ds_read_b128 v[120:123], v9 offset:13312
    v_mfma_f32_16x16x32_bf16 v[88:91], a[88:91], v[124:127], v[88:91]
    s_waitcnt lgkmcnt(10)
    v_mfma_f32_16x16x32_bf16 v[32:35], a[96:99], v[128:131], v[32:35]
    ds_read_b128 v[124:127], v9 offset:15360
    v_mfma_f32_16x16x32_bf16 v[36:39], a[100:103], v[128:131], v[36:39]
    s_waitcnt vmcnt(12)
    ds_read_b64_tr_b16 v[192:193], v3 offset:0
    s_waitcnt lgkmcnt(11)
    v_mfma_f32_16x16x32_bf16 v[44:47], a[100:103], v[132:135], v[44:47]
    ds_read_b128 v[128:131], v10 offset:13312
    v_mfma_f32_16x16x32_bf16 v[40:43], a[96:99], v[132:135], v[40:43]
    ds_read_b64_tr_b16 v[194:195], v3 offset:1024
    ds_read_b64_tr_b16 v[196:197], v4 offset:0
    s_waitcnt lgkmcnt(13)
    v_mfma_f32_16x16x32_bf16 v[48:51], a[96:99], v[136:139], v[48:51]
    ds_read_b128 v[132:135], v10 offset:15360
    v_mfma_f32_16x16x32_bf16 v[52:55], a[100:103], v[136:139], v[52:55]
    ds_read_b64_tr_b16 v[198:199], v4 offset:1024
    ds_read_b64_tr_b16 v[200:201], v3 offset:2048
    s_waitcnt lgkmcnt(15)
    v_mfma_f32_16x16x32_bf16 v[60:63], a[100:103], v[140:143], v[60:63]
    ds_read_b128 v[136:139], v11 offset:13312
    v_mfma_f32_16x16x32_bf16 v[56:59], a[96:99], v[140:143], v[56:59]
    ds_read_b64_tr_b16 v[202:203], v3 offset:3072
    ds_read_b64_tr_b16 v[204:205], v4 offset:2048
    s_waitcnt lgkmcnt(15)
    v_mfma_f32_16x16x32_bf16 v[64:67], a[96:99], v[96:99], v[64:67]
    ds_read_b128 v[140:143], v11 offset:15360
    v_mfma_f32_16x16x32_bf16 v[68:71], a[100:103], v[96:99], v[68:71]
    ds_read_b64_tr_b16 v[206:207], v4 offset:3072
    s_add_u32 m0, s98, 8192
    s_barrier
    v_mfma_f32_16x16x32_bf16 v[76:79], a[100:103], v[100:103], v[76:79]
    ds_read_b128 v[96:99], v8 offset:16384
    v_mfma_f32_16x16x32_bf16 v[72:75], a[96:99], v[100:103], v[72:75]
    buffer_load_dwordx4 v28, s[68:71], s72 offen offset:0 lds
    buffer_load_dwordx4 v29, s[68:71], s72 offen offset:1024 lds
    v_mfma_f32_16x16x32_bf16 v[80:83], a[96:99], v[104:107], v[80:83]
    ds_read_b128 v[100:103], v8 offset:18432
    v_mfma_f32_16x16x32_bf16 v[84:87], a[100:103], v[104:107], v[84:87]
    buffer_load_dwordx4 v30, s[68:71], s72 offen offset:2048 lds
    buffer_load_dwordx4 v31, s[68:71], s72 offen offset:3072 lds
    s_waitcnt lgkmcnt(15)
    v_mfma_f32_16x16x32_bf16 v[92:95], a[100:103], v[108:111], v[92:95]
    ds_read_b128 v[104:107], v9 offset:16384
    v_mfma_f32_16x16x32_bf16 v[88:91], a[96:99], v[108:111], v[88:91]
    s_add_u32 s72, s72, 131072
    v_mfma_f32_16x16x32_bf16 v[32:35], a[104:107], v[112:115], v[32:35]
    ds_read_b128 v[108:111], v9 offset:18432
    v_mfma_f32_16x16x32_bf16 v[36:39], a[108:111], v[112:115], v[36:39]
    s_add_u32 m0, s98, 36864
    v_mfma_f32_16x16x32_bf16 v[44:47], a[108:111], v[116:119], v[44:47]
    ds_read_b128 v[112:115], v10 offset:16384
    v_mfma_f32_16x16x32_bf16 v[40:43], a[104:107], v[116:119], v[40:43]
    buffer_load_dwordx4 v16, s[32:35], s84 offen offset:0 sc1 lds
    v_mfma_f32_16x16x32_bf16 v[48:51], a[104:107], v[120:123], v[48:51]
    ds_read_b128 v[116:119], v10 offset:18432
    v_mfma_f32_16x16x32_bf16 v[52:55], a[108:111], v[120:123], v[52:55]
    buffer_load_dwordx4 v16, s[32:35], s84 offen offset:1024 sc1 lds
    s_waitcnt lgkmcnt(15)
    v_mfma_f32_16x16x32_bf16 v[60:63], a[108:111], v[124:127], v[60:63]
    ds_read_b128 v[120:123], v11 offset:16384
    v_mfma_f32_16x16x32_bf16 v[56:59], a[104:107], v[124:127], v[56:59]
    buffer_load_dwordx4 v12, s[32:35], s84 offen offset:2048 sc1 lds
    v_mfma_f32_16x16x32_bf16 v[64:67], a[104:107], v[128:131], v[64:67]
    ds_read_b128 v[124:127], v11 offset:18432
    v_mfma_f32_16x16x32_bf16 v[68:71], a[108:111], v[128:131], v[68:71]
    buffer_load_dwordx4 v12, s[32:35], s84 offen offset:3072 sc1 lds
    s_waitcnt lgkmcnt(15)
    v_mfma_f32_16x16x32_bf16 v[76:79], a[108:111], v[132:135], v[76:79]
    ds_read2st64_b64 v[128:131], v24 offset0:34 offset1:35
    v_mfma_f32_16x16x32_bf16 v[72:75], a[104:107], v[132:135], v[72:75]
    s_add_u32 s84, s84, 2048
    s_waitcnt lgkmcnt(13)
    v_mfma_f32_16x16x32_bf16 v[80:83], a[104:107], v[136:139], v[80:83]
    ds_read2st64_b64 v[132:135], v24 offset0:38 offset1:39
    v_mfma_f32_16x16x32_bf16 v[84:87], a[108:111], v[136:139], v[84:87]
    s_waitcnt lgkmcnt(11)
    v_mfma_f32_16x16x32_bf16 v[92:95], a[108:111], v[140:143], v[92:95]
    ds_read2st64_b64 v[136:139], v25 offset0:34 offset1:35
    v_mfma_f32_16x16x32_bf16 v[88:91], a[104:107], v[140:143], v[88:91]
    s_waitcnt lgkmcnt(10)
    v_mfma_f32_16x16x32_bf16 v[32:35], a[112:115], v[96:99], v[32:35]
    ds_read2st64_b64 v[140:143], v25 offset0:38 offset1:39
    v_mfma_f32_16x16x32_bf16 v[36:39], a[116:119], v[96:99], v[36:39]
    s_waitcnt vmcnt(12)
    ds_read_b64_tr_b16 v[208:209], v3 offset:4096
    s_waitcnt lgkmcnt(11)
    v_mfma_f32_16x16x32_bf16 v[44:47], a[116:119], v[100:103], v[44:47]
    ds_read2st64_b64 v[96:99], v26 offset0:34 offset1:35
    v_mfma_f32_16x16x32_bf16 v[40:43], a[112:115], v[100:103], v[40:43]
    ds_read_b64_tr_b16 v[210:211], v3 offset:5120
    ds_read_b64_tr_b16 v[212:213], v4 offset:4096
    s_waitcnt lgkmcnt(13)
    v_mfma_f32_16x16x32_bf16 v[48:51], a[112:115], v[104:107], v[48:51]
    ds_read2st64_b64 v[100:103], v26 offset0:38 offset1:39
    v_mfma_f32_16x16x32_bf16 v[52:55], a[116:119], v[104:107], v[52:55]
    ds_read_b64_tr_b16 v[214:215], v4 offset:5120
    ds_read_b64_tr_b16 v[216:217], v3 offset:6144
    s_waitcnt lgkmcnt(15)
    v_mfma_f32_16x16x32_bf16 v[60:63], a[116:119], v[108:111], v[60:63]
    ds_read2st64_b64 v[104:107], v27 offset0:34 offset1:35
    v_mfma_f32_16x16x32_bf16 v[56:59], a[112:115], v[108:111], v[56:59]
    ds_read_b64_tr_b16 v[218:219], v3 offset:7168
    ds_read_b64_tr_b16 v[220:221], v4 offset:6144
    s_waitcnt lgkmcnt(15)
    v_mfma_f32_16x16x32_bf16 v[64:67], a[112:115], v[112:115], v[64:67]
    ds_read2st64_b64 v[108:111], v27 offset0:38 offset1:39
    v_mfma_f32_16x16x32_bf16 v[68:71], a[116:119], v[112:115], v[68:71]
    ds_read_b64_tr_b16 v[222:223], v4 offset:7168
    s_barrier
    v_mfma_f32_16x16x32_bf16 v[76:79], a[116:119], v[116:119], v[76:79]
    ds_read_b128 v[112:115], v8 offset:20480
    v_mfma_f32_16x16x32_bf16 v[72:75], a[112:115], v[116:119], v[72:75]
    v_mfma_f32_16x16x32_bf16 v[80:83], a[112:115], v[120:123], v[80:83]
    ds_read_b128 v[116:119], v8 offset:22528
    v_mfma_f32_16x16x32_bf16 v[84:87], a[116:119], v[120:123], v[84:87]
    s_waitcnt lgkmcnt(15)
    v_mfma_f32_16x16x32_bf16 v[92:95], a[116:119], v[124:127], v[92:95]
    ds_read_b128 v[120:123], v9 offset:20480
    v_mfma_f32_16x16x32_bf16 v[88:91], a[112:115], v[124:127], v[88:91]
    v_mfma_f32_16x16x32_bf16 v[32:35], a[120:123], v[128:131], v[32:35]
    ds_read_b128 v[124:127], v9 offset:22528
    v_mfma_f32_16x16x32_bf16 v[36:39], a[124:127], v[128:131], v[36:39]
    s_add_u32 m0, s98, 12288
    v_mfma_f32_16x16x32_bf16 v[44:47], a[124:127], v[132:135], v[44:47]
    ds_read_b128 v[128:131], v10 offset:20480
    v_mfma_f32_16x16x32_bf16 v[40:43], a[120:123], v[132:135], v[40:43]
    buffer_load_dwordx4 v16, s[32:35], s84 offen offset:0 sc1 lds
    v_mfma_f32_16x16x32_bf16 v[48:51], a[120:123], v[136:139], v[48:51]
    ds_read_b128 v[132:135], v10 offset:22528
    v_mfma_f32_16x16x32_bf16 v[52:55], a[124:127], v[136:139], v[52:55]
    buffer_load_dwordx4 v16, s[32:35], s84 offen offset:1024 sc1 lds
    s_waitcnt lgkmcnt(15)
    v_mfma_f32_16x16x32_bf16 v[60:63], a[124:127], v[140:143], v[60:63]
    ds_read_b128 v[136:139], v11 offset:20480
    v_mfma_f32_16x16x32_bf16 v[56:59], a[120:123], v[140:143], v[56:59]
    buffer_load_dwordx4 v12, s[32:35], s84 offen offset:2048 sc1 lds
    v_mfma_f32_16x16x32_bf16 v[64:67], a[120:123], v[96:99], v[64:67]
    ds_read_b128 v[140:143], v11 offset:22528
    v_mfma_f32_16x16x32_bf16 v[68:71], a[124:127], v[96:99], v[68:71]
    buffer_load_dwordx4 v12, s[32:35], s84 offen offset:3072 sc1 lds
    s_waitcnt lgkmcnt(15)
    v_mfma_f32_16x16x32_bf16 v[76:79], a[124:127], v[100:103], v[76:79]
    ds_read_b128 v[96:99], v8 offset:21504
    v_mfma_f32_16x16x32_bf16 v[72:75], a[120:123], v[100:103], v[72:75]
    s_add_u32 s84, s84, 2048
    s_waitcnt lgkmcnt(13)
    v_mfma_f32_16x16x32_bf16 v[80:83], a[120:123], v[104:107], v[80:83]
    ds_read_b128 v[100:103], v8 offset:23552
    v_mfma_f32_16x16x32_bf16 v[84:87], a[124:127], v[104:107], v[84:87]
    s_waitcnt lgkmcnt(11)
    v_mfma_f32_16x16x32_bf16 v[92:95], a[124:127], v[108:111], v[92:95]
    ds_read_b128 v[104:107], v9 offset:21504
    v_mfma_f32_16x16x32_bf16 v[88:91], a[120:123], v[108:111], v[88:91]
    s_waitcnt lgkmcnt(10)
    v_mfma_f32_16x16x32_bf16 v[32:35], v[144:147], v[112:115], v[32:35]
    ds_read_b128 v[108:111], v9 offset:23552
    v_mfma_f32_16x16x32_bf16 v[36:39], v[148:151], v[112:115], v[36:39]
    s_waitcnt vmcnt(8)
    ds_read_b64_tr_b16 v[224:225], v3 offset:8192
    s_waitcnt lgkmcnt(11)
    v_mfma_f32_16x16x32_bf16 v[44:47], v[148:151], v[116:119], v[44:47]
    ds_read_b128 v[112:115], v10 offset:21504
    v_mfma_f32_16x16x32_bf16 v[40:43], v[144:147], v[116:119], v[40:43]
    ds_read_b64_tr_b16 v[226:227], v3 offset:9216
    ds_read_b64_tr_b16 v[228:229], v4 offset:8192
    s_waitcnt lgkmcnt(13)
    v_mfma_f32_16x16x32_bf16 v[48:51], v[144:147], v[120:123], v[48:51]
    ds_read_b128 v[116:119], v10 offset:23552
    v_mfma_f32_16x16x32_bf16 v[52:55], v[148:151], v[120:123], v[52:55]
    ds_read_b64_tr_b16 v[230:231], v4 offset:9216
    ds_read_b64_tr_b16 v[232:233], v3 offset:10240
    s_waitcnt lgkmcnt(15)
    v_mfma_f32_16x16x32_bf16 v[60:63], v[148:151], v[124:127], v[60:63]
    ds_read_b128 v[120:123], v11 offset:21504
    v_mfma_f32_16x16x32_bf16 v[56:59], v[144:147], v[124:127], v[56:59]
    ds_read_b64_tr_b16 v[234:235], v3 offset:11264
    ds_read_b64_tr_b16 v[236:237], v4 offset:10240
    s_waitcnt lgkmcnt(15)
    v_mfma_f32_16x16x32_bf16 v[64:67], v[144:147], v[128:131], v[64:67]
    ds_read_b128 v[124:127], v11 offset:23552
    v_mfma_f32_16x16x32_bf16 v[68:71], v[148:151], v[128:131], v[68:71]
    ds_read_b64_tr_b16 v[238:239], v4 offset:11264
    s_add_u32 m0, s98, 0
    s_barrier
    v_mfma_f32_16x16x32_bf16 v[76:79], v[148:151], v[132:135], v[76:79]
    ds_read_b128 v[128:131], v8 offset:24576
    v_mfma_f32_16x16x32_bf16 v[72:75], v[144:147], v[132:135], v[72:75]
    buffer_load_dwordx4 v28, s[68:71], s72 offen offset:0 lds
    buffer_load_dwordx4 v29, s[68:71], s72 offen offset:1024 lds
    v_mfma_f32_16x16x32_bf16 v[80:83], v[144:147], v[136:139], v[80:83]
    ds_read_b128 v[132:135], v8 offset:26624
    v_mfma_f32_16x16x32_bf16 v[84:87], v[148:151], v[136:139], v[84:87]
    buffer_load_dwordx4 v30, s[68:71], s72 offen offset:2048 lds
    buffer_load_dwordx4 v31, s[68:71], s72 offen offset:3072 lds
    s_waitcnt lgkmcnt(15)
    v_mfma_f32_16x16x32_bf16 v[92:95], v[148:151], v[140:143], v[92:95]
    ds_read_b128 v[136:139], v9 offset:24576
    v_mfma_f32_16x16x32_bf16 v[88:91], v[144:147], v[140:143], v[88:91]
    s_add_u32 s72, s72, 131072
    v_mfma_f32_16x16x32_bf16 v[32:35], v[152:155], v[96:99], v[32:35]
    ds_read_b128 v[140:143], v9 offset:26624
    v_mfma_f32_16x16x32_bf16 v[36:39], v[156:159], v[96:99], v[36:39]
    s_add_u32 m0, s98, 16384
    v_mfma_f32_16x16x32_bf16 v[44:47], v[156:159], v[100:103], v[44:47]
    ds_read_b128 v[96:99], v10 offset:24576
    v_mfma_f32_16x16x32_bf16 v[40:43], v[152:155], v[100:103], v[40:43]
    buffer_load_dwordx4 v16, s[32:35], s84 offen offset:0 sc1 lds
    v_mfma_f32_16x16x32_bf16 v[48:51], v[152:155], v[104:107], v[48:51]
    ds_read_b128 v[100:103], v10 offset:26624
    v_mfma_f32_16x16x32_bf16 v[52:55], v[156:159], v[104:107], v[52:55]
    buffer_load_dwordx4 v16, s[32:35], s84 offen offset:1024 sc1 lds
    s_waitcnt lgkmcnt(15)
    v_mfma_f32_16x16x32_bf16 v[60:63], v[156:159], v[108:111], v[60:63]
    ds_read_b128 v[104:107], v11 offset:24576
    v_mfma_f32_16x16x32_bf16 v[56:59], v[152:155], v[108:111], v[56:59]
    buffer_load_dwordx4 v12, s[32:35], s84 offen offset:2048 sc1 lds
    v_mfma_f32_16x16x32_bf16 v[64:67], v[152:155], v[112:115], v[64:67]
    ds_read_b128 v[108:111], v11 offset:26624
    v_mfma_f32_16x16x32_bf16 v[68:71], v[156:159], v[112:115], v[68:71]
    buffer_load_dwordx4 v12, s[32:35], s84 offen offset:3072 sc1 lds
    s_waitcnt lgkmcnt(15)
    v_mfma_f32_16x16x32_bf16 v[76:79], v[156:159], v[116:119], v[76:79]
    ds_read_b128 v[112:115], v8 offset:25600
    v_mfma_f32_16x16x32_bf16 v[72:75], v[152:155], v[116:119], v[72:75]
    s_add_u32 s84, s84, 2048
    s_waitcnt lgkmcnt(13)
    v_mfma_f32_16x16x32_bf16 v[80:83], v[152:155], v[120:123], v[80:83]
    ds_read_b128 v[116:119], v8 offset:27648
    v_mfma_f32_16x16x32_bf16 v[84:87], v[156:159], v[120:123], v[84:87]
    s_waitcnt lgkmcnt(11)
    v_mfma_f32_16x16x32_bf16 v[92:95], v[156:159], v[124:127], v[92:95]
    ds_read_b128 v[120:123], v9 offset:25600
    v_mfma_f32_16x16x32_bf16 v[88:91], v[152:155], v[124:127], v[88:91]
    s_waitcnt lgkmcnt(10)
    v_mfma_f32_16x16x32_bf16 v[32:35], v[160:163], v[128:131], v[32:35]
    ds_read_b128 v[124:127], v9 offset:27648
    v_mfma_f32_16x16x32_bf16 v[36:39], v[164:167], v[128:131], v[36:39]
    s_add_u32 m0, s98, 4096
    s_waitcnt lgkmcnt(10)
    v_mfma_f32_16x16x32_bf16 v[44:47], v[164:167], v[132:135], v[44:47]
    ds_read_b128 v[128:131], v10 offset:25600
    v_mfma_f32_16x16x32_bf16 v[40:43], v[160:163], v[132:135], v[40:43]
    buffer_load_dwordx4 v28, s[68:71], s72 offen offset:0 lds
    s_waitcnt lgkmcnt(10)
    v_mfma_f32_16x16x32_bf16 v[48:51], v[160:163], v[136:139], v[48:51]
    ds_read_b128 v[132:135], v10 offset:27648
    v_mfma_f32_16x16x32_bf16 v[52:55], v[164:167], v[136:139], v[52:55]
    buffer_load_dwordx4 v29, s[68:71], s72 offen offset:1024 lds
    s_waitcnt lgkmcnt(10)
    v_mfma_f32_16x16x32_bf16 v[60:63], v[164:167], v[140:143], v[60:63]
    ds_read_b128 v[136:139], v11 offset:25600
    v_mfma_f32_16x16x32_bf16 v[56:59], v[160:163], v[140:143], v[56:59]
    buffer_load_dwordx4 v30, s[68:71], s72 offen offset:2048 lds
    s_waitcnt lgkmcnt(10)
    v_mfma_f32_16x16x32_bf16 v[64:67], v[160:163], v[96:99], v[64:67]
    ds_read_b128 v[140:143], v11 offset:27648
    v_mfma_f32_16x16x32_bf16 v[68:71], v[164:167], v[96:99], v[68:71]
    buffer_load_dwordx4 v31, s[68:71], s72 offen offset:3072 lds
    s_barrier
    s_waitcnt lgkmcnt(10)
    v_mfma_f32_16x16x32_bf16 v[76:79], v[164:167], v[100:103], v[76:79]
    ds_read_b128 v[96:99], v8 offset:28672
    v_mfma_f32_16x16x32_bf16 v[72:75], v[160:163], v[100:103], v[72:75]
    s_add_u32 s72, s72, 131072
    s_waitcnt lgkmcnt(10)
    v_mfma_f32_16x16x32_bf16 v[80:83], v[160:163], v[104:107], v[80:83]
    ds_read_b128 v[100:103], v8 offset:30720
    v_mfma_f32_16x16x32_bf16 v[84:87], v[164:167], v[104:107], v[84:87]
    s_waitcnt lgkmcnt(10)
    v_mfma_f32_16x16x32_bf16 v[92:95], v[164:167], v[108:111], v[92:95]
    ds_read_b128 v[104:107], v9 offset:28672
    v_mfma_f32_16x16x32_bf16 v[88:91], v[160:163], v[108:111], v[88:91]
    s_waitcnt lgkmcnt(10)
    v_mfma_f32_16x16x32_bf16 v[32:35], v[168:171], v[112:115], v[32:35]
    ds_read_b128 v[108:111], v9 offset:30720
    v_mfma_f32_16x16x32_bf16 v[36:39], v[172:175], v[112:115], v[36:39]
    s_add_u32 m0, s98, 20480
    s_waitcnt lgkmcnt(10)
    v_mfma_f32_16x16x32_bf16 v[44:47], v[172:175], v[116:119], v[44:47]
    ds_read_b128 v[112:115], v10 offset:28672
    v_mfma_f32_16x16x32_bf16 v[40:43], v[168:171], v[116:119], v[40:43]
    buffer_load_dwordx4 v16, s[32:35], s84 offen offset:0 sc1 lds
    s_waitcnt lgkmcnt(10)
    v_mfma_f32_16x16x32_bf16 v[48:51], v[168:171], v[120:123], v[48:51]
    ds_read_b128 v[116:119], v10 offset:30720
    v_mfma_f32_16x16x32_bf16 v[52:55], v[172:175], v[120:123], v[52:55]
    buffer_load_dwordx4 v16, s[32:35], s84 offen offset:1024 sc1 lds
    s_waitcnt lgkmcnt(10)
    v_mfma_f32_16x16x32_bf16 v[60:63], v[172:175], v[124:127], v[60:63]
    ds_read_b128 v[120:123], v11 offset:28672
    v_mfma_f32_16x16x32_bf16 v[56:59], v[168:171], v[124:127], v[56:59]
    buffer_load_dwordx4 v12, s[32:35], s84 offen offset:2048 sc1 lds
    s_waitcnt lgkmcnt(10)
    v_mfma_f32_16x16x32_bf16 v[64:67], v[168:171], v[128:131], v[64:67]
    ds_read_b128 v[124:127], v11 offset:30720
    v_mfma_f32_16x16x32_bf16 v[68:71], v[172:175], v[128:131], v[68:71]
    buffer_load_dwordx4 v12, s[32:35], s84 offen offset:3072 sc1 lds
    s_waitcnt lgkmcnt(10)
    v_mfma_f32_16x16x32_bf16 v[76:79], v[172:175], v[132:135], v[76:79]
    ds_read_b128 v[128:131], v8 offset:29696
    v_mfma_f32_16x16x32_bf16 v[72:75], v[168:171], v[132:135], v[72:75]
    s_add_u32 s84, s84, 2048
    s_waitcnt lgkmcnt(10)
    v_mfma_f32_16x16x32_bf16 v[80:83], v[168:171], v[136:139], v[80:83]
    ds_read_b128 v[132:135], v8 offset:31744
    v_mfma_f32_16x16x32_bf16 v[84:87], v[172:175], v[136:139], v[84:87]
    s_waitcnt lgkmcnt(10)
    v_mfma_f32_16x16x32_bf16 v[92:95], v[172:175], v[140:143], v[92:95]
    ds_read_b128 v[136:139], v9 offset:29696
    v_mfma_f32_16x16x32_bf16 v[88:91], v[168:171], v[140:143], v[88:91]
    s_waitcnt lgkmcnt(10)
    v_mfma_f32_16x16x32_bf16 v[32:35], v[176:179], v[96:99], v[32:35]
    ds_read_b128 v[140:143], v9 offset:31744
    v_mfma_f32_16x16x32_bf16 v[36:39], v[180:183], v[96:99], v[36:39]
    s_waitcnt vmcnt(12)
    ds_read_b64_tr_b16 v[240:241], v3 offset:0
    s_waitcnt lgkmcnt(11)
    v_mfma_f32_16x16x32_bf16 v[44:47], v[180:183], v[100:103], v[44:47]
    ds_read_b128 v[96:99], v10 offset:29696
    v_mfma_f32_16x16x32_bf16 v[40:43], v[176:179], v[100:103], v[40:43]
    ds_read_b64_tr_b16 v[242:243], v3 offset:1024
    ds_read_b64_tr_b16 v[244:245], v4 offset:0
    s_waitcnt lgkmcnt(13)
    v_mfma_f32_16x16x32_bf16 v[48:51], v[176:179], v[104:107], v[48:51]
    ds_read_b128 v[100:103], v10 offset:31744
    v_mfma_f32_16x16x32_bf16 v[52:55], v[180:183], v[104:107], v[52:55]
    ds_read_b64_tr_b16 v[246:247], v4 offset:1024
    ds_read_b64_tr_b16 v[248:249], v3 offset:2048
    s_waitcnt lgkmcnt(15)
    v_mfma_f32_16x16x32_bf16 v[60:63], v[180:183], v[108:111], v[60:63]
    ds_read_b128 v[104:107], v11 offset:29696
    v_mfma_f32_16x16x32_bf16 v[56:59], v[176:179], v[108:111], v[56:59]
    ds_read_b64_tr_b16 v[250:251], v3 offset:3072
    ds_read_b64_tr_b16 v[252:253], v4 offset:2048
    s_waitcnt lgkmcnt(15)
    v_mfma_f32_16x16x32_bf16 v[64:67], v[176:179], v[112:115], v[64:67]
    ds_read_b128 v[108:111], v11 offset:31744
    v_mfma_f32_16x16x32_bf16 v[68:71], v[180:183], v[112:115], v[68:71]
    ds_read_b64_tr_b16 v[254:255], v4 offset:3072
    s_add_u32 m0, s98, 8192
    s_barrier
    v_mfma_f32_16x16x32_bf16 v[76:79], v[180:183], v[116:119], v[76:79]
    ds_read2st64_b64 v[112:115], v24 offset0:64 offset1:65
    v_mfma_f32_16x16x32_bf16 v[72:75], v[176:179], v[116:119], v[72:75]
    buffer_load_dwordx4 v28, s[68:71], s72 offen offset:0 lds
    buffer_load_dwordx4 v29, s[68:71], s72 offen offset:1024 lds
    v_mfma_f32_16x16x32_bf16 v[80:83], v[176:179], v[120:123], v[80:83]
    ds_read2st64_b64 v[116:119], v24 offset0:68 offset1:69
    v_mfma_f32_16x16x32_bf16 v[84:87], v[180:183], v[120:123], v[84:87]
    buffer_load_dwordx4 v30, s[68:71], s72 offen offset:2048 lds
    buffer_load_dwordx4 v31, s[68:71], s72 offen offset:3072 lds
    s_waitcnt lgkmcnt(15)
    v_mfma_f32_16x16x32_bf16 v[92:95], v[180:183], v[124:127], v[92:95]
    ds_read2st64_b64 v[120:123], v25 offset0:64 offset1:65
    v_mfma_f32_16x16x32_bf16 v[88:91], v[176:179], v[124:127], v[88:91]
    s_add_u32 s72, s72, 131072
    v_mfma_f32_16x16x32_bf16 v[32:35], v[184:187], v[128:131], v[32:35]
    ds_read2st64_b64 v[124:127], v25 offset0:68 offset1:69
    v_mfma_f32_16x16x32_bf16 v[36:39], v[188:191], v[128:131], v[36:39]
    s_add_u32 m0, s98, 24576
    v_mfma_f32_16x16x32_bf16 v[44:47], v[188:191], v[132:135], v[44:47]
    ds_read2st64_b64 v[128:131], v26 offset0:64 offset1:65
    v_mfma_f32_16x16x32_bf16 v[40:43], v[184:187], v[132:135], v[40:43]
    buffer_load_dwordx4 v16, s[32:35], s84 offen offset:0 sc1 lds
    v_mfma_f32_16x16x32_bf16 v[48:51], v[184:187], v[136:139], v[48:51]
    ds_read2st64_b64 v[132:135], v26 offset0:68 offset1:69
    v_mfma_f32_16x16x32_bf16 v[52:55], v[188:191], v[136:139], v[52:55]
    buffer_load_dwordx4 v16, s[32:35], s84 offen offset:1024 sc1 lds
    s_waitcnt lgkmcnt(15)
    v_mfma_f32_16x16x32_bf16 v[60:63], v[188:191], v[140:143], v[60:63]
    ds_read2st64_b64 v[136:139], v27 offset0:64 offset1:65
    v_mfma_f32_16x16x32_bf16 v[56:59], v[184:187], v[140:143], v[56:59]
    buffer_load_dwordx4 v12, s[32:35], s84 offen offset:2048 sc1 lds
    v_mfma_f32_16x16x32_bf16 v[64:67], v[184:187], v[96:99], v[64:67]
    ds_read2st64_b64 v[140:143], v27 offset0:68 offset1:69
    v_mfma_f32_16x16x32_bf16 v[68:71], v[188:191], v[96:99], v[68:71]
    buffer_load_dwordx4 v12, s[32:35], s84 offen offset:3072 sc1 lds
    s_waitcnt lgkmcnt(15)
    v_mfma_f32_16x16x32_bf16 v[76:79], v[188:191], v[100:103], v[76:79]
    ds_read_b128 v[96:99], v8 offset:33792
    v_mfma_f32_16x16x32_bf16 v[72:75], v[184:187], v[100:103], v[72:75]
    s_add_u32 s84, s84, 2048
    s_waitcnt lgkmcnt(13)
    v_mfma_f32_16x16x32_bf16 v[80:83], v[184:187], v[104:107], v[80:83]
    ds_read_b128 v[100:103], v8 offset:35840
    v_mfma_f32_16x16x32_bf16 v[84:87], v[188:191], v[104:107], v[84:87]
    s_waitcnt lgkmcnt(11)
    v_mfma_f32_16x16x32_bf16 v[92:95], v[188:191], v[108:111], v[92:95]
    ds_read_b128 v[104:107], v9 offset:33792
    v_mfma_f32_16x16x32_bf16 v[88:91], v[184:187], v[108:111], v[88:91]
    s_waitcnt lgkmcnt(10)
    v_mfma_f32_16x16x32_bf16 v[32:35], v[192:195], v[112:115], v[32:35]
    ds_read_b128 v[108:111], v9 offset:35840
    v_mfma_f32_16x16x32_bf16 v[36:39], v[196:199], v[112:115], v[36:39]
    s_waitcnt vmcnt(12)
    ds_read_b64_tr_b16 a[128:129], v3 offset:4096
    s_waitcnt lgkmcnt(11)
    v_mfma_f32_16x16x32_bf16 v[44:47], v[196:199], v[116:119], v[44:47]
    ds_read_b128 v[112:115], v10 offset:33792
    v_mfma_f32_16x16x32_bf16 v[40:43], v[192:195], v[116:119], v[40:43]
    ds_read_b64_tr_b16 a[130:131], v3 offset:5120
    ds_read_b64_tr_b16 a[132:133], v4 offset:4096
    s_waitcnt lgkmcnt(13)
    v_mfma_f32_16x16x32_bf16 v[48:51], v[192:195], v[120:123], v[48:51]
    ds_read_b128 v[116:119], v10 offset:35840
    v_mfma_f32_16x16x32_bf16 v[52:55], v[196:199], v[120:123], v[52:55]
    ds_read_b64_tr_b16 a[134:135], v4 offset:5120
    ds_read_b64_tr_b16 a[136:137], v3 offset:6144
    s_waitcnt lgkmcnt(15)
    v_mfma_f32_16x16x32_bf16 v[60:63], v[196:199], v[124:127], v[60:63]
    ds_read_b128 v[120:123], v11 offset:33792
    v_mfma_f32_16x16x32_bf16 v[56:59], v[192:195], v[124:127], v[56:59]
    ds_read_b64_tr_b16 a[138:139], v3 offset:7168
    ds_read_b64_tr_b16 a[140:141], v4 offset:6144
    s_waitcnt lgkmcnt(15)
    v_mfma_f32_16x16x32_bf16 v[64:67], v[192:195], v[128:131], v[64:67]
    ds_read_b128 v[124:127], v11 offset:35840
    v_mfma_f32_16x16x32_bf16 v[68:71], v[196:199], v[128:131], v[68:71]
    ds_read_b64_tr_b16 a[142:143], v4 offset:7168
    s_barrier
    v_mfma_f32_16x16x32_bf16 v[76:79], v[196:199], v[132:135], v[76:79]
    ds_read_b128 v[128:131], v8 offset:36864
    v_mfma_f32_16x16x32_bf16 v[72:75], v[192:195], v[132:135], v[72:75]
    v_mfma_f32_16x16x32_bf16 v[80:83], v[192:195], v[136:139], v[80:83]
    ds_read_b128 v[132:135], v8 offset:38912
    v_mfma_f32_16x16x32_bf16 v[84:87], v[196:199], v[136:139], v[84:87]
    s_waitcnt lgkmcnt(15)
    v_mfma_f32_16x16x32_bf16 v[92:95], v[196:199], v[140:143], v[92:95]
    ds_read_b128 v[136:139], v9 offset:36864
    v_mfma_f32_16x16x32_bf16 v[88:91], v[192:195], v[140:143], v[88:91]
    v_mfma_f32_16x16x32_bf16 v[32:35], v[200:203], v[96:99], v[32:35]
    ds_read_b128 v[140:143], v9 offset:38912
    v_mfma_f32_16x16x32_bf16 v[36:39], v[204:207], v[96:99], v[36:39]
    s_add_u32 m0, s98, 28672
    v_mfma_f32_16x16x32_bf16 v[44:47], v[204:207], v[100:103], v[44:47]
    ds_read_b128 v[96:99], v10 offset:36864
    v_mfma_f32_16x16x32_bf16 v[40:43], v[200:203], v[100:103], v[40:43]
    buffer_load_dwordx4 v16, s[32:35], s84 offen offset:0 sc1 lds
    v_mfma_f32_16x16x32_bf16 v[48:51], v[200:203], v[104:107], v[48:51]
    ds_read_b128 v[100:103], v10 offset:38912
    v_mfma_f32_16x16x32_bf16 v[52:55], v[204:207], v[104:107], v[52:55]
    buffer_load_dwordx4 v16, s[32:35], s84 offen offset:1024 sc1 lds
    s_waitcnt lgkmcnt(15)
    v_mfma_f32_16x16x32_bf16 v[60:63], v[204:207], v[108:111], v[60:63]
    ds_read_b128 v[104:107], v11 offset:36864
    v_mfma_f32_16x16x32_bf16 v[56:59], v[200:203], v[108:111], v[56:59]
    buffer_load_dwordx4 v12, s[32:35], s84 offen offset:2048 sc1 lds
    v_mfma_f32_16x16x32_bf16 v[64:67], v[200:203], v[112:115], v[64:67]
    ds_read_b128 v[108:111], v11 offset:38912
    v_mfma_f32_16x16x32_bf16 v[68:71], v[204:207], v[112:115], v[68:71]
    buffer_load_dwordx4 v12, s[32:35], s84 offen offset:3072 sc1 lds
    s_waitcnt lgkmcnt(15)
    v_mfma_f32_16x16x32_bf16 v[76:79], v[204:207], v[116:119], v[76:79]
    ds_read_b128 v[112:115], v8 offset:37888
    v_mfma_f32_16x16x32_bf16 v[72:75], v[200:203], v[116:119], v[72:75]
    s_add_u32 s84, s84, 2048
    s_waitcnt lgkmcnt(13)
    v_mfma_f32_16x16x32_bf16 v[80:83], v[200:203], v[120:123], v[80:83]
    ds_read_b128 v[116:119], v8 offset:39936
    v_mfma_f32_16x16x32_bf16 v[84:87], v[204:207], v[120:123], v[84:87]
    s_waitcnt lgkmcnt(11)
    v_mfma_f32_16x16x32_bf16 v[92:95], v[204:207], v[124:127], v[92:95]
    ds_read_b128 v[120:123], v9 offset:37888
    v_mfma_f32_16x16x32_bf16 v[88:91], v[200:203], v[124:127], v[88:91]
    s_waitcnt lgkmcnt(10)
    v_mfma_f32_16x16x32_bf16 v[32:35], v[208:211], v[128:131], v[32:35]
    ds_read_b128 v[124:127], v9 offset:39936
    v_mfma_f32_16x16x32_bf16 v[36:39], v[212:215], v[128:131], v[36:39]
    s_waitcnt vmcnt(8)
    ds_read_b64_tr_b16 a[144:145], v3 offset:8192
    s_waitcnt lgkmcnt(11)
    v_mfma_f32_16x16x32_bf16 v[44:47], v[212:215], v[132:135], v[44:47]
    ds_read_b128 v[128:131], v10 offset:37888
    v_mfma_f32_16x16x32_bf16 v[40:43], v[208:211], v[132:135], v[40:43]
    ds_read_b64_tr_b16 a[146:147], v3 offset:9216
    ds_read_b64_tr_b16 a[148:149], v4 offset:8192
    s_waitcnt lgkmcnt(13)
    v_mfma_f32_16x16x32_bf16 v[48:51], v[208:211], v[136:139], v[48:51]
    ds_read_b128 v[132:135], v10 offset:39936
    v_mfma_f32_16x16x32_bf16 v[52:55], v[212:215], v[136:139], v[52:55]
    ds_read_b64_tr_b16 a[150:151], v4 offset:9216
    ds_read_b64_tr_b16 a[152:153], v3 offset:10240
    s_waitcnt lgkmcnt(15)
    v_mfma_f32_16x16x32_bf16 v[60:63], v[212:215], v[140:143], v[60:63]
    ds_read_b128 v[136:139], v11 offset:37888
    v_mfma_f32_16x16x32_bf16 v[56:59], v[208:211], v[140:143], v[56:59]
    ds_read_b64_tr_b16 a[154:155], v3 offset:11264
    ds_read_b64_tr_b16 a[156:157], v4 offset:10240
    s_waitcnt lgkmcnt(15)
    v_mfma_f32_16x16x32_bf16 v[64:67], v[208:211], v[96:99], v[64:67]
    ds_read_b128 v[140:143], v11 offset:39936
    v_mfma_f32_16x16x32_bf16 v[68:71], v[212:215], v[96:99], v[68:71]
    ds_read_b64_tr_b16 a[158:159], v4 offset:11264
    s_add_u32 m0, s98, 0
    s_barrier
    v_mfma_f32_16x16x32_bf16 v[76:79], v[212:215], v[100:103], v[76:79]
    ds_read_b128 v[96:99], v8 offset:12288
    v_mfma_f32_16x16x32_bf16 v[72:75], v[208:211], v[100:103], v[72:75]
    buffer_load_dwordx4 v28, s[68:71], s72 offen offset:0 lds
    buffer_load_dwordx4 v29, s[68:71], s72 offen offset:1024 lds
    v_mfma_f32_16x16x32_bf16 v[80:83], v[208:211], v[104:107], v[80:83]
    ds_read_b128 v[100:103], v8 offset:14336
    v_mfma_f32_16x16x32_bf16 v[84:87], v[212:215], v[104:107], v[84:87]
    buffer_load_dwordx4 v30, s[68:71], s72 offen offset:2048 lds
    buffer_load_dwordx4 v31, s[68:71], s72 offen offset:3072 lds
    s_waitcnt lgkmcnt(15)
    v_mfma_f32_16x16x32_bf16 v[92:95], v[212:215], v[108:111], v[92:95]
    ds_read_b128 v[104:107], v9 offset:12288
    v_mfma_f32_16x16x32_bf16 v[88:91], v[208:211], v[108:111], v[88:91]
    s_add_u32 s72, s72, 131072
    v_mfma_f32_16x16x32_bf16 v[32:35], v[216:219], v[112:115], v[32:35]
    ds_read_b128 v[108:111], v9 offset:14336
    v_mfma_f32_16x16x32_bf16 v[36:39], v[220:223], v[112:115], v[36:39]
    s_add_u32 m0, s98, 32768
    v_mfma_f32_16x16x32_bf16 v[44:47], v[220:223], v[116:119], v[44:47]
    ds_read_b128 v[112:115], v10 offset:12288
    v_mfma_f32_16x16x32_bf16 v[40:43], v[216:219], v[116:119], v[40:43]
    buffer_load_dwordx4 v16, s[32:35], s84 offen offset:0 sc1 lds
    v_mfma_f32_16x16x32_bf16 v[48:51], v[216:219], v[120:123], v[48:51]
    ds_read_b128 v[116:119], v10 offset:14336
    v_mfma_f32_16x16x32_bf16 v[52:55], v[220:223], v[120:123], v[52:55]
    buffer_load_dwordx4 v16, s[32:35], s84 offen offset:1024 sc1 lds
    s_waitcnt lgkmcnt(15)
    v_mfma_f32_16x16x32_bf16 v[60:63], v[220:223], v[124:127], v[60:63]
    ds_read_b128 v[120:123], v11 offset:12288
    v_mfma_f32_16x16x32_bf16 v[56:59], v[216:219], v[124:127], v[56:59]
    buffer_load_dwordx4 v12, s[32:35], s84 offen offset:2048 sc1 lds
    v_mfma_f32_16x16x32_bf16 v[64:67], v[216:219], v[128:131], v[64:67]
    ds_read_b128 v[124:127], v11 offset:14336
    v_mfma_f32_16x16x32_bf16 v[68:71], v[220:223], v[128:131], v[68:71]
    buffer_load_dwordx4 v12, s[32:35], s84 offen offset:3072 sc1 lds
    s_waitcnt lgkmcnt(15)
    v_mfma_f32_16x16x32_bf16 v[76:79], v[220:223], v[132:135], v[76:79]
    ds_read_b128 v[128:131], v8 offset:13312
    v_mfma_f32_16x16x32_bf16 v[72:75], v[216:219], v[132:135], v[72:75]
    s_add_u32 s84, s84, 2048
    s_waitcnt lgkmcnt(13)
    v_mfma_f32_16x16x32_bf16 v[80:83], v[216:219], v[136:139], v[80:83]
    ds_read_b128 v[132:135], v8 offset:15360
    v_mfma_f32_16x16x32_bf16 v[84:87], v[220:223], v[136:139], v[84:87]
    s_waitcnt lgkmcnt(11)
    v_mfma_f32_16x16x32_bf16 v[92:95], v[220:223], v[140:143], v[92:95]
    ds_read_b128 v[136:139], v9 offset:13312
    v_mfma_f32_16x16x32_bf16 v[88:91], v[216:219], v[140:143], v[88:91]
    s_waitcnt lgkmcnt(10)
    v_mfma_f32_16x16x32_bf16 v[32:35], v[224:227], v[96:99], v[32:35]
    ds_read_b128 v[140:143], v9 offset:15360
    v_mfma_f32_16x16x32_bf16 v[36:39], v[228:231], v[96:99], v[36:39]
    s_add_u32 m0, s98, 4096
    s_waitcnt lgkmcnt(10)
    v_mfma_f32_16x16x32_bf16 v[44:47], v[228:231], v[100:103], v[44:47]
    ds_read_b128 v[96:99], v10 offset:13312
    v_mfma_f32_16x16x32_bf16 v[40:43], v[224:227], v[100:103], v[40:43]
    buffer_load_dwordx4 v28, s[68:71], s72 offen offset:0 lds
    s_waitcnt lgkmcnt(10)
    v_mfma_f32_16x16x32_bf16 v[48:51], v[224:227], v[104:107], v[48:51]
    ds_read_b128 v[100:103], v10 offset:15360
    v_mfma_f32_16x16x32_bf16 v[52:55], v[228:231], v[104:107], v[52:55]
    buffer_load_dwordx4 v29, s[68:71], s72 offen offset:1024 lds
    s_waitcnt lgkmcnt(10)
    v_mfma_f32_16x16x32_bf16 v[60:63], v[228:231], v[108:111], v[60:63]
    ds_read_b128 v[104:107], v11 offset:13312
    v_mfma_f32_16x16x32_bf16 v[56:59], v[224:227], v[108:111], v[56:59]
    buffer_load_dwordx4 v30, s[68:71], s72 offen offset:2048 lds
    s_waitcnt lgkmcnt(10)
    v_mfma_f32_16x16x32_bf16 v[64:67], v[224:227], v[112:115], v[64:67]
    ds_read_b128 v[108:111], v11 offset:15360
    v_mfma_f32_16x16x32_bf16 v[68:71], v[228:231], v[112:115], v[68:71]
    buffer_load_dwordx4 v31, s[68:71], s72 offen offset:3072 lds
    s_barrier
    s_waitcnt lgkmcnt(10)
    v_mfma_f32_16x16x32_bf16 v[76:79], v[228:231], v[116:119], v[76:79]
    ds_read_b128 v[112:115], v10 offset:16384
    v_mfma_f32_16x16x32_bf16 v[72:75], v[224:227], v[116:119], v[72:75]
    s_add_u32 s72, s72, 131072
    s_waitcnt lgkmcnt(10)
    v_mfma_f32_16x16x32_bf16 v[80:83], v[224:227], v[120:123], v[80:83]
    ds_read_b128 v[116:119], v10 offset:18432
    v_mfma_f32_16x16x32_bf16 v[84:87], v[228:231], v[120:123], v[84:87]
    s_waitcnt lgkmcnt(10)
    v_mfma_f32_16x16x32_bf16 v[92:95], v[228:231], v[124:127], v[92:95]
    ds_read_b128 v[120:123], v11 offset:16384
    v_mfma_f32_16x16x32_bf16 v[88:91], v[224:227], v[124:127], v[88:91]
    s_waitcnt lgkmcnt(10)
    v_mfma_f32_16x16x32_bf16 v[32:35], v[232:235], v[128:131], v[32:35]
    ds_read_b128 v[124:127], v11 offset:18432
    v_mfma_f32_16x16x32_bf16 v[36:39], v[236:239], v[128:131], v[36:39]
    s_add_u32 m0, s98, 36864
    s_waitcnt lgkmcnt(10)
    v_mfma_f32_16x16x32_bf16 v[44:47], v[236:239], v[132:135], v[44:47]
    ds_read2st64_b64 v[128:131], v26 offset0:34 offset1:35
    v_mfma_f32_16x16x32_bf16 v[40:43], v[232:235], v[132:135], v[40:43]
    buffer_load_dwordx4 v16, s[32:35], s84 offen offset:0 sc1 lds
    s_waitcnt lgkmcnt(10)
    v_mfma_f32_16x16x32_bf16 v[48:51], v[232:235], v[136:139], v[48:51]
    ds_read2st64_b64 v[132:135], v26 offset0:38 offset1:39
    v_mfma_f32_16x16x32_bf16 v[52:55], v[236:239], v[136:139], v[52:55]
    buffer_load_dwordx4 v16, s[32:35], s84 offen offset:1024 sc1 lds
    s_waitcnt lgkmcnt(10)
    v_mfma_f32_16x16x32_bf16 v[60:63], v[236:239], v[140:143], v[60:63]
    ds_read2st64_b64 v[136:139], v27 offset0:34 offset1:35
    v_mfma_f32_16x16x32_bf16 v[56:59], v[232:235], v[140:143], v[56:59]
    buffer_load_dwordx4 v12, s[32:35], s84 offen offset:2048 sc1 lds
    s_waitcnt lgkmcnt(10)
    v_mfma_f32_16x16x32_bf16 v[64:67], v[232:235], v[96:99], v[64:67]
    ds_read2st64_b64 v[140:143], v27 offset0:38 offset1:39
    v_mfma_f32_16x16x32_bf16 v[68:71], v[236:239], v[96:99], v[68:71]
    buffer_load_dwordx4 v12, s[32:35], s84 offen offset:3072 sc1 lds
    s_barrier
    s_waitcnt lgkmcnt(10)
    v_mfma_f32_16x16x32_bf16 v[76:79], v[236:239], v[100:103], v[76:79]
    ds_read_b128 v[96:99], v10 offset:20480
    v_mfma_f32_16x16x32_bf16 v[72:75], v[232:235], v[100:103], v[72:75]
    s_add_u32 s84, s84, 2048
    s_waitcnt lgkmcnt(10)
    v_mfma_f32_16x16x32_bf16 v[80:83], v[232:235], v[104:107], v[80:83]
    ds_read_b128 v[100:103], v10 offset:22528
    v_mfma_f32_16x16x32_bf16 v[84:87], v[236:239], v[104:107], v[84:87]
    s_waitcnt lgkmcnt(10)
    v_mfma_f32_16x16x32_bf16 v[92:95], v[236:239], v[108:111], v[92:95]
    ds_read_b128 v[104:107], v11 offset:20480
    v_mfma_f32_16x16x32_bf16 v[88:91], v[232:235], v[108:111], v[88:91]
    s_waitcnt lgkmcnt(10)
    v_mfma_f32_16x16x32_bf16 v[64:67], v[240:243], v[112:115], v[64:67]
    ds_read_b128 v[108:111], v11 offset:22528
    v_mfma_f32_16x16x32_bf16 v[68:71], v[244:247], v[112:115], v[68:71]
    s_waitcnt vmcnt(12)
    ds_read_b64_tr_b16 a[160:161], v3 offset:0
    s_waitcnt lgkmcnt(11)
    v_mfma_f32_16x16x32_bf16 v[76:79], v[244:247], v[116:119], v[76:79]
    ds_read_b128 v[112:115], v10 offset:21504
    v_mfma_f32_16x16x32_bf16 v[72:75], v[240:243], v[116:119], v[72:75]
    ds_read_b64_tr_b16 a[162:163], v3 offset:1024
    ds_read_b64_tr_b16 a[164:165], v4 offset:0
    s_waitcnt lgkmcnt(13)
    v_mfma_f32_16x16x32_bf16 v[80:83], v[240:243], v[120:123], v[80:83]
    ds_read_b128 v[116:119], v10 offset:23552
    v_mfma_f32_16x16x32_bf16 v[84:87], v[244:247], v[120:123], v[84:87]
    ds_read_b64_tr_b16 a[166:167], v4 offset:1024
    ds_read_b64_tr_b16 a[168:169], v3 offset:2048
    s_waitcnt lgkmcnt(15)
    v_mfma_f32_16x16x32_bf16 v[92:95], v[244:247], v[124:127], v[92:95]
    ds_read_b128 v[120:123], v11 offset:21504
    v_mfma_f32_16x16x32_bf16 v[88:91], v[240:243], v[124:127], v[88:91]
    ds_read_b64_tr_b16 a[170:171], v3 offset:3072
    ds_read_b64_tr_b16 a[172:173], v4 offset:2048
    s_waitcnt lgkmcnt(15)
    v_mfma_f32_16x16x32_bf16 v[64:67], v[248:251], v[128:131], v[64:67]
    ds_read_b128 v[124:127], v11 offset:23552
    v_mfma_f32_16x16x32_bf16 v[68:71], v[252:255], v[128:131], v[68:71]
    ds_read_b64_tr_b16 a[174:175], v4 offset:3072
    s_add_u32 m0, s98, 8192
    s_barrier
    v_mfma_f32_16x16x32_bf16 v[76:79], v[252:255], v[132:135], v[76:79]
    ds_read_b128 v[128:131], v10 offset:24576
    v_mfma_f32_16x16x32_bf16 v[72:75], v[248:251], v[132:135], v[72:75]
    buffer_load_dwordx4 v28, s[68:71], s72 offen offset:0 lds
    buffer_load_dwordx4 v29, s[68:71], s72 offen offset:1024 lds
    v_mfma_f32_16x16x32_bf16 v[80:83], v[248:251], v[136:139], v[80:83]
    ds_read_b128 v[132:135], v10 offset:26624
    v_mfma_f32_16x16x32_bf16 v[84:87], v[252:255], v[136:139], v[84:87]
    buffer_load_dwordx4 v30, s[68:71], s72 offen offset:2048 lds
    buffer_load_dwordx4 v31, s[68:71], s72 offen offset:3072 lds
    s_waitcnt lgkmcnt(15)
    v_mfma_f32_16x16x32_bf16 v[92:95], v[252:255], v[140:143], v[92:95]
    ds_read_b128 v[136:139], v11 offset:24576
    v_mfma_f32_16x16x32_bf16 v[88:91], v[248:251], v[140:143], v[88:91]
    s_add_u32 s72, s72, 131072
    v_mfma_f32_16x16x32_bf16 v[64:67], a[128:131], v[96:99], v[64:67]
    ds_read_b128 v[140:143], v11 offset:26624
    v_mfma_f32_16x16x32_bf16 v[68:71], a[132:135], v[96:99], v[68:71]
    v_mfma_f32_16x16x32_bf16 v[76:79], a[132:135], v[100:103], v[76:79]
    ds_read_b128 v[96:99], v10 offset:25600
    v_mfma_f32_16x16x32_bf16 v[72:75], a[128:131], v[100:103], v[72:75]
    v_mfma_f32_16x16x32_bf16 v[80:83], a[128:131], v[104:107], v[80:83]
    ds_read_b128 v[100:103], v10 offset:27648
    v_mfma_f32_16x16x32_bf16 v[84:87], a[132:135], v[104:107], v[84:87]
    s_waitcnt lgkmcnt(15)
    v_mfma_f32_16x16x32_bf16 v[92:95], a[132:135], v[108:111], v[92:95]
    ds_read_b128 v[104:107], v11 offset:25600
    v_mfma_f32_16x16x32_bf16 v[88:91], a[128:131], v[108:111], v[88:91]
    v_mfma_f32_16x16x32_bf16 v[64:67], a[136:139], v[112:115], v[64:67]
    ds_read_b128 v[108:111], v11 offset:27648
    v_mfma_f32_16x16x32_bf16 v[68:71], a[140:143], v[112:115], v[68:71]
    s_barrier
    s_waitcnt lgkmcnt(15)
    v_mfma_f32_16x16x32_bf16 v[76:79], a[140:143], v[116:119], v[76:79]
    ds_read_b128 v[112:115], v10 offset:28672
    v_mfma_f32_16x16x32_bf16 v[72:75], a[136:139], v[116:119], v[72:75]
    s_waitcnt lgkmcnt(13)
    v_mfma_f32_16x16x32_bf16 v[80:83], a[136:139], v[120:123], v[80:83]
    ds_read_b128 v[116:119], v10 offset:30720
    v_mfma_f32_16x16x32_bf16 v[84:87], a[140:143], v[120:123], v[84:87]
    s_waitcnt lgkmcnt(11)
    v_mfma_f32_16x16x32_bf16 v[92:95], a[140:143], v[124:127], v[92:95]
    ds_read_b128 v[120:123], v11 offset:28672
    v_mfma_f32_16x16x32_bf16 v[88:91], a[136:139], v[124:127], v[88:91]
    s_waitcnt lgkmcnt(10)
    v_mfma_f32_16x16x32_bf16 v[64:67], a[144:147], v[128:131], v[64:67]
    ds_read_b128 v[124:127], v11 offset:30720
    v_mfma_f32_16x16x32_bf16 v[68:71], a[148:151], v[128:131], v[68:71]
    s_waitcnt vmcnt(8)
    ds_read_b64_tr_b16 a[176:177], v3 offset:4096
    s_waitcnt lgkmcnt(11)
    v_mfma_f32_16x16x32_bf16 v[76:79], a[148:151], v[132:135], v[76:79]
    ds_read_b128 v[128:131], v10 offset:29696
    v_mfma_f32_16x16x32_bf16 v[72:75], a[144:147], v[132:135], v[72:75]
    ds_read_b64_tr_b16 a[178:179], v3 offset:5120
    ds_read_b64_tr_b16 a[180:181], v4 offset:4096
    s_waitcnt lgkmcnt(13)
    v_mfma_f32_16x16x32_bf16 v[80:83], a[144:147], v[136:139], v[80:83]
    ds_read_b128 v[132:135], v10 offset:31744
    v_mfma_f32_16x16x32_bf16 v[84:87], a[148:151], v[136:139], v[84:87]
    ds_read_b64_tr_b16 a[182:183], v4 offset:5120
    ds_read_b64_tr_b16 a[184:185], v3 offset:6144
    s_waitcnt lgkmcnt(15)
    v_mfma_f32_16x16x32_bf16 v[92:95], a[148:151], v[140:143], v[92:95]
    ds_read_b128 v[136:139], v11 offset:29696
    v_mfma_f32_16x16x32_bf16 v[88:91], a[144:147], v[140:143], v[88:91]
    ds_read_b64_tr_b16 a[186:187], v3 offset:7168
    ds_read_b64_tr_b16 a[188:189], v4 offset:6144
    s_waitcnt lgkmcnt(15)
    v_mfma_f32_16x16x32_bf16 v[64:67], a[152:155], v[96:99], v[64:67]
    ds_read_b128 v[140:143], v11 offset:31744
    v_mfma_f32_16x16x32_bf16 v[68:71], a[156:159], v[96:99], v[68:71]
    ds_read_b64_tr_b16 a[190:191], v4 offset:7168
    s_barrier
    v_mfma_f32_16x16x32_bf16 v[76:79], a[156:159], v[100:103], v[76:79]
    ds_read2st64_b64 v[96:99], v26 offset0:64 offset1:65
    v_mfma_f32_16x16x32_bf16 v[72:75], a[152:155], v[100:103], v[72:75]
    v_mfma_f32_16x16x32_bf16 v[80:83], a[152:155], v[104:107], v[80:83]
    ds_read2st64_b64 v[100:103], v26 offset0:68 offset1:69
    v_mfma_f32_16x16x32_bf16 v[84:87], a[156:159], v[104:107], v[84:87]
    s_waitcnt lgkmcnt(15)
    v_mfma_f32_16x16x32_bf16 v[92:95], a[156:159], v[108:111], v[92:95]
    ds_read2st64_b64 v[104:107], v27 offset0:64 offset1:65
    v_mfma_f32_16x16x32_bf16 v[88:91], a[152:155], v[108:111], v[88:91]
    v_mfma_f32_16x16x32_bf16 v[64:67], a[160:163], v[112:115], v[64:67]
    ds_read2st64_b64 v[108:111], v27 offset0:68 offset1:69
    v_mfma_f32_16x16x32_bf16 v[68:71], a[164:167], v[112:115], v[68:71]
    v_mfma_f32_16x16x32_bf16 v[76:79], a[164:167], v[116:119], v[76:79]
    ds_read_b128 v[112:115], v10 offset:33792
    v_mfma_f32_16x16x32_bf16 v[72:75], a[160:163], v[116:119], v[72:75]
    v_mfma_f32_16x16x32_bf16 v[80:83], a[160:163], v[120:123], v[80:83]
    ds_read_b128 v[116:119], v10 offset:35840
    v_mfma_f32_16x16x32_bf16 v[84:87], a[164:167], v[120:123], v[84:87]
    s_waitcnt lgkmcnt(15)
    v_mfma_f32_16x16x32_bf16 v[92:95], a[164:167], v[124:127], v[92:95]
    ds_read_b128 v[120:123], v11 offset:33792
    v_mfma_f32_16x16x32_bf16 v[88:91], a[160:163], v[124:127], v[88:91]
    v_mfma_f32_16x16x32_bf16 v[64:67], a[168:171], v[128:131], v[64:67]
    ds_read_b128 v[124:127], v11 offset:35840
    v_mfma_f32_16x16x32_bf16 v[68:71], a[172:175], v[128:131], v[68:71]
    s_waitcnt vmcnt(4)
    s_barrier
    s_waitcnt lgkmcnt(15)
    v_mfma_f32_16x16x32_bf16 v[76:79], a[172:175], v[132:135], v[76:79]
    ds_read_b128 v[128:131], v10 offset:36864
    v_mfma_f32_16x16x32_bf16 v[72:75], a[168:171], v[132:135], v[72:75]
    s_waitcnt lgkmcnt(13)
    v_mfma_f32_16x16x32_bf16 v[80:83], a[168:171], v[136:139], v[80:83]
    ds_read_b128 v[132:135], v10 offset:38912
    v_mfma_f32_16x16x32_bf16 v[84:87], a[172:175], v[136:139], v[84:87]
    s_waitcnt lgkmcnt(11)
    v_mfma_f32_16x16x32_bf16 v[92:95], a[172:175], v[140:143], v[92:95]
    ds_read_b128 v[136:139], v11 offset:36864
    v_mfma_f32_16x16x32_bf16 v[88:91], a[168:171], v[140:143], v[88:91]
    s_waitcnt lgkmcnt(10)
    v_mfma_f32_16x16x32_bf16 v[64:67], a[176:179], v[96:99], v[64:67]
    ds_read_b128 v[140:143], v11 offset:38912
    v_mfma_f32_16x16x32_bf16 v[68:71], a[180:183], v[96:99], v[68:71]
    s_waitcnt vmcnt(0)
    ds_read_b64_tr_b16 a[192:193], v3 offset:8192
    s_waitcnt lgkmcnt(11)
    v_mfma_f32_16x16x32_bf16 v[76:79], a[180:183], v[100:103], v[76:79]
    ds_read_b128 v[96:99], v10 offset:37888
    v_mfma_f32_16x16x32_bf16 v[72:75], a[176:179], v[100:103], v[72:75]
    ds_read_b64_tr_b16 a[194:195], v3 offset:9216
    ds_read_b64_tr_b16 a[196:197], v4 offset:8192
    s_waitcnt lgkmcnt(13)
    v_mfma_f32_16x16x32_bf16 v[80:83], a[176:179], v[104:107], v[80:83]
    ds_read_b128 v[100:103], v10 offset:39936
    v_mfma_f32_16x16x32_bf16 v[84:87], a[180:183], v[104:107], v[84:87]
    ds_read_b64_tr_b16 a[198:199], v4 offset:9216
    ds_read_b64_tr_b16 a[200:201], v3 offset:10240
    s_waitcnt lgkmcnt(15)
    v_mfma_f32_16x16x32_bf16 v[92:95], a[180:183], v[108:111], v[92:95]
    ds_read_b128 v[104:107], v11 offset:37888
    v_mfma_f32_16x16x32_bf16 v[88:91], a[176:179], v[108:111], v[88:91]
    ds_read_b64_tr_b16 a[202:203], v3 offset:11264
    ds_read_b64_tr_b16 a[204:205], v4 offset:10240
    s_waitcnt lgkmcnt(15)
    v_mfma_f32_16x16x32_bf16 v[64:67], a[184:187], v[112:115], v[64:67]
    ds_read_b128 v[108:111], v11 offset:39936
    v_mfma_f32_16x16x32_bf16 v[68:71], a[188:191], v[112:115], v[68:71]
    ds_read_b64_tr_b16 a[206:207], v4 offset:11264
    v_mfma_f32_16x16x32_bf16 v[76:79], a[188:191], v[116:119], v[76:79]
    ds_read_b128 v[112:115], v8 offset:16384
    v_mfma_f32_16x16x32_bf16 v[72:75], a[184:187], v[116:119], v[72:75]
    v_mfma_f32_16x16x32_bf16 v[80:83], a[184:187], v[120:123], v[80:83]
    ds_read_b128 v[116:119], v8 offset:18432
    v_mfma_f32_16x16x32_bf16 v[84:87], a[188:191], v[120:123], v[84:87]
    s_waitcnt lgkmcnt(15)
    v_mfma_f32_16x16x32_bf16 v[92:95], a[188:191], v[124:127], v[92:95]
    ds_read_b128 v[120:123], v9 offset:16384
    v_mfma_f32_16x16x32_bf16 v[88:91], a[184:187], v[124:127], v[88:91]
    s_waitcnt lgkmcnt(3)
    v_mfma_f32_16x16x32_bf16 v[64:67], a[192:195], v[128:131], v[64:67]
    ds_read_b128 v[124:127], v9 offset:18432
    v_mfma_f32_16x16x32_bf16 v[68:71], a[196:199], v[128:131], v[68:71]
    v_mfma_f32_16x16x32_bf16 v[76:79], a[196:199], v[132:135], v[76:79]
    ds_read2st64_b64 v[128:131], v24 offset0:34 offset1:35
    v_mfma_f32_16x16x32_bf16 v[72:75], a[192:195], v[132:135], v[72:75]
    v_mfma_f32_16x16x32_bf16 v[80:83], a[192:195], v[136:139], v[80:83]
    ds_read2st64_b64 v[132:135], v24 offset0:38 offset1:39
    v_mfma_f32_16x16x32_bf16 v[84:87], a[196:199], v[136:139], v[84:87]
    v_mfma_f32_16x16x32_bf16 v[92:95], a[196:199], v[140:143], v[92:95]
    ds_read2st64_b64 v[136:139], v25 offset0:34 offset1:35
    v_mfma_f32_16x16x32_bf16 v[88:91], a[192:195], v[140:143], v[88:91]
    v_mfma_f32_16x16x32_bf16 v[64:67], a[200:203], v[96:99], v[64:67]
    ds_read2st64_b64 v[140:143], v25 offset0:38 offset1:39
    v_mfma_f32_16x16x32_bf16 v[68:71], a[204:207], v[96:99], v[68:71]
    v_mfma_f32_16x16x32_bf16 v[76:79], a[204:207], v[100:103], v[76:79]
    ds_read_b128 v[96:99], v8 offset:20480
    v_mfma_f32_16x16x32_bf16 v[72:75], a[200:203], v[100:103], v[72:75]
    v_mfma_f32_16x16x32_bf16 v[80:83], a[200:203], v[104:107], v[80:83]
    ds_read_b128 v[100:103], v8 offset:22528
    v_mfma_f32_16x16x32_bf16 v[84:87], a[204:207], v[104:107], v[84:87]
    v_mfma_f32_16x16x32_bf16 v[92:95], a[204:207], v[108:111], v[92:95]
    ds_read_b128 v[104:107], v9 offset:20480
    v_mfma_f32_16x16x32_bf16 v[88:91], a[200:203], v[108:111], v[88:91]
    s_waitcnt lgkmcnt(10)
    v_mfma_f32_16x16x32_bf16 v[32:35], v[240:243], v[112:115], v[32:35]
    ds_read_b128 v[108:111], v9 offset:22528
    v_mfma_f32_16x16x32_bf16 v[36:39], v[244:247], v[112:115], v[36:39]
    v_cvt_pk_bf16_f32 v64, v64, v65
    v_cvt_pk_bf16_f32 v65, v66, v67
    v_cvt_pk_bf16_f32 v66, v68, v69
    v_cvt_pk_bf16_f32 v67, v70, v71
    buffer_store_dwordx4 v[64:67], v16, s[40:43], s57 offen offset:0 sc1
    s_waitcnt lgkmcnt(10)
    v_mfma_f32_16x16x32_bf16 v[44:47], v[244:247], v[116:119], v[44:47]
    ds_read_b128 v[112:115], v8 offset:21504
    v_mfma_f32_16x16x32_bf16 v[40:43], v[240:243], v[116:119], v[40:43]
    v_cvt_pk_bf16_f32 v72, v72, v73
    v_cvt_pk_bf16_f32 v73, v74, v75
    v_cvt_pk_bf16_f32 v74, v76, v77
    v_cvt_pk_bf16_f32 v75, v78, v79
    buffer_store_dwordx4 v[72:75], v16, s[40:43], s57 offen offset:1024 sc1
    s_waitcnt lgkmcnt(10)
    v_mfma_f32_16x16x32_bf16 v[48:51], v[240:243], v[120:123], v[48:51]
    ds_read_b128 v[116:119], v8 offset:23552
    v_mfma_f32_16x16x32_bf16 v[52:55], v[244:247], v[120:123], v[52:55]
    v_cvt_pk_bf16_f32 v80, v80, v81
    v_cvt_pk_bf16_f32 v81, v82, v83
    v_cvt_pk_bf16_f32 v82, v84, v85
    v_cvt_pk_bf16_f32 v83, v86, v87
    buffer_store_dwordx4 v[80:83], v16, s[40:43], s57 offen offset:2048 sc1
    s_waitcnt lgkmcnt(10)
    v_mfma_f32_16x16x32_bf16 v[60:63], v[244:247], v[124:127], v[60:63]
    ds_read_b128 v[120:123], v9 offset:21504
    v_mfma_f32_16x16x32_bf16 v[56:59], v[240:243], v[124:127], v[56:59]
    v_cvt_pk_bf16_f32 v88, v88, v89
    v_cvt_pk_bf16_f32 v89, v90, v91
    v_cvt_pk_bf16_f32 v90, v92, v93
    v_cvt_pk_bf16_f32 v91, v94, v95
    buffer_store_dwordx4 v[88:91], v16, s[40:43], s57 offen offset:3072 sc1
    s_waitcnt lgkmcnt(10)
    v_mfma_f32_16x16x32_bf16 v[32:35], v[248:251], v[128:131], v[32:35]
    ds_read_b128 v[124:127], v9 offset:23552
    v_mfma_f32_16x16x32_bf16 v[36:39], v[252:255], v[128:131], v[36:39]
    s_waitcnt lgkmcnt(10)
    v_mfma_f32_16x16x32_bf16 v[44:47], v[252:255], v[132:135], v[44:47]
    ds_read_b128 v[128:131], v8 offset:24576
    v_mfma_f32_16x16x32_bf16 v[40:43], v[248:251], v[132:135], v[40:43]
    s_waitcnt lgkmcnt(10)
    v_mfma_f32_16x16x32_bf16 v[48:51], v[248:251], v[136:139], v[48:51]
    ds_read_b128 v[132:135], v8 offset:26624
    v_mfma_f32_16x16x32_bf16 v[52:55], v[252:255], v[136:139], v[52:55]
    s_waitcnt lgkmcnt(10)
    v_mfma_f32_16x16x32_bf16 v[60:63], v[252:255], v[140:143], v[60:63]
    ds_read_b128 v[136:139], v9 offset:24576
    v_mfma_f32_16x16x32_bf16 v[56:59], v[248:251], v[140:143], v[56:59]
    s_waitcnt lgkmcnt(10)
    v_mfma_f32_16x16x32_bf16 v[32:35], a[128:131], v[96:99], v[32:35]
    ds_read_b128 v[140:143], v9 offset:26624
    v_mfma_f32_16x16x32_bf16 v[36:39], a[132:135], v[96:99], v[36:39]
    s_waitcnt lgkmcnt(10)
    v_mfma_f32_16x16x32_bf16 v[44:47], a[132:135], v[100:103], v[44:47]
    ds_read_b128 v[96:99], v8 offset:25600
    v_mfma_f32_16x16x32_bf16 v[40:43], a[128:131], v[100:103], v[40:43]
    s_waitcnt lgkmcnt(10)
    v_mfma_f32_16x16x32_bf16 v[48:51], a[128:131], v[104:107], v[48:51]
    ds_read_b128 v[100:103], v8 offset:27648
    v_mfma_f32_16x16x32_bf16 v[52:55], a[132:135], v[104:107], v[52:55]
    s_waitcnt lgkmcnt(10)
    v_mfma_f32_16x16x32_bf16 v[60:63], a[132:135], v[108:111], v[60:63]
    ds_read_b128 v[104:107], v9 offset:25600
    v_mfma_f32_16x16x32_bf16 v[56:59], a[128:131], v[108:111], v[56:59]
    s_waitcnt lgkmcnt(10)
    v_mfma_f32_16x16x32_bf16 v[32:35], a[136:139], v[112:115], v[32:35]
    ds_read_b128 v[108:111], v9 offset:27648
    v_mfma_f32_16x16x32_bf16 v[36:39], a[140:143], v[112:115], v[36:39]
    s_waitcnt lgkmcnt(10)
    v_mfma_f32_16x16x32_bf16 v[44:47], a[140:143], v[116:119], v[44:47]
    ds_read_b128 v[112:115], v8 offset:28672
    v_mfma_f32_16x16x32_bf16 v[40:43], a[136:139], v[116:119], v[40:43]
    s_waitcnt lgkmcnt(10)
    v_mfma_f32_16x16x32_bf16 v[48:51], a[136:139], v[120:123], v[48:51]
    ds_read_b128 v[116:119], v8 offset:30720
    v_mfma_f32_16x16x32_bf16 v[52:55], a[140:143], v[120:123], v[52:55]
    s_waitcnt lgkmcnt(10)
    v_mfma_f32_16x16x32_bf16 v[60:63], a[140:143], v[124:127], v[60:63]
    ds_read_b128 v[120:123], v9 offset:28672
    v_mfma_f32_16x16x32_bf16 v[56:59], a[136:139], v[124:127], v[56:59]
    s_waitcnt lgkmcnt(10)
    v_mfma_f32_16x16x32_bf16 v[32:35], a[144:147], v[128:131], v[32:35]
    ds_read_b128 v[124:127], v9 offset:30720
    v_mfma_f32_16x16x32_bf16 v[36:39], a[148:151], v[128:131], v[36:39]
    buffer_load_dwordx4 a[0:3], v13, s[44:47], s85 offen sc1
    s_waitcnt lgkmcnt(10)
    v_mfma_f32_16x16x32_bf16 v[44:47], a[148:151], v[132:135], v[44:47]
    ds_read_b128 v[128:131], v8 offset:29696
    v_mfma_f32_16x16x32_bf16 v[40:43], a[144:147], v[132:135], v[40:43]
    s_add_u32 s86, s85, 32768
    buffer_load_dwordx4 a[4:7], v13, s[44:47], s86 offen sc1
    s_waitcnt lgkmcnt(10)
    v_mfma_f32_16x16x32_bf16 v[48:51], a[144:147], v[136:139], v[48:51]
    ds_read_b128 v[132:135], v8 offset:31744
    v_mfma_f32_16x16x32_bf16 v[52:55], a[148:151], v[136:139], v[52:55]
    s_add_u32 s86, s85, 65536
    buffer_load_dwordx4 a[8:11], v13, s[44:47], s86 offen sc1
    s_waitcnt lgkmcnt(10)
    v_mfma_f32_16x16x32_bf16 v[60:63], a[148:151], v[140:143], v[60:63]
    ds_read_b128 v[136:139], v9 offset:29696
    v_mfma_f32_16x16x32_bf16 v[56:59], a[144:147], v[140:143], v[56:59]
    s_add_u32 s86, s85, 98304
    buffer_load_dwordx4 a[12:15], v13, s[44:47], s86 offen sc1
    s_waitcnt lgkmcnt(10)
    v_mfma_f32_16x16x32_bf16 v[32:35], a[152:155], v[96:99], v[32:35]
    ds_read_b128 v[140:143], v9 offset:31744
    v_mfma_f32_16x16x32_bf16 v[36:39], a[156:159], v[96:99], v[36:39]
    s_waitcnt lgkmcnt(10)
    v_mfma_f32_16x16x32_bf16 v[44:47], a[156:159], v[100:103], v[44:47]
    ds_read2st64_b64 v[96:99], v24 offset0:64 offset1:65
    v_mfma_f32_16x16x32_bf16 v[40:43], a[152:155], v[100:103], v[40:43]
    s_waitcnt lgkmcnt(10)
    v_mfma_f32_16x16x32_bf16 v[48:51], a[152:155], v[104:107], v[48:51]
    ds_read2st64_b64 v[100:103], v24 offset0:68 offset1:69
    v_mfma_f32_16x16x32_bf16 v[52:55], a[156:159], v[104:107], v[52:55]
    s_waitcnt lgkmcnt(10)
    v_mfma_f32_16x16x32_bf16 v[60:63], a[156:159], v[108:111], v[60:63]
    ds_read2st64_b64 v[104:107], v25 offset0:64 offset1:65
    v_mfma_f32_16x16x32_bf16 v[56:59], a[152:155], v[108:111], v[56:59]
    s_waitcnt lgkmcnt(10)
    v_mfma_f32_16x16x32_bf16 v[32:35], a[160:163], v[112:115], v[32:35]
    ds_read2st64_b64 v[108:111], v25 offset0:68 offset1:69
    v_mfma_f32_16x16x32_bf16 v[36:39], a[164:167], v[112:115], v[36:39]
    s_waitcnt lgkmcnt(10)
    v_mfma_f32_16x16x32_bf16 v[44:47], a[164:167], v[116:119], v[44:47]
    ds_read_b128 v[112:115], v8 offset:33792
    v_mfma_f32_16x16x32_bf16 v[40:43], a[160:163], v[116:119], v[40:43]
    s_waitcnt lgkmcnt(10)
    v_mfma_f32_16x16x32_bf16 v[48:51], a[160:163], v[120:123], v[48:51]
    ds_read_b128 v[116:119], v8 offset:35840
    v_mfma_f32_16x16x32_bf16 v[52:55], a[164:167], v[120:123], v[52:55]
    s_waitcnt lgkmcnt(10)
    v_mfma_f32_16x16x32_bf16 v[60:63], a[164:167], v[124:127], v[60:63]
    ds_read_b128 v[120:123], v9 offset:33792
    v_mfma_f32_16x16x32_bf16 v[56:59], a[160:163], v[124:127], v[56:59]
    s_waitcnt lgkmcnt(10)
    v_mfma_f32_16x16x32_bf16 v[32:35], a[168:171], v[128:131], v[32:35]
    ds_read_b128 v[124:127], v9 offset:35840
    v_mfma_f32_16x16x32_bf16 v[36:39], a[172:175], v[128:131], v[36:39]
    s_waitcnt lgkmcnt(10)
    v_mfma_f32_16x16x32_bf16 v[44:47], a[172:175], v[132:135], v[44:47]
    ds_read_b128 v[128:131], v8 offset:36864
    v_mfma_f32_16x16x32_bf16 v[40:43], a[168:171], v[132:135], v[40:43]
    s_waitcnt lgkmcnt(10)
    v_mfma_f32_16x16x32_bf16 v[48:51], a[168:171], v[136:139], v[48:51]
    ds_read_b128 v[132:135], v8 offset:38912
    v_mfma_f32_16x16x32_bf16 v[52:55], a[172:175], v[136:139], v[52:55]
    s_waitcnt lgkmcnt(10)
    v_mfma_f32_16x16x32_bf16 v[60:63], a[172:175], v[140:143], v[60:63]
    ds_read_b128 v[136:139], v9 offset:36864
    v_mfma_f32_16x16x32_bf16 v[56:59], a[168:171], v[140:143], v[56:59]
    s_waitcnt lgkmcnt(10)
    v_mfma_f32_16x16x32_bf16 v[32:35], a[176:179], v[96:99], v[32:35]
    ds_read_b128 v[140:143], v9 offset:38912
    v_mfma_f32_16x16x32_bf16 v[36:39], a[180:183], v[96:99], v[36:39]
    s_waitcnt lgkmcnt(10)
    v_mfma_f32_16x16x32_bf16 v[44:47], a[180:183], v[100:103], v[44:47]
    ds_read_b128 v[96:99], v8 offset:37888
    v_mfma_f32_16x16x32_bf16 v[40:43], a[176:179], v[100:103], v[40:43]
    s_waitcnt lgkmcnt(10)
    v_mfma_f32_16x16x32_bf16 v[48:51], a[176:179], v[104:107], v[48:51]
    ds_read_b128 v[100:103], v8 offset:39936
    v_mfma_f32_16x16x32_bf16 v[52:55], a[180:183], v[104:107], v[52:55]
    s_waitcnt lgkmcnt(10)
    v_mfma_f32_16x16x32_bf16 v[60:63], a[180:183], v[108:111], v[60:63]
    ds_read_b128 v[104:107], v9 offset:37888
    v_mfma_f32_16x16x32_bf16 v[56:59], a[176:179], v[108:111], v[56:59]
    s_waitcnt vmcnt(4)
    buffer_load_dword v22, v20, s[92:95], s59 offen sc1
    s_mov_b64 exec, 1
    buffer_store_dword v21, v20, s[92:95], s56 offen sc1
    s_mov_b64 exec, -1
    s_waitcnt lgkmcnt(10)
    v_mfma_f32_16x16x32_bf16 v[32:35], a[184:187], v[112:115], v[32:35]
    ds_read_b128 v[108:111], v9 offset:39936
    v_mfma_f32_16x16x32_bf16 v[36:39], a[188:191], v[112:115], v[36:39]
    s_waitcnt lgkmcnt(10)
    v_mfma_f32_16x16x32_bf16 v[44:47], a[188:191], v[116:119], v[44:47]
    v_mfma_f32_16x16x32_bf16 v[40:43], a[184:187], v[116:119], v[40:43]
    s_waitcnt lgkmcnt(9)
    v_mfma_f32_16x16x32_bf16 v[48:51], a[184:187], v[120:123], v[48:51]
    v_mfma_f32_16x16x32_bf16 v[52:55], a[188:191], v[120:123], v[52:55]
    s_waitcnt lgkmcnt(8)
    v_mfma_f32_16x16x32_bf16 v[60:63], a[188:191], v[124:127], v[60:63]
    v_mfma_f32_16x16x32_bf16 v[56:59], a[184:187], v[124:127], v[56:59]
    s_waitcnt lgkmcnt(7)
    v_mfma_f32_16x16x32_bf16 v[32:35], a[192:195], v[128:131], v[32:35]
    v_mfma_f32_16x16x32_bf16 v[36:39], a[196:199], v[128:131], v[36:39]
    s_waitcnt lgkmcnt(6)
    v_mfma_f32_16x16x32_bf16 v[44:47], a[196:199], v[132:135], v[44:47]
    v_mfma_f32_16x16x32_bf16 v[40:43], a[192:195], v[132:135], v[40:43]
    s_waitcnt lgkmcnt(5)
    v_mfma_f32_16x16x32_bf16 v[48:51], a[192:195], v[136:139], v[48:51]
    v_mfma_f32_16x16x32_bf16 v[52:55], a[196:199], v[136:139], v[52:55]
    s_waitcnt lgkmcnt(4)
    v_mfma_f32_16x16x32_bf16 v[60:63], a[196:199], v[140:143], v[60:63]
    v_mfma_f32_16x16x32_bf16 v[56:59], a[192:195], v[140:143], v[56:59]
    s_waitcnt lgkmcnt(3)
    v_mfma_f32_16x16x32_bf16 v[32:35], a[200:203], v[96:99], v[32:35]
    v_mfma_f32_16x16x32_bf16 v[36:39], a[204:207], v[96:99], v[36:39]
    s_waitcnt lgkmcnt(2)
    v_mfma_f32_16x16x32_bf16 v[44:47], a[204:207], v[100:103], v[44:47]
    v_mfma_f32_16x16x32_bf16 v[40:43], a[200:203], v[100:103], v[40:43]
    s_waitcnt lgkmcnt(1)
    v_mfma_f32_16x16x32_bf16 v[48:51], a[200:203], v[104:107], v[48:51]
    v_mfma_f32_16x16x32_bf16 v[52:55], a[204:207], v[104:107], v[52:55]
    s_waitcnt lgkmcnt(0)
    v_mfma_f32_16x16x32_bf16 v[60:63], a[204:207], v[108:111], v[60:63]
    v_mfma_f32_16x16x32_bf16 v[56:59], a[200:203], v[108:111], v[56:59]
    s_waitcnt vmcnt(1)
    v_cmp_ne_u32 vcc, s31, v22
    s_cbranch_vccz L_xok
L_poll10:
    buffer_load_dword v22, v20, s[92:95], s59 offen sc1
    s_waitcnt vmcnt(0)
    v_cmp_ne_u32 vcc, s31, v22
    s_add_u32 s3, s3, 1
    s_cmp_gt_u32 s3, 200000
    s_cbranch_scc1 L_poll10x
    s_cbranch_vccz L_poll10x
    s_branch L_poll10
L_poll10x:
L_xok:
    buffer_load_dwordx4 v[96:99], v16, s[40:43], s58 offen offset:0 sc1
    buffer_load_dwordx4 v[100:103], v16, s[40:43], s58 offen offset:1024 sc1
    buffer_load_dwordx4 v[104:107], v16, s[40:43], s58 offen offset:2048 sc1
    buffer_load_dwordx4 v[108:111], v16, s[40:43], s58 offen offset:3072 sc1
    v_accvgpr_read_b32 v192, a0
    v_accvgpr_read_b32 v193, a1
    v_accvgpr_read_b32 v194, a2
    v_accvgpr_read_b32 v195, a3
    v_accvgpr_read_b32 v196, a4
    v_accvgpr_read_b32 v197, a5
    v_accvgpr_read_b32 v198, a6
    v_accvgpr_read_b32 v199, a7
    v_accvgpr_read_b32 v200, a8
    v_accvgpr_read_b32 v201, a9
    v_accvgpr_read_b32 v202, a10
    v_accvgpr_read_b32 v203, a11
    v_accvgpr_read_b32 v204, a12
    v_accvgpr_read_b32 v205, a13
    v_accvgpr_read_b32 v206, a14
    v_accvgpr_read_b32 v207, a15
    v_permlane16_swap_b32 v192, v194
    v_permlane16_swap_b32 v193, v195
    v_permlane16_swap_b32 v196, v198
    v_permlane16_swap_b32 v197, v199
    v_permlane16_swap_b32 v200, v202
    v_permlane16_swap_b32 v201, v203
    s_nop 0
    v_permlane16_swap_b32 v204, v206
    v_permlane16_swap_b32 v205, v207
    v_lshlrev_b32 v208, 16, v192
    v_and_b32 v209, s90, v192
    v_lshlrev_b32 v210, 16, v193
    v_and_b32 v211, s90, v193
    v_lshlrev_b32 v212, 16, v194
    v_and_b32 v213, s90, v194
    v_lshlrev_b32 v214, 16, v195
    v_and_b32 v215, s90, v195
    v_lshlrev_b32 v216, 16, v196
    v_and_b32 v217, s90, v196
    v_lshlrev_b32 v218, 16, v197
    v_and_b32 v219, s90, v197
    v_lshlrev_b32 v220, 16, v198
    v_and_b32 v221, s90, v198
    v_lshlrev_b32 v222, 16, v199
    v_and_b32 v223, s90, v199
    v_lshlrev_b32 v224, 16, v200
    v_and_b32 v225, s90, v200
    v_lshlrev_b32 v226, 16, v201
    v_and_b32 v227, s90, v201
    v_lshlrev_b32 v228, 16, v202
    v_and_b32 v229, s90, v202
    v_lshlrev_b32 v230, 16, v203
    v_and_b32 v231, s90, v203
    v_lshlrev_b32 v232, 16, v204
    v_and_b32 v233, s90, v204
    v_lshlrev_b32 v234, 16, v205
    v_and_b32 v235, s90, v205
    v_lshlrev_b32 v236, 16, v206
    v_and_b32 v237, s90, v206
    v_lshlrev_b32 v238, 16, v207
    v_and_b32 v239, s90, v207
    s_mov_b32 s82, 0x3ef5fdf0
    s_mov_b32 s83, 0x3ef5fdf0
    s_waitcnt vmcnt(3)
    v_lshlrev_b32 v128, 16, v96
    v_and_b32 v129, s90, v96
    v_pk_add_f32 v[32:33], v[32:33], v[128:129]
    v_cvt_pk_bf16_f32 v128, v32, v33
    v_lshlrev_b32 v32, 16, v128
    v_and_b32 v33, s90, v128
    v_pk_add_f32 v[32:33], v[32:33], v[208:209]
    v_cvt_pk_bf16_f32 v192, v32, v33
    v_lshlrev_b32 v130, 16, v97
    v_and_b32 v131, s90, v97
    v_pk_add_f32 v[34:35], v[34:35], v[130:131]
    v_cvt_pk_bf16_f32 v130, v34, v35
    v_lshlrev_b32 v34, 16, v130
    v_and_b32 v35, s90, v130
    v_pk_add_f32 v[34:35], v[34:35], v[210:211]
    v_cvt_pk_bf16_f32 v193, v34, v35
    v_lshlrev_b32 v128, 16, v98
    v_and_b32 v129, s90, v98
    v_pk_add_f32 v[36:37], v[36:37], v[128:129]
    v_cvt_pk_bf16_f32 v128, v36, v37
    v_lshlrev_b32 v36, 16, v128
    v_and_b32 v37, s90, v128
    v_pk_add_f32 v[36:37], v[36:37], v[212:213]
    v_cvt_pk_bf16_f32 v194, v36, v37
    v_lshlrev_b32 v130, 16, v99
    v_and_b32 v131, s90, v99
    v_pk_add_f32 v[38:39], v[38:39], v[130:131]
    v_cvt_pk_bf16_f32 v130, v38, v39
    v_lshlrev_b32 v38, 16, v130
    v_and_b32 v39, s90, v130
    v_pk_add_f32 v[38:39], v[38:39], v[214:215]
    v_cvt_pk_bf16_f32 v195, v38, v39
    s_nop 1
    v_permlane16_swap_b32 v192, v194
    v_permlane16_swap_b32 v193, v195
    buffer_store_dwordx4 v[192:195], v13, s[48:51], s85 offen
    s_add_u32 s85, s85, 32768
    s_waitcnt vmcnt(3)
    v_lshlrev_b32 v128, 16, v100
    v_and_b32 v129, s90, v100
    v_pk_add_f32 v[40:41], v[40:41], v[128:129]
    v_cvt_pk_bf16_f32 v128, v40, v41
    v_lshlrev_b32 v40, 16, v128
    v_and_b32 v41, s90, v128
    v_pk_add_f32 v[40:41], v[40:41], v[216:217]
    v_cvt_pk_bf16_f32 v196, v40, v41
    v_lshlrev_b32 v130, 16, v101
    v_and_b32 v131, s90, v101
    v_pk_add_f32 v[42:43], v[42:43], v[130:131]
    v_cvt_pk_bf16_f32 v130, v42, v43
    v_lshlrev_b32 v42, 16, v130
    v_and_b32 v43, s90, v130
    v_pk_add_f32 v[42:43], v[42:43], v[218:219]
    v_cvt_pk_bf16_f32 v197, v42, v43
    v_lshlrev_b32 v128, 16, v102
    v_and_b32 v129, s90, v102
    v_pk_add_f32 v[44:45], v[44:45], v[128:129]
    v_cvt_pk_bf16_f32 v128, v44, v45
    v_lshlrev_b32 v44, 16, v128
    v_and_b32 v45, s90, v128
    v_pk_add_f32 v[44:45], v[44:45], v[220:221]
    v_cvt_pk_bf16_f32 v198, v44, v45
    v_lshlrev_b32 v130, 16, v103
    v_and_b32 v131, s90, v103
    v_pk_add_f32 v[46:47], v[46:47], v[130:131]
    v_cvt_pk_bf16_f32 v130, v46, v47
    v_lshlrev_b32 v46, 16, v130
    v_and_b32 v47, s90, v130
    v_pk_add_f32 v[46:47], v[46:47], v[222:223]
    v_cvt_pk_bf16_f32 v199, v46, v47
    s_nop 1
    v_permlane16_swap_b32 v196, v198
    v_permlane16_swap_b32 v197, v199
    buffer_store_dwordx4 v[196:199], v13, s[48:51], s85 offen
    s_add_u32 s85, s85, 32768
    s_waitcnt vmcnt(3)
    v_lshlrev_b32 v128, 16, v104
    v_and_b32 v129, s90, v104
    v_pk_add_f32 v[48:49], v[48:49], v[128:129]
    v_cvt_pk_bf16_f32 v128, v48, v49
    v_lshlrev_b32 v48, 16, v128
    v_and_b32 v49, s90, v128
    v_pk_add_f32 v[48:49], v[48:49], v[224:225]
    v_cvt_pk_bf16_f32 v200, v48, v49
    v_lshlrev_b32 v130, 16, v105
    v_and_b32 v131, s90, v105
    v_pk_add_f32 v[50:51], v[50:51], v[130:131]
    v_cvt_pk_bf16_f32 v130, v50, v51
    v_lshlrev_b32 v50, 16, v130
    v_and_b32 v51, s90, v130
    v_pk_add_f32 v[50:51], v[50:51], v[226:227]
    v_cvt_pk_bf16_f32 v201, v50, v51
    v_lshlrev_b32 v128, 16, v106
    v_and_b32 v129, s90, v106
    v_pk_add_f32 v[52:53], v[52:53], v[128:129]
    v_cvt_pk_bf16_f32 v128, v52, v53
    v_lshlrev_b32 v52, 16, v128
    v_and_b32 v53, s90, v128
    v_pk_add_f32 v[52:53], v[52:53], v[228:229]
    v_cvt_pk_bf16_f32 v202, v52, v53
    v_lshlrev_b32 v130, 16, v107
    v_and_b32 v131, s90, v107
    v_pk_add_f32 v[54:55], v[54:55], v[130:131]
    v_cvt_pk_bf16_f32 v130, v54, v55
    v_lshlrev_b32 v54, 16, v130
    v_and_b32 v55, s90, v130
    v_pk_add_f32 v[54:55], v[54:55], v[230:231]
    v_cvt_pk_bf16_f32 v203, v54, v55
    s_nop 1
    v_permlane16_swap_b32 v200, v202
    v_permlane16_swap_b32 v201, v203
    buffer_store_dwordx4 v[200:203], v13, s[48:51], s85 offen
    s_add_u32 s85, s85, 32768
    s_waitcnt vmcnt(3)
    v_lshlrev_b32 v128, 16, v108
    v_and_b32 v129, s90, v108
    v_pk_add_f32 v[56:57], v[56:57], v[128:129]
    v_cvt_pk_bf16_f32 v128, v56, v57
    v_lshlrev_b32 v56, 16, v128
    v_and_b32 v57, s90, v128
    v_pk_add_f32 v[56:57], v[56:57], v[232:233]
    v_cvt_pk_bf16_f32 v204, v56, v57
    v_lshlrev_b32 v130, 16, v109
    v_and_b32 v131, s90, v109
    v_pk_add_f32 v[58:59], v[58:59], v[130:131]
    v_cvt_pk_bf16_f32 v130, v58, v59
    v_lshlrev_b32 v58, 16, v130
    v_and_b32 v59, s90, v130
    v_pk_add_f32 v[58:59], v[58:59], v[234:235]
    v_cvt_pk_bf16_f32 v205, v58, v59
    v_lshlrev_b32 v128, 16, v110
    v_and_b32 v129, s90, v110
    v_pk_add_f32 v[60:61], v[60:61], v[128:129]
    v_cvt_pk_bf16_f32 v128, v60, v61
    v_lshlrev_b32 v60, 16, v128
    v_and_b32 v61, s90, v128
    v_pk_add_f32 v[60:61], v[60:61], v[236:237]
    v_cvt_pk_bf16_f32 v206, v60, v61
    v_lshlrev_b32 v130, 16, v111
    v_and_b32 v131, s90, v111
    v_pk_add_f32 v[62:63], v[62:63], v[130:131]
    v_cvt_pk_bf16_f32 v130, v62, v63
    v_lshlrev_b32 v62, 16, v130
    v_and_b32 v63, s90, v130
    v_pk_add_f32 v[62:63], v[62:63], v[238:239]
    v_cvt_pk_bf16_f32 v207, v62, v63
    s_nop 1
    v_permlane16_swap_b32 v204, v206
    v_permlane16_swap_b32 v205, v207
    buffer_store_dwordx4 v[204:207], v13, s[48:51], s85 offen
    s_or_b32 s57, s2, s30
    s_cmp_lg_u32 s57, 0
    s_cbranch_scc1 L_clean_skip
    s_mov_b32 s32, s26
    s_mov_b32 s33, s27
    s_mov_b32 s34, 0x100
    s_mov_b32 s35, 0x20000
    v_mov_b32 v20, 0
    s_mov_b64 exec, 1
    buffer_store_dword v20, v20, s[32:35], 0 offen sc1
    s_mov_b64 exec, -1
L_clean_skip:
L_end:
    s_endpgm
.section .rodata,"a"
.p2align 6
.amdhsa_kernel sequential_preLN__ssm_conv_h3__glu_gated_swiglu__prompt_kernel
  .amdhsa_next_free_vgpr 512
  .amdhsa_next_free_sgpr 102
  .amdhsa_accum_offset 256
  .amdhsa_group_segment_fixed_size 0
  .amdhsa_kernarg_size 104
  .amdhsa_user_sgpr_count 2
  .amdhsa_user_sgpr_kernarg_segment_ptr 1
  .amdhsa_system_sgpr_workgroup_id_x 1
  .amdhsa_float_denorm_mode_32 3
.end_amdhsa_kernel
```
